```python
import torch

def _softmax(x, axis=-1):
    return torch.softmax(x, dim=axis)

def _gelu(x):
    return torch.nn.functional.gelu(x, approximate='tanh')

def _silu(x):
    return torch.nn.functional.silu(x)

def _sigmoid(x):
    return torch.sigmoid(x)

def _layernorm(x, axis=-1, eps=1e-05):
    m = x.mean(dim=axis, keepdim=True)
    v = x.var(dim=axis, keepdim=True, unbiased=False)
    return (x - m) / torch.sqrt(v + eps)

def _scatter_add(tgt, idx, src, axis=0):
    return tgt.clone().index_add_(axis, idx, src)

def _segment_sum(src, seg, n):
    out = torch.zeros((n,) + src.shape[1:], dtype=src.dtype)
    return out.index_add_(0, seg, src)

def _pad(x, pw):
    flat = tuple((v for pair in reversed(pw) for v in pair))
    return torch.nn.functional.pad(x, flat)
kernel_name = 'parallel_sum__softmax_full_mha__mixer_gmlp__prompt'

def setup_inputs():

    _w = lambda a: (lambda t: t.to(torch.bfloat16) if t.is_floating_point() else t)(torch.as_tensor(a))

    def _A_setup():
        B, S, D = (1, 2048, 448)
        return {'x': _w((lambda *s: torch.randn(*s, dtype=torch.bfloat16) * 0.05)(B, S, D)), 'wqkv': _w((lambda *s: torch.randn(*s, dtype=torch.bfloat16) * 0.2)(D, 3 * D)), 'wo': _w((lambda *s: torch.randn(*s, dtype=torch.bfloat16) * 0.1)(D, D))}
    _A_in = _A_setup()

    def _B_setup():
        B, S, D, F = (1, 2048, 448, 1792)
        Fh = F // 2
        return {'x': _w((lambda *s: torch.randn(*s, dtype=torch.bfloat16) * 0.05)(B, S, D)), 'w_in': _w((lambda *s: torch.randn(*s, dtype=torch.bfloat16) * 0.4)(D, 2 * Fh)), 'w_sp': _w(0.01 * (lambda *s: torch.randn(*s, dtype=torch.bfloat16) * 0.4)(S, S)), 'b_sp': _w(1.0 + 0.01 * (lambda *s: torch.randn(*s, dtype=torch.bfloat16) * 0.2)(S)), 'w_out': _w((lambda *s: torch.randn(*s, dtype=torch.bfloat16) * 0.2)(Fh, D))}
    _B_in = _B_setup()
    return {'A_x': _A_in['x'], 'A_wqkv': _A_in['wqkv'], 'A_wo': _A_in['wo'], 'B_x': _B_in['x'], 'B_w_in': _B_in['w_in'], 'B_w_sp': _B_in['w_sp'], 'B_b_sp': _B_in['b_sp'], 'B_w_out': _B_in['w_out']}

def reference(A_x, A_wqkv, A_wo, B_x, B_w_in, B_w_sp, B_b_sp, B_w_out):

    def _A_ref(x, wqkv, wo):
        B, S, D = x.shape
        H = 16
        Dh = D // H
        qkv = (lambda x, *d: x.permute(*d))((x @ wqkv).reshape(B, S, 3, H, Dh), 2, 0, 3, 1, 4)
        q, k, v = (qkv[0], qkv[1], qkv[2])
        scale = Dh ** (-0.5)
        scores = torch.einsum('bhqd,bhkd->bhqk', q, k) * scale
        p = _softmax(scores, axis=-1)
        o = torch.einsum('bhqk,bhkd->bhqd', p, v)
        return (lambda x, *d: x.permute(*d))(o, 0, 2, 1, 3).reshape(B, S, D) @ wo

    def _B_ref(x, w_in, w_sp, b_sp, w_out):
        B, S, D = x.shape
        F = w_in.shape[-1]
        Fh = F // 2
        z = _gelu(torch.einsum('bsd,df->bsf', x, w_in))
        z1 = z[..., :Fh].clone()
        z2 = _layernorm(z[..., Fh:], axis=-1)
        g = torch.einsum('ts,bsf->btf', w_sp, z2) + b_sp[None, :, None]
        return torch.einsum('bsf,fd->bsd', z1 * g, w_out)
    x = A_x
    xn = _layernorm(x, axis=-1)
    return x + _A_ref(xn, A_wqkv, A_wo) + _B_ref(xn, B_w_in, B_w_sp, B_b_sp, B_w_out)
```

```asm
; @launch kernel=k1_kernel grid=(256,1,1) block=(512,1,1) lds=163840
; @launch kernel=k2_kernel grid=(256,1,1) block=(512,1,1) lds=163840
; @launch kernel=k3_kernel grid=(224,1,1) block=(256,1,1) lds=114688
.amdgcn_target "amdgcn-amd-amdhsa--gfx950"
.text
.globl k1_kernel
.p2align 8
.type k1_kernel,@function
k1_kernel:
    s_cmp_lt_u32 s2, 32
    s_cbranch_scc1 L_k1_pref
    s_cmp_ge_u32 s2, 256
    s_cbranch_scc1 L_k1_end
    s_sub_u32 s2, s2, 32
    s_load_dwordx4 s[4:7], s[0:1], 0
    s_load_dwordx2 s[8:9], s[0:1], 32
    s_load_dwordx4 s[12:15], s[0:1], 72
    s_load_dwordx2 s[32:33], s[0:1], 40
    s_memrealtime s[10:11]
    v_lshrrev_b32 v1, 6, v0
    v_and_b32 v0, 63, v0
    v_readfirstlane_b32 s3, v1
    s_bfe_u32 s48, s2, 0x20001
    s_lshl_b32 s48, s48, 2
    s_lshr_b32 s50, s2, 3
    s_mul_i32 s49, s50, 37
    s_lshr_b32 s49, s49, 8
    s_add_u32 s48, s48, s49
    s_mul_i32 s49, s49, 7
    s_sub_u32 s50, s50, s49
    s_and_b32 s51, s2, 1
    s_mul_i32 s49, s51, 7
    s_add_u32 s49, s49, s50
    s_and_b32 s66, s3, 3
    s_lshl_b32 s52, s48, 2
    s_add_u32 s52, s52, s66
    s_mul_i32 s53, s66, 28672
    v_lshrrev_b32 v196, 3, v0
    v_mul_u32_u24 v196, 896, v196
    v_lshrrev_b32 v197, 4, v0
    v_sub_u32 v194, v0, v197
    v_and_b32 v194, 7, v194
    v_xor_b32 v195, 4, v194
    v_lshl_add_u32 v194, v194, 4, v196
    v_lshl_add_u32 v195, v195, 4, v196
    v_lshlrev_b32 v198, 2, v197
    v_sub_u32 v198, v0, v198
    v_and_b32 v198, 15, v198
    v_mul_u32_u24 v2, 3584, v197
    v_lshl_add_u32 v2, v198, 4, v2
    s_mul_i32 s54, s52, 28672
    s_lshl_b32 s56, s49, 8
    s_mul_i32 s57, s3, 28672
    s_add_u32 s56, s56, s57
    s_lshl_b32 s57, s3, 11
    s_add_u32 s57, s57, 114688
    s_lshr_b32 s69, s3, 1
    s_mul_i32 s69, s69, 28672
    s_and_b32 s70, s3, 1
    s_lshl_b32 s70, s70, 11
    s_add_u32 s69, s69, s70
    s_waitcnt lgkmcnt(0)
    s_mov_b32 s16, s4
    s_and_b32 s17, s5, 0xffff
    s_mov_b32 s18, 1835008
    s_mov_b32 s19, 0x20000
    s_mov_b32 s24, s8
    s_and_b32 s25, s9, 0xffff
    s_mov_b32 s26, 1605632
    s_mov_b32 s27, 0x20000
    s_cmp_ge_u32 s3, 4
    s_cbranch_scc1 L_k1_role1
    s_add_u32 s55, s54, 0
    s_add_u32 m0, s53, 0
    s_nop 0
    buffer_load_dwordx4 v194, s[16:19], s55 offen lds
    s_add_u32 s55, s54, 7168
    s_add_u32 m0, s53, 1024
    s_nop 0
    buffer_load_dwordx4 v195, s[16:19], s55 offen lds
    s_add_u32 s55, s54, 14336
    s_add_u32 m0, s53, 2048
    s_nop 0
    buffer_load_dwordx4 v194, s[16:19], s55 offen lds
    s_add_u32 s55, s54, 21504
    s_add_u32 m0, s53, 3072
    s_nop 0
    buffer_load_dwordx4 v195, s[16:19], s55 offen lds
    s_add_u32 s55, s56, 0
    s_add_u32 m0, s57, 0
    s_nop 0
    buffer_load_dwordx4 v2, s[24:27], s55 offen lds
    s_add_u32 s55, s56, 14336
    s_add_u32 m0, s57, 1024
    s_nop 0
    buffer_load_dwordx4 v2, s[24:27], s55 offen lds
    s_add_u32 s55, s54, 256
    s_add_u32 m0, s53, 8192
    s_nop 0
    buffer_load_dwordx4 v194, s[16:19], s55 offen lds
    s_add_u32 s55, s54, 7424
    s_add_u32 m0, s53, 9216
    s_nop 0
    buffer_load_dwordx4 v195, s[16:19], s55 offen lds
    s_add_u32 s55, s54, 14592
    s_add_u32 m0, s53, 10240
    s_nop 0
    buffer_load_dwordx4 v194, s[16:19], s55 offen lds
    s_add_u32 s55, s54, 21760
    s_add_u32 m0, s53, 11264
    s_nop 0
    buffer_load_dwordx4 v195, s[16:19], s55 offen lds
    s_add_u32 s55, s56, 229376
    s_add_u32 m0, s57, 16384
    s_nop 0
    buffer_load_dwordx4 v2, s[24:27], s55 offen lds
    s_add_u32 s55, s56, 243712
    s_add_u32 m0, s57, 17408
    s_nop 0
    buffer_load_dwordx4 v2, s[24:27], s55 offen lds
    v_bfe_u32 v196, v0, 2, 2
    v_bfe_u32 v197, v0, 5, 1
    v_lshl_add_u32 v198, v197, 3, v196
    v_bfe_u32 v199, v0, 4, 1
    v_bfe_u32 v200, v0, 1, 1
    v_lshl_add_u32 v200, v199, 1, v200
    v_lshl_add_u32 v200, v196, 2, v200
    v_and_b32 v201, 1, v0
    v_lshlrev_b32 v201, 3, v201
    v_lshl_add_u32 v201, v198, 8, v201
    v_add_u32 v205, 0, v200
    v_and_b32 v205, 15, v205
    v_lshl_add_u32 v210, v205, 4, v201
    v_add_u32 v211, 57344, v210
    v_add_u32 v212, 114688, v210
    v_add_u32 v205, 4, v200
    v_and_b32 v205, 15, v205
    v_lshl_add_u32 v213, v205, 4, v201
    v_add_u32 v214, 57344, v213
    v_add_u32 v215, 114688, v213
    v_mul_u32_u24 v5, 192, v198
    v_lshl_add_u32 v5, v199, 5, v5
    v_and_b32 v201, 3, v0
    v_lshl_add_u32 v5, v201, 3, v5
    v_add_u32 v6, 57344, v5
    v_add_u32 v7, 114688, v5
    v_lshlrev_b32 v1, 4, v0
    v_mul_u32_u24 v193, 96, v197
    v_and_b32 v196, 31, v0
    v_lshrrev_b32 v198, 1, v196
    v_add_u32 v198, v198, v197
    v_lshlrev_b32 v196, 7, v196
    v_add_u32 v196, s53, v196
    v_add_u32 v205, 0, v198
    v_and_b32 v205, 7, v205
    v_lshl_add_u32 v8, v205, 4, v196
    v_add_u32 v205, 2, v198
    v_and_b32 v205, 7, v205
    v_lshl_add_u32 v9, v205, 4, v196
    v_add_u32 v205, 4, v198
    v_and_b32 v205, 7, v205
    v_lshl_add_u32 v10, v205, 4, v196
    v_add_u32 v205, 6, v198
    v_and_b32 v205, 7, v205
    v_lshl_add_u32 v11, v205, 4, v196
    v_mov_b32 v216, v194
    v_mov_b32 v217, v195
    s_mov_b32 s20, s6
    s_and_b32 s21, s7, 0xffff
    s_mov_b32 s22, 1204224
    s_mov_b32 s23, 0x20000
    s_mov_b32 s28, s14
    s_and_b32 s29, s15, 0xffff
    s_mov_b32 s30, 25165824
    s_mov_b32 s31, 0x20000
    s_mov_b32 s44, s12
    s_and_b32 s45, s13, 0xffff
    s_mov_b32 s46, 256
    s_mov_b32 s47, 0x20000
    s_or_b32 s10, s10, 1
    v_mov_b32 v202, s10
    v_mov_b32 v203, 0
    s_lshl_b32 s58, s48, 2
    v_mov_b32 v204, s58
    s_lshl_b32 s59, s3, 1
    s_sub_u32 s59, s51, s59
    s_cmp_eq_u32 s59, 1
    s_cbranch_scc0 L_k1_nononce
    s_mov_b64 exec, 1
    buffer_atomic_cmpswap v[202:203], v204, s[44:47], 0 offen sc0
    s_mov_b64 exec, -1
L_k1_nononce:
    s_lshl_b32 s58, s3, 6
    s_lshl_b32 s59, s49, 7
    s_lshl_b32 s60, s49, 6
    s_add_u32 s60, s60, 1664
    s_mov_b32 s61, 43691
    v_add_u32 v196, s58, v0
    v_mul_lo_u32 v197, v196, s61
    v_lshrrev_b32 v197, 19, v197
    v_mad_i32_i24 v198, v197, -12, v196
    v_mov_b32 v199, s59
    v_mov_b32 v200, s60
    v_cmp_gt_u32 vcc, 8, v198
    s_nop 1
    v_cndmask_b32 v199, v200, v199, vcc
    v_lshl_add_u32 v199, v198, 4, v199
    v_mul_u32_u24 v197, 2688, v197
    v_add_u32 v3, v197, v199
    v_add_u32 v196, s58, v0
    v_add_u32 v196, 512, v196
    v_mul_lo_u32 v197, v196, s61
    v_lshrrev_b32 v197, 19, v197
    v_mad_i32_i24 v198, v197, -12, v196
    v_mov_b32 v199, s59
    v_mov_b32 v200, s60
    v_cmp_gt_u32 vcc, 8, v198
    s_nop 1
    v_cndmask_b32 v199, v200, v199, vcc
    v_lshl_add_u32 v199, v198, 4, v199
    v_mul_u32_u24 v197, 2688, v197
    v_add_u32 v4, v197, v199
    s_add_u32 s58, s3, 0
    s_mul_i32 s59, s58, 43
    s_lshr_b32 s59, s59, 7
    s_mul_i32 s60, s59, 3
    s_sub_u32 s60, s58, s60
    s_lshl_b32 s60, s60, 10
    s_lshl_b32 s61, s59, 12
    s_add_u32 s61, s61, s60
    s_add_u32 s36, s61, 114688
    s_mul_i32 s61, s59, 28672
    s_add_u32 s38, s61, s60
    s_add_u32 s58, s3, 8
    s_mul_i32 s59, s58, 43
    s_lshr_b32 s59, s59, 7
    s_mul_i32 s60, s59, 3
    s_sub_u32 s60, s58, s60
    s_lshl_b32 s60, s60, 10
    s_lshl_b32 s61, s59, 12
    s_add_u32 s61, s61, s60
    s_add_u32 s37, s61, 114688
    s_mul_i32 s61, s59, 28672
    s_add_u32 s39, s61, s60
    v_mov_b32 v14, 0x409d30fc
    v_mov_b32 v198, 0
    v_mov_b32 v199, 0
    v_mov_b32 v200, 0
    v_mov_b32 v201, 0
    v_mov_b32 v15, 0
    v_mov_b32 v192, 0
    s_waitcnt vmcnt(8)
    s_waitcnt vmcnt(6)
    s_barrier
    ds_read_b128 v[16:19], v8 offset:0
    ds_read_b128 v[20:23], v9 offset:0
    ds_read_b128 v[24:27], v10 offset:0
    ds_read_b128 v[28:31], v11 offset:0
    ds_read_b64_tr_b16 a[0:1], v212 offset:0
    ds_read_b64_tr_b16 a[2:3], v212 offset:1024
    ds_read_b64_tr_b16 a[4:5], v215 offset:0
    ds_read_b64_tr_b16 a[6:7], v215 offset:1024
    ds_read_b64_tr_b16 a[8:9], v212 offset:4096
    ds_read_b64_tr_b16 a[10:11], v212 offset:5120
    ds_read_b64_tr_b16 a[12:13], v215 offset:4096
    ds_read_b64_tr_b16 a[14:15], v215 offset:5120
    ds_read_b128 v[32:35], v8 offset:4096
    ds_read_b128 v[36:39], v9 offset:4096
    ds_read_b128 v[40:43], v10 offset:4096
    ds_read_b128 v[44:47], v11 offset:4096
    s_add_u32 s55, s54, 512
    s_add_u32 m0, s53, 16384
    s_nop 0
    buffer_load_dwordx4 v216, s[16:19], s55 offen lds
    s_add_u32 s55, s54, 7680
    s_add_u32 m0, s53, 17408
    s_nop 0
    buffer_load_dwordx4 v217, s[16:19], s55 offen lds
    s_add_u32 s55, s54, 14848
    s_add_u32 m0, s53, 18432
    s_nop 0
    buffer_load_dwordx4 v216, s[16:19], s55 offen lds
    s_add_u32 s55, s54, 22016
    s_add_u32 m0, s53, 19456
    s_nop 0
    buffer_load_dwordx4 v217, s[16:19], s55 offen lds
    s_add_u32 s55, s56, 458752
    s_add_u32 m0, s57, 32768
    s_nop 0
    buffer_load_dwordx4 v2, s[24:27], s55 offen lds
    s_add_u32 s55, s56, 473088
    s_add_u32 m0, s57, 33792
    s_nop 0
    buffer_load_dwordx4 v2, s[24:27], s55 offen lds
    v_mov_b32 v196, 0x3f803f80
    s_waitcnt lgkmcnt(15)
    v_dot2_f32_bf16 v198, v16, v196, v198
    v_dot2_f32_bf16 v200, v16, v16, v200
    v_dot2_f32_bf16 v199, v17, v196, v199
    v_dot2_f32_bf16 v201, v17, v17, v201
    v_dot2_f32_bf16 v198, v18, v196, v198
    v_dot2_f32_bf16 v200, v18, v18, v200
    v_dot2_f32_bf16 v199, v19, v196, v199
    v_dot2_f32_bf16 v201, v19, v19, v201
    s_waitcnt lgkmcnt(14)
    v_dot2_f32_bf16 v198, v20, v196, v198
    v_dot2_f32_bf16 v200, v20, v20, v200
    v_dot2_f32_bf16 v199, v21, v196, v199
    v_dot2_f32_bf16 v201, v21, v21, v201
    v_dot2_f32_bf16 v198, v22, v196, v198
    v_dot2_f32_bf16 v200, v22, v22, v200
    v_dot2_f32_bf16 v199, v23, v196, v199
    v_dot2_f32_bf16 v201, v23, v23, v201
    s_waitcnt lgkmcnt(13)
    v_dot2_f32_bf16 v198, v24, v196, v198
    v_dot2_f32_bf16 v200, v24, v24, v200
    v_dot2_f32_bf16 v199, v25, v196, v199
    v_dot2_f32_bf16 v201, v25, v25, v201
    v_dot2_f32_bf16 v198, v26, v196, v198
    v_dot2_f32_bf16 v200, v26, v26, v200
    v_dot2_f32_bf16 v199, v27, v196, v199
    v_dot2_f32_bf16 v201, v27, v27, v201
    s_waitcnt lgkmcnt(12)
    v_dot2_f32_bf16 v198, v28, v196, v198
    v_dot2_f32_bf16 v200, v28, v28, v200
    v_dot2_f32_bf16 v199, v29, v196, v199
    v_dot2_f32_bf16 v201, v29, v29, v201
    v_dot2_f32_bf16 v198, v30, v196, v198
    v_dot2_f32_bf16 v200, v30, v30, v200
    v_dot2_f32_bf16 v199, v31, v196, v199
    v_dot2_f32_bf16 v201, v31, v31, v201
    s_nop 2
    s_waitcnt lgkmcnt(10)
    v_mfma_f32_32x32x16_bf16 v[128:143], a[0:3], v[16:19], 0
    ds_read_b64_tr_b16 a[16:17], v212 offset:8192
    ds_read_b64_tr_b16 a[18:19], v212 offset:9216
    ds_read_b64_tr_b16 a[20:21], v215 offset:8192
    ds_read_b64_tr_b16 a[22:23], v215 offset:9216
    s_add_u32 s55, s54, 768
    s_add_u32 m0, s53, 24576
    s_nop 0
    buffer_load_dwordx4 v216, s[16:19], s55 offen lds
    s_add_u32 s55, s54, 7936
    s_add_u32 m0, s53, 25600
    s_nop 0
    buffer_load_dwordx4 v217, s[16:19], s55 offen lds
    s_add_u32 s55, s54, 15104
    s_add_u32 m0, s53, 26624
    s_nop 0
    buffer_load_dwordx4 v216, s[16:19], s55 offen lds
    s_add_u32 s55, s54, 22272
    s_add_u32 m0, s53, 27648
    s_nop 0
    buffer_load_dwordx4 v217, s[16:19], s55 offen lds
    s_waitcnt lgkmcnt(12)
    v_mfma_f32_32x32x16_bf16 v[144:159], a[4:7], v[16:19], 0
    s_waitcnt lgkmcnt(10)
    v_mfma_f32_32x32x16_bf16 v[128:143], a[8:11], v[20:23], v[128:143]
    ds_read_b64_tr_b16 a[0:1], v212 offset:12288
    ds_read_b64_tr_b16 a[2:3], v212 offset:13312
    ds_read_b64_tr_b16 a[4:5], v215 offset:12288
    ds_read_b64_tr_b16 a[6:7], v215 offset:13312
    s_waitcnt lgkmcnt(12)
    v_mfma_f32_32x32x16_bf16 v[144:159], a[12:15], v[20:23], v[144:159]
    s_waitcnt lgkmcnt(0)
    s_waitcnt vmcnt(12)
    s_waitcnt vmcnt(10)
    s_barrier
    ds_read_b128 v[48:51], v8 offset:8192
    ds_read_b128 v[52:55], v9 offset:8192
    ds_read_b128 v[56:59], v10 offset:8192
    ds_read_b128 v[60:63], v11 offset:8192
    ds_read_b128 v[64:67], v8 offset:12288
    ds_read_b128 v[68:71], v9 offset:12288
    ds_read_b128 v[72:75], v10 offset:12288
    ds_read_b128 v[76:79], v11 offset:12288
    s_waitcnt lgkmcnt(7)
    v_dot2_f32_bf16 v198, v48, v196, v198
    v_dot2_f32_bf16 v200, v48, v48, v200
    v_dot2_f32_bf16 v199, v49, v196, v199
    v_dot2_f32_bf16 v201, v49, v49, v201
    v_dot2_f32_bf16 v198, v50, v196, v198
    v_dot2_f32_bf16 v200, v50, v50, v200
    v_dot2_f32_bf16 v199, v51, v196, v199
    v_dot2_f32_bf16 v201, v51, v51, v201
    s_waitcnt lgkmcnt(6)
    v_dot2_f32_bf16 v198, v52, v196, v198
    v_dot2_f32_bf16 v200, v52, v52, v200
    v_dot2_f32_bf16 v199, v53, v196, v199
    v_dot2_f32_bf16 v201, v53, v53, v201
    v_dot2_f32_bf16 v198, v54, v196, v198
    v_dot2_f32_bf16 v200, v54, v54, v200
    v_dot2_f32_bf16 v199, v55, v196, v199
    v_dot2_f32_bf16 v201, v55, v55, v201
    s_waitcnt lgkmcnt(5)
    v_dot2_f32_bf16 v198, v56, v196, v198
    v_dot2_f32_bf16 v200, v56, v56, v200
    v_dot2_f32_bf16 v199, v57, v196, v199
    v_dot2_f32_bf16 v201, v57, v57, v201
    v_dot2_f32_bf16 v198, v58, v196, v198
    v_dot2_f32_bf16 v200, v58, v58, v200
    v_dot2_f32_bf16 v199, v59, v196, v199
    v_dot2_f32_bf16 v201, v59, v59, v201
    s_waitcnt lgkmcnt(4)
    v_dot2_f32_bf16 v198, v60, v196, v198
    v_dot2_f32_bf16 v200, v60, v60, v200
    v_dot2_f32_bf16 v199, v61, v196, v199
    v_dot2_f32_bf16 v201, v61, v61, v201
    v_dot2_f32_bf16 v198, v62, v196, v198
    v_dot2_f32_bf16 v200, v62, v62, v200
    v_dot2_f32_bf16 v199, v63, v196, v199
    v_dot2_f32_bf16 v201, v63, v63, v201
    s_nop 2
    v_mfma_f32_32x32x16_bf16 v[128:143], a[16:19], v[24:27], v[128:143]
    ds_read_b64_tr_b16 a[8:9], v212 offset:16384
    ds_read_b64_tr_b16 a[10:11], v212 offset:17408
    ds_read_b64_tr_b16 a[12:13], v215 offset:16384
    ds_read_b64_tr_b16 a[14:15], v215 offset:17408
    s_add_u32 s55, s56, 688128
    s_add_u32 m0, s69, 0
    s_nop 0
    buffer_load_dwordx4 v2, s[24:27], s55 offen lds
    s_add_u32 s55, s56, 702464
    s_add_u32 m0, s69, 1024
    s_nop 0
    buffer_load_dwordx4 v2, s[24:27], s55 offen lds
    v_mfma_f32_32x32x16_bf16 v[144:159], a[20:23], v[24:27], v[144:159]
    v_mfma_f32_32x32x16_bf16 v[128:143], a[0:3], v[28:31], v[128:143]
    ds_read_b64_tr_b16 a[16:17], v212 offset:20480
    ds_read_b64_tr_b16 a[18:19], v212 offset:21504
    ds_read_b64_tr_b16 a[20:21], v215 offset:20480
    ds_read_b64_tr_b16 a[22:23], v215 offset:21504
    s_add_u32 s55, s56, 917504
    s_add_u32 m0, s69, 4096
    s_nop 0
    buffer_load_dwordx4 v2, s[24:27], s55 offen lds
    s_add_u32 s55, s56, 931840
    s_add_u32 m0, s69, 5120
    s_nop 0
    buffer_load_dwordx4 v2, s[24:27], s55 offen lds
    v_mfma_f32_32x32x16_bf16 v[144:159], a[4:7], v[28:31], v[144:159]
    s_waitcnt lgkmcnt(6)
    v_mfma_f32_32x32x16_bf16 v[128:143], a[8:11], v[32:35], v[128:143]
    ds_read_b64_tr_b16 a[0:1], v212 offset:24576
    ds_read_b64_tr_b16 a[2:3], v212 offset:25600
    ds_read_b64_tr_b16 a[4:5], v215 offset:24576
    ds_read_b64_tr_b16 a[6:7], v215 offset:25600
    s_mov_b32 s55, 344064
    s_add_u32 m0, s36, 0
    s_nop 0
    buffer_load_dwordx4 v3, s[20:23], s55 offen lds
    s_add_u32 m0, s37, 0
    s_nop 0
    buffer_load_dwordx4 v4, s[20:23], s55 offen lds
    s_waitcnt lgkmcnt(8)
    v_mfma_f32_32x32x16_bf16 v[144:159], a[12:15], v[32:35], v[144:159]
    s_waitcnt lgkmcnt(6)
    v_mfma_f32_32x32x16_bf16 v[128:143], a[16:19], v[36:39], v[128:143]
    ds_read_b64_tr_b16 a[8:9], v212 offset:28672
    ds_read_b64_tr_b16 a[10:11], v212 offset:29696
    ds_read_b64_tr_b16 a[12:13], v215 offset:28672
    ds_read_b64_tr_b16 a[14:15], v215 offset:29696
    s_waitcnt lgkmcnt(8)
    v_mfma_f32_32x32x16_bf16 v[144:159], a[20:23], v[36:39], v[144:159]
    s_waitcnt lgkmcnt(0)
    s_waitcnt vmcnt(12)
    s_waitcnt vmcnt(10)
    s_barrier
    ds_read_b128 v[80:83], v8 offset:16384
    ds_read_b128 v[84:87], v9 offset:16384
    ds_read_b128 v[88:91], v10 offset:16384
    ds_read_b128 v[92:95], v11 offset:16384
    ds_read_b128 v[96:99], v8 offset:20480
    ds_read_b128 v[100:103], v9 offset:20480
    ds_read_b128 v[104:107], v10 offset:20480
    ds_read_b128 v[108:111], v11 offset:20480
    s_waitcnt lgkmcnt(7)
    v_dot2_f32_bf16 v198, v80, v196, v198
    v_dot2_f32_bf16 v200, v80, v80, v200
    v_dot2_f32_bf16 v199, v81, v196, v199
    v_dot2_f32_bf16 v201, v81, v81, v201
    v_dot2_f32_bf16 v198, v82, v196, v198
    v_dot2_f32_bf16 v200, v82, v82, v200
    v_dot2_f32_bf16 v199, v83, v196, v199
    v_dot2_f32_bf16 v201, v83, v83, v201
    s_waitcnt lgkmcnt(6)
    v_dot2_f32_bf16 v198, v84, v196, v198
    v_dot2_f32_bf16 v200, v84, v84, v200
    v_dot2_f32_bf16 v199, v85, v196, v199
    v_dot2_f32_bf16 v201, v85, v85, v201
    v_dot2_f32_bf16 v198, v86, v196, v198
    v_dot2_f32_bf16 v200, v86, v86, v200
    v_dot2_f32_bf16 v199, v87, v196, v199
    v_dot2_f32_bf16 v201, v87, v87, v201
    s_waitcnt lgkmcnt(5)
    v_dot2_f32_bf16 v198, v88, v196, v198
    v_dot2_f32_bf16 v200, v88, v88, v200
    v_dot2_f32_bf16 v199, v89, v196, v199
    v_dot2_f32_bf16 v201, v89, v89, v201
    v_dot2_f32_bf16 v198, v90, v196, v198
    v_dot2_f32_bf16 v200, v90, v90, v200
    v_dot2_f32_bf16 v199, v91, v196, v199
    v_dot2_f32_bf16 v201, v91, v91, v201
    s_waitcnt lgkmcnt(4)
    v_dot2_f32_bf16 v198, v92, v196, v198
    v_dot2_f32_bf16 v200, v92, v92, v200
    v_dot2_f32_bf16 v199, v93, v196, v199
    v_dot2_f32_bf16 v201, v93, v93, v201
    v_dot2_f32_bf16 v198, v94, v196, v198
    v_dot2_f32_bf16 v200, v94, v94, v200
    v_dot2_f32_bf16 v199, v95, v196, v199
    v_dot2_f32_bf16 v201, v95, v95, v201
    s_nop 2
    v_mfma_f32_32x32x16_bf16 v[128:143], a[0:3], v[40:43], v[128:143]
    ds_read_b64_tr_b16 a[16:17], v212 offset:32768
    ds_read_b64_tr_b16 a[18:19], v212 offset:33792
    ds_read_b64_tr_b16 a[20:21], v215 offset:32768
    ds_read_b64_tr_b16 a[22:23], v215 offset:33792
    s_add_u32 s55, s56, 1146880
    s_add_u32 m0, s69, 8192
    s_nop 0
    buffer_load_dwordx4 v2, s[24:27], s55 offen lds
    s_add_u32 s55, s56, 1161216
    s_add_u32 m0, s69, 9216
    s_nop 0
    buffer_load_dwordx4 v2, s[24:27], s55 offen lds
    v_mfma_f32_32x32x16_bf16 v[144:159], a[4:7], v[40:43], v[144:159]
    v_mfma_f32_32x32x16_bf16 v[128:143], a[8:11], v[44:47], v[128:143]
    ds_read_b64_tr_b16 a[0:1], v212 offset:36864
    ds_read_b64_tr_b16 a[2:3], v212 offset:37888
    ds_read_b64_tr_b16 a[4:5], v215 offset:36864
    ds_read_b64_tr_b16 a[6:7], v215 offset:37888
    s_add_u32 s55, s56, 1376256
    s_add_u32 m0, s69, 12288
    s_nop 0
    buffer_load_dwordx4 v2, s[24:27], s55 offen lds
    s_add_u32 s55, s56, 1390592
    s_add_u32 m0, s69, 13312
    s_nop 0
    buffer_load_dwordx4 v2, s[24:27], s55 offen lds
    v_mfma_f32_32x32x16_bf16 v[144:159], a[12:15], v[44:47], v[144:159]
    s_waitcnt lgkmcnt(6)
    v_mfma_f32_32x32x16_bf16 v[128:143], a[16:19], v[48:51], v[128:143]
    ds_read_b64_tr_b16 a[8:9], v212 offset:40960
    ds_read_b64_tr_b16 a[10:11], v212 offset:41984
    ds_read_b64_tr_b16 a[12:13], v215 offset:40960
    ds_read_b64_tr_b16 a[14:15], v215 offset:41984
    s_mov_b32 s55, 516096
    s_add_u32 m0, s36, 16384
    s_nop 0
    buffer_load_dwordx4 v3, s[20:23], s55 offen lds
    s_add_u32 m0, s37, 16384
    s_nop 0
    buffer_load_dwordx4 v4, s[20:23], s55 offen lds
    s_waitcnt lgkmcnt(8)
    v_mfma_f32_32x32x16_bf16 v[144:159], a[20:23], v[48:51], v[144:159]
    s_waitcnt lgkmcnt(6)
    v_mfma_f32_32x32x16_bf16 v[128:143], a[0:3], v[52:55], v[128:143]
    ds_read_b64_tr_b16 a[16:17], v212 offset:45056
    ds_read_b64_tr_b16 a[18:19], v212 offset:46080
    ds_read_b64_tr_b16 a[20:21], v215 offset:45056
    ds_read_b64_tr_b16 a[22:23], v215 offset:46080
    s_waitcnt lgkmcnt(8)
    v_mfma_f32_32x32x16_bf16 v[144:159], a[4:7], v[52:55], v[144:159]
    s_waitcnt lgkmcnt(0)
    s_waitcnt vmcnt(12)
    s_waitcnt vmcnt(10)
    s_waitcnt vmcnt(8)
    s_barrier
    ds_read_b128 v[112:115], v8 offset:24576
    ds_read_b128 v[116:119], v9 offset:24576
    ds_read_b128 v[120:123], v10 offset:24576
    ds_read_b128 v[124:127], v11 offset:24576
    s_waitcnt lgkmcnt(3)
    v_dot2_f32_bf16 v198, v112, v196, v198
    v_dot2_f32_bf16 v200, v112, v112, v200
    v_dot2_f32_bf16 v199, v113, v196, v199
    v_dot2_f32_bf16 v201, v113, v113, v201
    v_dot2_f32_bf16 v198, v114, v196, v198
    v_dot2_f32_bf16 v200, v114, v114, v200
    v_dot2_f32_bf16 v199, v115, v196, v199
    v_dot2_f32_bf16 v201, v115, v115, v201
    s_waitcnt lgkmcnt(2)
    v_dot2_f32_bf16 v198, v116, v196, v198
    v_dot2_f32_bf16 v200, v116, v116, v200
    v_dot2_f32_bf16 v199, v117, v196, v199
    v_dot2_f32_bf16 v201, v117, v117, v201
    v_dot2_f32_bf16 v198, v118, v196, v198
    v_dot2_f32_bf16 v200, v118, v118, v200
    v_dot2_f32_bf16 v199, v119, v196, v199
    v_dot2_f32_bf16 v201, v119, v119, v201
    s_waitcnt lgkmcnt(1)
    v_dot2_f32_bf16 v198, v120, v196, v198
    v_dot2_f32_bf16 v200, v120, v120, v200
    v_dot2_f32_bf16 v199, v121, v196, v199
    v_dot2_f32_bf16 v201, v121, v121, v201
    v_dot2_f32_bf16 v198, v122, v196, v198
    v_dot2_f32_bf16 v200, v122, v122, v200
    v_dot2_f32_bf16 v199, v123, v196, v199
    v_dot2_f32_bf16 v201, v123, v123, v201
    s_waitcnt lgkmcnt(0)
    v_dot2_f32_bf16 v198, v124, v196, v198
    v_dot2_f32_bf16 v200, v124, v124, v200
    v_dot2_f32_bf16 v199, v125, v196, v199
    v_dot2_f32_bf16 v201, v125, v125, v201
    v_dot2_f32_bf16 v198, v126, v196, v198
    v_dot2_f32_bf16 v200, v126, v126, v200
    v_dot2_f32_bf16 v199, v127, v196, v199
    v_dot2_f32_bf16 v201, v127, v127, v201
    s_nop 2
    v_mfma_f32_32x32x16_bf16 v[128:143], a[8:11], v[56:59], v[128:143]
    ds_read_b64_tr_b16 a[0:1], v210 offset:0
    ds_read_b64_tr_b16 a[2:3], v210 offset:1024
    ds_read_b64_tr_b16 a[4:5], v213 offset:0
    ds_read_b64_tr_b16 a[6:7], v213 offset:1024
    s_mov_b32 s55, 0
    s_add_u32 m0, s38, 16384
    s_nop 0
    buffer_load_dwordx4 v3, s[20:23], s55 offen lds
    s_add_u32 m0, s39, 16384
    s_nop 0
    buffer_load_dwordx4 v4, s[20:23], s55 offen lds
    v_mfma_f32_32x32x16_bf16 v[144:159], a[12:15], v[56:59], v[144:159]
    v_mfma_f32_32x32x16_bf16 v[128:143], a[16:19], v[60:63], v[128:143]
    ds_read_b64_tr_b16 a[8:9], v210 offset:28672
    ds_read_b64_tr_b16 a[10:11], v210 offset:29696
    ds_read_b64_tr_b16 a[12:13], v213 offset:28672
    ds_read_b64_tr_b16 a[14:15], v213 offset:29696
    s_mov_b32 s55, 172032
    s_add_u32 m0, s38, 20480
    s_nop 0
    buffer_load_dwordx4 v3, s[20:23], s55 offen lds
    s_add_u32 m0, s39, 20480
    s_nop 0
    buffer_load_dwordx4 v4, s[20:23], s55 offen lds
    v_mfma_f32_32x32x16_bf16 v[144:159], a[20:23], v[60:63], v[144:159]
    s_waitcnt lgkmcnt(6)
    v_mfma_f32_32x32x16_bf16 v[128:143], a[0:3], v[64:67], v[128:143]
    ds_read_b64_tr_b16 a[16:17], v211 offset:0
    ds_read_b64_tr_b16 a[18:19], v211 offset:1024
    ds_read_b64_tr_b16 a[20:21], v214 offset:0
    ds_read_b64_tr_b16 a[22:23], v214 offset:1024
    s_mov_b32 s55, 688128
    s_add_u32 m0, s36, 32768
    s_nop 0
    buffer_load_dwordx4 v3, s[20:23], s55 offen lds
    s_add_u32 m0, s37, 32768
    s_nop 0
    buffer_load_dwordx4 v4, s[20:23], s55 offen lds
    s_waitcnt lgkmcnt(8)
    v_mfma_f32_32x32x16_bf16 v[144:159], a[4:7], v[64:67], v[144:159]
    s_waitcnt lgkmcnt(6)
    v_mfma_f32_32x32x16_bf16 v[128:143], a[8:11], v[68:71], v[128:143]
    ds_read_b64_tr_b16 a[0:1], v211 offset:28672
    ds_read_b64_tr_b16 a[2:3], v211 offset:29696
    ds_read_b64_tr_b16 a[4:5], v214 offset:28672
    ds_read_b64_tr_b16 a[6:7], v214 offset:29696
    s_waitcnt lgkmcnt(8)
    v_mfma_f32_32x32x16_bf16 v[144:159], a[12:15], v[68:71], v[144:159]
    s_waitcnt lgkmcnt(6)
    v_mfma_f32_32x32x16_bf16 v[128:143], a[16:19], v[72:75], v[128:143]
    ds_read_b64_tr_b16 a[8:9], v210 offset:4096
    ds_read_b64_tr_b16 a[10:11], v210 offset:5120
    ds_read_b64_tr_b16 a[12:13], v213 offset:4096
    ds_read_b64_tr_b16 a[14:15], v213 offset:5120
    s_waitcnt lgkmcnt(8)
    v_mfma_f32_32x32x16_bf16 v[144:159], a[20:23], v[72:75], v[144:159]
    s_waitcnt lgkmcnt(6)
    v_mfma_f32_32x32x16_bf16 v[128:143], a[0:3], v[76:79], v[128:143]
    ds_read_b64_tr_b16 a[16:17], v210 offset:32768
    ds_read_b64_tr_b16 a[18:19], v210 offset:33792
    ds_read_b64_tr_b16 a[20:21], v213 offset:32768
    ds_read_b64_tr_b16 a[22:23], v213 offset:33792
    s_waitcnt lgkmcnt(8)
    v_mfma_f32_32x32x16_bf16 v[144:159], a[4:7], v[76:79], v[144:159]
    s_waitcnt lgkmcnt(6)
    v_mfma_f32_32x32x16_bf16 v[128:143], a[8:11], v[80:83], v[128:143]
    ds_read_b64_tr_b16 a[0:1], v211 offset:4096
    ds_read_b64_tr_b16 a[2:3], v211 offset:5120
    ds_read_b64_tr_b16 a[4:5], v214 offset:4096
    ds_read_b64_tr_b16 a[6:7], v214 offset:5120
    s_waitcnt lgkmcnt(8)
    v_mfma_f32_32x32x16_bf16 v[144:159], a[12:15], v[80:83], v[144:159]
    s_waitcnt lgkmcnt(6)
    v_mfma_f32_32x32x16_bf16 v[128:143], a[16:19], v[84:87], v[128:143]
    ds_read_b64_tr_b16 a[8:9], v211 offset:32768
    ds_read_b64_tr_b16 a[10:11], v211 offset:33792
    ds_read_b64_tr_b16 a[12:13], v214 offset:32768
    ds_read_b64_tr_b16 a[14:15], v214 offset:33792
    s_waitcnt lgkmcnt(8)
    v_mfma_f32_32x32x16_bf16 v[144:159], a[20:23], v[84:87], v[144:159]
    s_waitcnt lgkmcnt(0)
    s_waitcnt vmcnt(10)
    s_waitcnt vmcnt(8)
    s_barrier
    v_mfma_f32_32x32x16_bf16 v[128:143], a[0:3], v[88:91], v[128:143]
    ds_read_b64_tr_b16 a[16:17], v210 offset:8192
    ds_read_b64_tr_b16 a[18:19], v210 offset:9216
    ds_read_b64_tr_b16 a[20:21], v213 offset:8192
    ds_read_b64_tr_b16 a[22:23], v213 offset:9216
    v_mfma_f32_32x32x16_bf16 v[144:159], a[4:7], v[88:91], v[144:159]
    v_mfma_f32_32x32x16_bf16 v[128:143], a[8:11], v[92:95], v[128:143]
    ds_read_b64_tr_b16 a[0:1], v210 offset:36864
    ds_read_b64_tr_b16 a[2:3], v210 offset:37888
    ds_read_b64_tr_b16 a[4:5], v213 offset:36864
    ds_read_b64_tr_b16 a[6:7], v213 offset:37888
    v_mfma_f32_32x32x16_bf16 v[144:159], a[12:15], v[92:95], v[144:159]
    s_waitcnt lgkmcnt(6)
    v_mfma_f32_32x32x16_bf16 v[128:143], a[16:19], v[96:99], v[128:143]
    ds_read_b64_tr_b16 a[8:9], v211 offset:8192
    ds_read_b64_tr_b16 a[10:11], v211 offset:9216
    ds_read_b64_tr_b16 a[12:13], v214 offset:8192
    ds_read_b64_tr_b16 a[14:15], v214 offset:9216
    s_waitcnt lgkmcnt(8)
    v_mfma_f32_32x32x16_bf16 v[144:159], a[20:23], v[96:99], v[144:159]
    s_waitcnt lgkmcnt(6)
    v_mfma_f32_32x32x16_bf16 v[128:143], a[0:3], v[100:103], v[128:143]
    ds_read_b64_tr_b16 a[16:17], v211 offset:36864
    ds_read_b64_tr_b16 a[18:19], v211 offset:37888
    ds_read_b64_tr_b16 a[20:21], v214 offset:36864
    ds_read_b64_tr_b16 a[22:23], v214 offset:37888
    s_waitcnt lgkmcnt(8)
    v_mfma_f32_32x32x16_bf16 v[144:159], a[4:7], v[100:103], v[144:159]
    v_add_f32 v198, v198, v199
    v_add_f32 v199, v200, v201
    v_mov_b32 v200, v198
    v_mov_b32 v201, v199
    s_nop 0
    v_permlane32_swap_b32 v198, v200
    v_permlane32_swap_b32 v199, v201
    v_and_b32 v206, 31, v0
    v_lshlrev_b32 v206, 3, v206
    v_add_u32 v206, s53, v206
    v_add_f32 v198, v198, v200
    v_add_f32 v199, v199, v201
    ds_write_b64 v206, v[198:199] offset:24576
    s_cmp_lg_u32 s3, 0
    s_cbranch_scc1 L_k1_nn2
    v_cmp_eq_u32 vcc, 0, v202
    v_mov_b32 v203, s10
    s_nop 0
    v_cndmask_b32 v202, v202, v203, vcc
    v_mov_b32 v203, 112640
    s_mov_b64 exec, 1
    ds_write_b32 v203, v202
    s_mov_b64 exec, -1
L_k1_nn2:
    s_waitcnt lgkmcnt(0)
    s_waitcnt vmcnt(4)
    s_waitcnt vmcnt(2)
    s_waitcnt vmcnt(0)
    s_barrier
    ds_read_b64 v[200:201], v206 offset:24832
    v_mov_b32 v207, 112640
    ds_read_b32 v203, v207
    v_mfma_f32_32x32x16_bf16 v[128:143], a[8:11], v[104:107], v[128:143]
    ds_read_b64_tr_b16 a[0:1], v210 offset:12288
    ds_read_b64_tr_b16 a[2:3], v210 offset:13312
    ds_read_b64_tr_b16 a[4:5], v213 offset:12288
    ds_read_b64_tr_b16 a[6:7], v213 offset:13312
    s_mov_b32 s55, 860160
    s_add_u32 m0, s38, 0
    s_nop 0
    buffer_load_dwordx4 v3, s[20:23], s55 offen lds
    s_add_u32 m0, s39, 0
    s_nop 0
    buffer_load_dwordx4 v4, s[20:23], s55 offen lds
    v_mfma_f32_32x32x16_bf16 v[144:159], a[12:15], v[104:107], v[144:159]
    v_mfma_f32_32x32x16_bf16 v[128:143], a[16:19], v[108:111], v[128:143]
    ds_read_b64_tr_b16 a[8:9], v210 offset:40960
    ds_read_b64_tr_b16 a[10:11], v210 offset:41984
    ds_read_b64_tr_b16 a[12:13], v213 offset:40960
    ds_read_b64_tr_b16 a[14:15], v213 offset:41984
    s_mov_b32 s55, 1032192
    s_add_u32 m0, s38, 4096
    s_nop 0
    buffer_load_dwordx4 v3, s[20:23], s55 offen lds
    s_add_u32 m0, s39, 4096
    s_nop 0
    buffer_load_dwordx4 v4, s[20:23], s55 offen lds
    v_mfma_f32_32x32x16_bf16 v[144:159], a[20:23], v[108:111], v[144:159]
    s_waitcnt lgkmcnt(9)
    v_add_f32 v198, v198, v200
    v_add_f32 v199, v199, v201
    v_mul_f32 v198, 0x3b124925, v198
    v_mul_f32 v199, 0x3b124925, v199
    v_fma_f32 v199, -v198, v198, v199
    v_max_f32 v199, 0, v199
    v_add_f32 v199, 0x3727c5ac, v199
    v_rsq_f32 v12, v199
    v_sub_f32 v13, 0, v198
    v_mul_f32 v208, 0x3eeff558, v12
    v_mov_b32 v198, v12
    v_mul_f32 v199, v13, v12
    ds_write_b64 v206, v[198:199] offset:25088
    s_waitcnt lgkmcnt(7)
    v_mfma_f32_32x32x16_bf16 v[128:143], a[0:3], v[112:115], v[128:143]
    ds_read_b64_tr_b16 a[16:17], v211 offset:12288
    ds_read_b64_tr_b16 a[18:19], v211 offset:13312
    ds_read_b64_tr_b16 a[20:21], v214 offset:12288
    ds_read_b64_tr_b16 a[22:23], v214 offset:13312
    s_waitcnt lgkmcnt(9)
    v_mfma_f32_32x32x16_bf16 v[144:159], a[4:7], v[112:115], v[144:159]
    s_waitcnt lgkmcnt(7)
    v_mfma_f32_32x32x16_bf16 v[128:143], a[8:11], v[116:119], v[128:143]
    ds_read_b64_tr_b16 a[0:1], v211 offset:40960
    ds_read_b64_tr_b16 a[2:3], v211 offset:41984
    ds_read_b64_tr_b16 a[4:5], v214 offset:40960
    ds_read_b64_tr_b16 a[6:7], v214 offset:41984
    s_waitcnt lgkmcnt(9)
    v_mfma_f32_32x32x16_bf16 v[144:159], a[12:15], v[116:119], v[144:159]
    s_lshl_b32 s40, s49, 2
    s_add_u32 s40, s40, 42
    s_and_b32 s41, s40, 0xfffc
    s_add_u32 s41, s41, 128
    s_mul_i32 s40, s40, 192
    s_add_u32 s40, s40, 22020096
    s_mov_b32 s61, 0
L_k1_cs0_0:
    v_mov_b32 v207, s41
    buffer_load_dword v204, v207, s[44:47], 0 offen sc0 sc1
    buffer_load_dwordx4 v[216:219], v193, s[28:31], s40 offen offset:0 sc0 sc1
    buffer_load_dwordx4 v[220:223], v193, s[28:31], s40 offen offset:16 sc0 sc1
    buffer_load_dwordx4 v[224:227], v193, s[28:31], s40 offen offset:32 sc0 sc1
    buffer_load_dwordx4 v[228:231], v193, s[28:31], s40 offen offset:48 sc0 sc1
    buffer_load_dwordx4 v[198:201], v193, s[28:31], s40 offen offset:64 sc0 sc1
    buffer_load_dwordx4 v[8:11], v193, s[28:31], s40 offen offset:80 sc0 sc1
    s_waitcnt lgkmcnt(6)
    v_mfma_f32_32x32x16_bf16 v[128:143], a[16:19], v[120:123], v[128:143]
    ds_read_b64_tr_b16 a[8:9], v5 offset:16384
    ds_read_b64_tr_b16 a[10:11], v5 offset:17152
    s_waitcnt lgkmcnt(6)
    v_mfma_f32_32x32x16_bf16 v[144:159], a[20:23], v[120:123], v[144:159]
    s_waitcnt lgkmcnt(4)
    v_mfma_f32_32x32x16_bf16 v[128:143], a[0:3], v[124:127], v[128:143]
    ds_read_b64_tr_b16 a[16:17], v5 offset:45056
    ds_read_b64_tr_b16 a[18:19], v5 offset:45824
    s_waitcnt lgkmcnt(4)
    v_mfma_f32_32x32x16_bf16 v[144:159], a[4:7], v[124:127], v[144:159]
    s_waitcnt lgkmcnt(2)
    v_mfma_f32_32x32x16_bf16 v[160:175], a[8:11], v[16:19], 0
    ds_read_b64_tr_b16 a[0:1], v6 offset:16384
    ds_read_b64_tr_b16 a[2:3], v6 offset:17152
L_k1_cs0_0_chk:
    s_waitcnt vmcnt(5)
    v_xor_b32 v207, v219, v204
    s_waitcnt vmcnt(4)
    v_xor_b32 v205, v223, v204
    v_or_b32 v207, v207, v205
    s_waitcnt vmcnt(3)
    v_xor_b32 v205, v227, v204
    v_or_b32 v207, v207, v205
    s_waitcnt vmcnt(2)
    v_xor_b32 v205, v231, v204
    v_or_b32 v207, v207, v205
    s_waitcnt vmcnt(1)
    v_xor_b32 v205, v201, v204
    v_or_b32 v207, v207, v205
    s_waitcnt vmcnt(0)
    v_xor_b32 v205, v11, v204
    v_or_b32 v207, v207, v205
    v_cmp_ne_u32 vcc, 0, v207
    v_cmp_eq_u32 s[62:63], 0, v204
    s_nop 0
    s_or_b64 vcc, vcc, s[62:63]
    s_add_u32 s61, s61, 1
    s_cmp_eq_u64 vcc, 0
    s_cbranch_scc1 L_k1_cs0_0_ok
    s_sleep 4
    v_mov_b32 v207, s41
    buffer_load_dword v204, v207, s[44:47], 0 offen sc0 sc1
    buffer_load_dwordx4 v[216:219], v193, s[28:31], s40 offen offset:0 sc0 sc1
    buffer_load_dwordx4 v[220:223], v193, s[28:31], s40 offen offset:16 sc0 sc1
    buffer_load_dwordx4 v[224:227], v193, s[28:31], s40 offen offset:32 sc0 sc1
    buffer_load_dwordx4 v[228:231], v193, s[28:31], s40 offen offset:48 sc0 sc1
    buffer_load_dwordx4 v[198:201], v193, s[28:31], s40 offen offset:64 sc0 sc1
    buffer_load_dwordx4 v[8:11], v193, s[28:31], s40 offen offset:80 sc0 sc1
    s_cmp_lt_u32 s61, 0x40000
    s_cbranch_scc1 L_k1_cs0_0_chk
L_k1_cs0_0_ok:
    v_fma_f32 v128, v13, v216, v128
    v_fma_f32 v129, v13, v217, v129
    v_fma_f32 v130, v13, v218, v130
    v_fma_f32 v131, v13, v220, v131
    v_fma_f32 v132, v13, v221, v132
    v_fma_f32 v133, v13, v222, v133
    v_fma_f32 v134, v13, v224, v134
    v_fma_f32 v135, v13, v225, v135
    v_fma_f32 v136, v13, v226, v136
    v_fma_f32 v137, v13, v228, v137
    v_fma_f32 v138, v13, v229, v138
    v_fma_f32 v139, v13, v230, v139
    v_fma_f32 v140, v13, v198, v140
    v_fma_f32 v141, v13, v199, v141
    v_fma_f32 v142, v13, v200, v142
    v_fma_f32 v143, v13, v8, v143
    v_mul_f32 v128, v128, v208
    s_waitcnt lgkmcnt(2)
    v_mfma_f32_32x32x16_bf16 v[160:175], a[16:19], v[20:23], v[160:175]
    ds_read_b64_tr_b16 a[8:9], v6 offset:45056
    ds_read_b64_tr_b16 a[10:11], v6 offset:45824
    v_mul_f32 v129, v129, v208
    v_mul_f32 v130, v130, v208
    v_mul_f32 v131, v131, v208
    v_mul_f32 v132, v132, v208
    v_mul_f32 v133, v133, v208
    v_mul_f32 v134, v134, v208
    v_mul_f32 v135, v135, v208
    v_mul_f32 v136, v136, v208
    v_mul_f32 v137, v137, v208
    v_mul_f32 v138, v138, v208
    v_mul_f32 v139, v139, v208
    v_mul_f32 v140, v140, v208
    v_mul_f32 v141, v141, v208
    v_mul_f32 v142, v142, v208
    v_mul_f32 v143, v143, v208
    s_add_u32 s40, s40, 192
    s_mov_b32 s61, 0
L_k1_cs0_1:
    v_mov_b32 v207, s41
    buffer_load_dword v204, v207, s[44:47], 0 offen sc0 sc1
    buffer_load_dwordx4 v[216:219], v193, s[28:31], s40 offen offset:0 sc0 sc1
    buffer_load_dwordx4 v[220:223], v193, s[28:31], s40 offen offset:16 sc0 sc1
    buffer_load_dwordx4 v[224:227], v193, s[28:31], s40 offen offset:32 sc0 sc1
    buffer_load_dwordx4 v[228:231], v193, s[28:31], s40 offen offset:48 sc0 sc1
    buffer_load_dwordx4 v[198:201], v193, s[28:31], s40 offen offset:64 sc0 sc1
    buffer_load_dwordx4 v[8:11], v193, s[28:31], s40 offen offset:80 sc0 sc1
    v_fma_f32 v194, v128, v128, v14
    v_fma_f32 v195, v129, v129, v14
    s_waitcnt lgkmcnt(2)
    v_mfma_f32_32x32x16_bf16 v[160:175], a[0:3], v[24:27], v[160:175]
    ds_read_b64_tr_b16 a[16:17], v5 offset:20480
    ds_read_b64_tr_b16 a[18:19], v5 offset:21248
    v_mul_f32 v194, v194, v128
    v_mul_f32 v195, v195, v129
    v_exp_f32_e64 v194, -v194
    v_exp_f32_e64 v195, -v195
    v_add_f32 v194, 1.0, v194
    v_add_f32 v195, 1.0, v195
    v_rcp_f32 v194, v194
    v_rcp_f32 v195, v195
    v_mul_f32 v128, v128, v194
    v_mul_f32 v129, v129, v195
    v_add_f32 v15, v15, v128
    v_fmac_f32 v192, v128, v128
    v_add_f32 v15, v15, v129
    v_fmac_f32 v192, v129, v129
    v_fma_f32 v196, v130, v130, v14
    v_fma_f32 v197, v131, v131, v14
    v_mul_f32 v196, v196, v130
    v_mul_f32 v197, v197, v131
    s_waitcnt lgkmcnt(2)
    v_mfma_f32_32x32x16_bf16 v[160:175], a[8:11], v[28:31], v[160:175]
    ds_read_b64_tr_b16 a[0:1], v5 offset:49152
    ds_read_b64_tr_b16 a[2:3], v5 offset:49920
    v_exp_f32_e64 v196, -v196
    v_exp_f32_e64 v197, -v197
    v_add_f32 v196, 1.0, v196
    v_add_f32 v197, 1.0, v197
    v_rcp_f32 v196, v196
    v_rcp_f32 v197, v197
    v_mul_f32 v130, v130, v196
    v_mul_f32 v131, v131, v197
    v_add_f32 v15, v15, v130
    v_fmac_f32 v192, v130, v130
    v_add_f32 v15, v15, v131
    v_fmac_f32 v192, v131, v131
    v_fma_f32 v194, v132, v132, v14
    v_fma_f32 v195, v133, v133, v14
    v_mul_f32 v194, v194, v132
    v_mul_f32 v195, v195, v133
    v_exp_f32_e64 v194, -v194
    v_exp_f32_e64 v195, -v195
    s_waitcnt lgkmcnt(2)
    v_mfma_f32_32x32x16_bf16 v[160:175], a[16:19], v[32:35], v[160:175]
    ds_read_b64_tr_b16 a[8:9], v6 offset:20480
    ds_read_b64_tr_b16 a[10:11], v6 offset:21248
    v_add_f32 v194, 1.0, v194
    v_add_f32 v195, 1.0, v195
    v_rcp_f32 v194, v194
    v_rcp_f32 v195, v195
    v_mul_f32 v132, v132, v194
    v_mul_f32 v133, v133, v195
    v_add_f32 v15, v15, v132
    v_fmac_f32 v192, v132, v132
    v_add_f32 v15, v15, v133
    v_fmac_f32 v192, v133, v133
    v_fma_f32 v196, v134, v134, v14
    v_fma_f32 v197, v135, v135, v14
    v_mul_f32 v196, v196, v134
    v_mul_f32 v197, v197, v135
    v_exp_f32_e64 v196, -v196
    v_exp_f32_e64 v197, -v197
    v_add_f32 v196, 1.0, v196
    v_add_f32 v197, 1.0, v197
    s_waitcnt lgkmcnt(2)
    v_mfma_f32_32x32x16_bf16 v[160:175], a[0:3], v[36:39], v[160:175]
    ds_read_b64_tr_b16 a[16:17], v6 offset:49152
    ds_read_b64_tr_b16 a[18:19], v6 offset:49920
    v_rcp_f32 v196, v196
    v_rcp_f32 v197, v197
    v_mul_f32 v134, v134, v196
    v_mul_f32 v135, v135, v197
    v_add_f32 v15, v15, v134
    v_fmac_f32 v192, v134, v134
    v_add_f32 v15, v15, v135
    v_fmac_f32 v192, v135, v135
    v_fma_f32 v194, v136, v136, v14
    v_fma_f32 v195, v137, v137, v14
    v_mul_f32 v194, v194, v136
    v_mul_f32 v195, v195, v137
    v_exp_f32_e64 v194, -v194
    v_exp_f32_e64 v195, -v195
    v_add_f32 v194, 1.0, v194
    v_add_f32 v195, 1.0, v195
    v_rcp_f32 v194, v194
    v_rcp_f32 v195, v195
    s_waitcnt lgkmcnt(2)
    v_mfma_f32_32x32x16_bf16 v[160:175], a[8:11], v[40:43], v[160:175]
    ds_read_b64_tr_b16 a[0:1], v7 offset:0
    ds_read_b64_tr_b16 a[2:3], v7 offset:768
    v_mul_f32 v136, v136, v194
    v_mul_f32 v137, v137, v195
    v_add_f32 v15, v15, v136
    v_fmac_f32 v192, v136, v136
    v_add_f32 v15, v15, v137
    v_fmac_f32 v192, v137, v137
    v_fma_f32 v196, v138, v138, v14
    v_fma_f32 v197, v139, v139, v14
    v_mul_f32 v196, v196, v138
    v_mul_f32 v197, v197, v139
    v_exp_f32_e64 v196, -v196
    v_exp_f32_e64 v197, -v197
    v_add_f32 v196, 1.0, v196
    v_add_f32 v197, 1.0, v197
    v_rcp_f32 v196, v196
    v_rcp_f32 v197, v197
    v_mul_f32 v138, v138, v196
    v_mul_f32 v139, v139, v197
    s_waitcnt lgkmcnt(2)
    v_mfma_f32_32x32x16_bf16 v[160:175], a[16:19], v[44:47], v[160:175]
    ds_read_b64_tr_b16 a[8:9], v7 offset:4096
    ds_read_b64_tr_b16 a[10:11], v7 offset:4864
    v_add_f32 v15, v15, v138
    v_fmac_f32 v192, v138, v138
    v_add_f32 v15, v15, v139
    v_fmac_f32 v192, v139, v139
    v_fma_f32 v194, v140, v140, v14
    v_fma_f32 v195, v141, v141, v14
    v_mul_f32 v194, v194, v140
    v_mul_f32 v195, v195, v141
    v_exp_f32_e64 v194, -v194
    v_exp_f32_e64 v195, -v195
    v_add_f32 v194, 1.0, v194
    v_add_f32 v195, 1.0, v195
    v_rcp_f32 v194, v194
    v_rcp_f32 v195, v195
    v_mul_f32 v140, v140, v194
    v_mul_f32 v141, v141, v195
    v_add_f32 v15, v15, v140
    v_fmac_f32 v192, v140, v140
    s_waitcnt lgkmcnt(2)
    v_mfma_f32_32x32x16_bf16 v[160:175], a[0:3], v[48:51], v[160:175]
    ds_read_b64_tr_b16 a[16:17], v7 offset:8192
    ds_read_b64_tr_b16 a[18:19], v7 offset:8960
    v_add_f32 v15, v15, v141
    v_fmac_f32 v192, v141, v141
    v_fma_f32 v196, v142, v142, v14
    v_fma_f32 v197, v143, v143, v14
    v_mul_f32 v196, v196, v142
    v_mul_f32 v197, v197, v143
    v_exp_f32_e64 v196, -v196
    v_exp_f32_e64 v197, -v197
    v_add_f32 v196, 1.0, v196
    v_add_f32 v197, 1.0, v197
    v_rcp_f32 v196, v196
    v_rcp_f32 v197, v197
    v_mul_f32 v142, v142, v196
    v_mul_f32 v143, v143, v197
    v_add_f32 v15, v15, v142
    v_fmac_f32 v192, v142, v142
    v_add_f32 v15, v15, v143
    v_fmac_f32 v192, v143, v143
    s_waitcnt lgkmcnt(2)
    v_mfma_f32_32x32x16_bf16 v[160:175], a[8:11], v[52:55], v[160:175]
    ds_read_b64_tr_b16 a[0:1], v7 offset:12288
    ds_read_b64_tr_b16 a[2:3], v7 offset:13056
L_k1_cs0_1_chk:
    s_waitcnt vmcnt(5)
    v_xor_b32 v207, v219, v204
    s_waitcnt vmcnt(4)
    v_xor_b32 v205, v223, v204
    v_or_b32 v207, v207, v205
    s_waitcnt vmcnt(3)
    v_xor_b32 v205, v227, v204
    v_or_b32 v207, v207, v205
    s_waitcnt vmcnt(2)
    v_xor_b32 v205, v231, v204
    v_or_b32 v207, v207, v205
    s_waitcnt vmcnt(1)
    v_xor_b32 v205, v201, v204
    v_or_b32 v207, v207, v205
    s_waitcnt vmcnt(0)
    v_xor_b32 v205, v11, v204
    v_or_b32 v207, v207, v205
    v_cmp_ne_u32 vcc, 0, v207
    v_cmp_eq_u32 s[62:63], 0, v204
    s_nop 0
    s_or_b64 vcc, vcc, s[62:63]
    s_add_u32 s61, s61, 1
    s_cmp_eq_u64 vcc, 0
    s_cbranch_scc1 L_k1_cs0_1_ok
    s_sleep 4
    v_mov_b32 v207, s41
    buffer_load_dword v204, v207, s[44:47], 0 offen sc0 sc1
    buffer_load_dwordx4 v[216:219], v193, s[28:31], s40 offen offset:0 sc0 sc1
    buffer_load_dwordx4 v[220:223], v193, s[28:31], s40 offen offset:16 sc0 sc1
    buffer_load_dwordx4 v[224:227], v193, s[28:31], s40 offen offset:32 sc0 sc1
    buffer_load_dwordx4 v[228:231], v193, s[28:31], s40 offen offset:48 sc0 sc1
    buffer_load_dwordx4 v[198:201], v193, s[28:31], s40 offen offset:64 sc0 sc1
    buffer_load_dwordx4 v[8:11], v193, s[28:31], s40 offen offset:80 sc0 sc1
    s_cmp_lt_u32 s61, 0x40000
    s_cbranch_scc1 L_k1_cs0_1_chk
L_k1_cs0_1_ok:
    v_fma_f32 v144, v13, v216, v144
    v_fma_f32 v145, v13, v217, v145
    v_fma_f32 v146, v13, v218, v146
    v_fma_f32 v147, v13, v220, v147
    v_fma_f32 v148, v13, v221, v148
    v_fma_f32 v149, v13, v222, v149
    v_fma_f32 v150, v13, v224, v150
    v_fma_f32 v151, v13, v225, v151
    v_fma_f32 v152, v13, v226, v152
    v_fma_f32 v153, v13, v228, v153
    v_fma_f32 v154, v13, v229, v154
    v_fma_f32 v155, v13, v230, v155
    v_fma_f32 v156, v13, v198, v156
    v_fma_f32 v157, v13, v199, v157
    v_fma_f32 v158, v13, v200, v158
    v_fma_f32 v159, v13, v8, v159
    v_mul_f32 v144, v144, v208
    s_waitcnt lgkmcnt(2)
    v_mfma_f32_32x32x16_bf16 v[160:175], a[16:19], v[56:59], v[160:175]
    ds_read_b64_tr_b16 a[8:9], v7 offset:16384
    ds_read_b64_tr_b16 a[10:11], v7 offset:17152
    v_mul_f32 v145, v145, v208
    v_mul_f32 v146, v146, v208
    v_mul_f32 v147, v147, v208
    v_mul_f32 v148, v148, v208
    v_mul_f32 v149, v149, v208
    v_mul_f32 v150, v150, v208
    v_mul_f32 v151, v151, v208
    v_mul_f32 v152, v152, v208
    v_mul_f32 v153, v153, v208
    v_mul_f32 v154, v154, v208
    v_mul_f32 v155, v155, v208
    v_mul_f32 v156, v156, v208
    v_mul_f32 v157, v157, v208
    v_mul_f32 v158, v158, v208
    v_mul_f32 v159, v159, v208
    s_lshl_b32 s40, s49, 1
    s_add_u32 s40, s40, 0
    s_and_b32 s41, s40, 0xfffc
    s_add_u32 s41, s41, 128
    s_mul_i32 s40, s40, 192
    s_add_u32 s40, s40, 22020096
    s_mov_b32 s61, 0
L_k1_cs0_2:
    v_mov_b32 v207, s41
    buffer_load_dword v204, v207, s[44:47], 0 offen sc0 sc1
    buffer_load_dwordx4 v[216:219], v193, s[28:31], s40 offen offset:0 sc0 sc1
    buffer_load_dwordx4 v[220:223], v193, s[28:31], s40 offen offset:16 sc0 sc1
    buffer_load_dwordx4 v[224:227], v193, s[28:31], s40 offen offset:32 sc0 sc1
    buffer_load_dwordx4 v[228:231], v193, s[28:31], s40 offen offset:48 sc0 sc1
    buffer_load_dwordx4 v[198:201], v193, s[28:31], s40 offen offset:64 sc0 sc1
    buffer_load_dwordx4 v[8:11], v193, s[28:31], s40 offen offset:80 sc0 sc1
    v_fma_f32 v194, v144, v144, v14
    v_fma_f32 v195, v145, v145, v14
    s_waitcnt lgkmcnt(2)
    v_mfma_f32_32x32x16_bf16 v[160:175], a[0:3], v[60:63], v[160:175]
    ds_read_b64_tr_b16 a[16:17], v7 offset:20480
    ds_read_b64_tr_b16 a[18:19], v7 offset:21248
    v_mul_f32 v194, v194, v144
    v_mul_f32 v195, v195, v145
    v_exp_f32_e64 v194, -v194
    v_exp_f32_e64 v195, -v195
    v_add_f32 v194, 1.0, v194
    v_add_f32 v195, 1.0, v195
    v_rcp_f32 v194, v194
    v_rcp_f32 v195, v195
    v_mul_f32 v144, v144, v194
    v_mul_f32 v145, v145, v195
    v_add_f32 v15, v15, v144
    v_fmac_f32 v192, v144, v144
    v_add_f32 v15, v15, v145
    v_fmac_f32 v192, v145, v145
    v_fma_f32 v196, v146, v146, v14
    v_fma_f32 v197, v147, v147, v14
    v_mul_f32 v196, v196, v146
    v_mul_f32 v197, v197, v147
    s_waitcnt lgkmcnt(2)
    v_mfma_f32_32x32x16_bf16 v[160:175], a[8:11], v[64:67], v[160:175]
    ds_read_b64_tr_b16 a[0:1], v7 offset:24576
    ds_read_b64_tr_b16 a[2:3], v7 offset:25344
    v_exp_f32_e64 v196, -v196
    v_exp_f32_e64 v197, -v197
    v_add_f32 v196, 1.0, v196
    v_add_f32 v197, 1.0, v197
    v_rcp_f32 v196, v196
    v_rcp_f32 v197, v197
    v_mul_f32 v146, v146, v196
    v_mul_f32 v147, v147, v197
    v_add_f32 v15, v15, v146
    v_fmac_f32 v192, v146, v146
    v_add_f32 v15, v15, v147
    v_fmac_f32 v192, v147, v147
    v_fma_f32 v194, v148, v148, v14
    v_fma_f32 v195, v149, v149, v14
    v_mul_f32 v194, v194, v148
    v_mul_f32 v195, v195, v149
    v_exp_f32_e64 v194, -v194
    v_exp_f32_e64 v195, -v195
    s_waitcnt lgkmcnt(2)
    v_mfma_f32_32x32x16_bf16 v[160:175], a[16:19], v[68:71], v[160:175]
    ds_read_b64_tr_b16 a[8:9], v7 offset:28672
    ds_read_b64_tr_b16 a[10:11], v7 offset:29440
    v_add_f32 v194, 1.0, v194
    v_add_f32 v195, 1.0, v195
    v_rcp_f32 v194, v194
    v_rcp_f32 v195, v195
    v_mul_f32 v148, v148, v194
    v_mul_f32 v149, v149, v195
    v_add_f32 v15, v15, v148
    v_fmac_f32 v192, v148, v148
    v_add_f32 v15, v15, v149
    v_fmac_f32 v192, v149, v149
    v_fma_f32 v196, v150, v150, v14
    v_fma_f32 v197, v151, v151, v14
    v_mul_f32 v196, v196, v150
    v_mul_f32 v197, v197, v151
    v_exp_f32_e64 v196, -v196
    v_exp_f32_e64 v197, -v197
    v_add_f32 v196, 1.0, v196
    v_add_f32 v197, 1.0, v197
    s_waitcnt lgkmcnt(0)
    s_barrier
    v_mfma_f32_32x32x16_bf16 v[160:175], a[0:3], v[72:75], v[160:175]
    ds_read_b64_tr_b16 a[16:17], v7 offset:32768
    ds_read_b64_tr_b16 a[18:19], v7 offset:33536
    v_rcp_f32 v196, v196
    v_rcp_f32 v197, v197
    v_mul_f32 v150, v150, v196
    v_mul_f32 v151, v151, v197
    v_add_f32 v15, v15, v150
    v_fmac_f32 v192, v150, v150
    v_add_f32 v15, v15, v151
    v_fmac_f32 v192, v151, v151
    v_fma_f32 v194, v152, v152, v14
    v_fma_f32 v195, v153, v153, v14
    v_mul_f32 v194, v194, v152
    v_mul_f32 v195, v195, v153
    v_exp_f32_e64 v194, -v194
    v_exp_f32_e64 v195, -v195
    v_add_f32 v194, 1.0, v194
    v_add_f32 v195, 1.0, v195
    v_rcp_f32 v194, v194
    v_rcp_f32 v195, v195
    v_mfma_f32_32x32x16_bf16 v[160:175], a[8:11], v[76:79], v[160:175]
    ds_read_b64_tr_b16 a[0:1], v7 offset:36864
    ds_read_b64_tr_b16 a[2:3], v7 offset:37632
    v_mul_f32 v152, v152, v194
    v_mul_f32 v153, v153, v195
    v_add_f32 v15, v15, v152
    v_fmac_f32 v192, v152, v152
    v_add_f32 v15, v15, v153
    v_fmac_f32 v192, v153, v153
    v_fma_f32 v196, v154, v154, v14
    v_fma_f32 v197, v155, v155, v14
    v_mul_f32 v196, v196, v154
    v_mul_f32 v197, v197, v155
    v_exp_f32_e64 v196, -v196
    v_exp_f32_e64 v197, -v197
    v_add_f32 v196, 1.0, v196
    v_add_f32 v197, 1.0, v197
    v_rcp_f32 v196, v196
    v_rcp_f32 v197, v197
    v_mul_f32 v154, v154, v196
    v_mul_f32 v155, v155, v197
    s_waitcnt lgkmcnt(2)
    v_mfma_f32_32x32x16_bf16 v[160:175], a[16:19], v[80:83], v[160:175]
    ds_read_b64_tr_b16 a[8:9], v7 offset:40960
    ds_read_b64_tr_b16 a[10:11], v7 offset:41728
    v_add_f32 v15, v15, v154
    v_fmac_f32 v192, v154, v154
    v_add_f32 v15, v15, v155
    v_fmac_f32 v192, v155, v155
    v_fma_f32 v194, v156, v156, v14
    v_fma_f32 v195, v157, v157, v14
    v_mul_f32 v194, v194, v156
    v_mul_f32 v195, v195, v157
    v_exp_f32_e64 v194, -v194
    v_exp_f32_e64 v195, -v195
    v_add_f32 v194, 1.0, v194
    v_add_f32 v195, 1.0, v195
    v_rcp_f32 v194, v194
    v_rcp_f32 v195, v195
    v_mul_f32 v156, v156, v194
    v_mul_f32 v157, v157, v195
    v_add_f32 v15, v15, v156
    v_fmac_f32 v192, v156, v156
    s_waitcnt lgkmcnt(2)
    v_mfma_f32_32x32x16_bf16 v[160:175], a[0:3], v[84:87], v[160:175]
    ds_read_b64_tr_b16 a[16:17], v7 offset:45056
    ds_read_b64_tr_b16 a[18:19], v7 offset:45824
    v_add_f32 v15, v15, v157
    v_fmac_f32 v192, v157, v157
    v_fma_f32 v196, v158, v158, v14
    v_fma_f32 v197, v159, v159, v14
    v_mul_f32 v196, v196, v158
    v_mul_f32 v197, v197, v159
    v_exp_f32_e64 v196, -v196
    v_exp_f32_e64 v197, -v197
    v_add_f32 v196, 1.0, v196
    v_add_f32 v197, 1.0, v197
    v_rcp_f32 v196, v196
    v_rcp_f32 v197, v197
    v_mul_f32 v158, v158, v196
    v_mul_f32 v159, v159, v197
    v_add_f32 v15, v15, v158
    v_fmac_f32 v192, v158, v158
    v_add_f32 v15, v15, v159
    v_fmac_f32 v192, v159, v159
    s_waitcnt lgkmcnt(2)
    v_mfma_f32_32x32x16_bf16 v[160:175], a[8:11], v[88:91], v[160:175]
    ds_read_b64_tr_b16 a[0:1], v5 offset:0
    ds_read_b64_tr_b16 a[2:3], v5 offset:768
    s_lshl_b32 s34, s49, 8
    s_add_u32 s34, s34, 22092800
    s_add_u32 s35, s49, 28
    s_and_b32 s35, s35, 0xfffc
    s_add_u32 s35, s35, 128
    v_and_b32 v213, 31, v0
    v_lshlrev_b32 v213, 3, v213
    v_mov_b32 v214, s35
    buffer_load_dwordx2 v[210:211], v213, s[28:31], s34 offen sc0 sc1
    buffer_load_dword v212, v214, s[44:47], 0 offen sc0 sc1
L_k1_cs0_2_chk:
    s_waitcnt vmcnt(5)
    v_xor_b32 v207, v219, v204
    s_waitcnt vmcnt(4)
    v_xor_b32 v205, v223, v204
    v_or_b32 v207, v207, v205
    s_waitcnt vmcnt(3)
    v_xor_b32 v205, v227, v204
    v_or_b32 v207, v207, v205
    s_waitcnt vmcnt(2)
    v_xor_b32 v205, v231, v204
    v_or_b32 v207, v207, v205
    s_waitcnt vmcnt(1)
    v_xor_b32 v205, v201, v204
    v_or_b32 v207, v207, v205
    s_waitcnt vmcnt(0)
    v_xor_b32 v205, v11, v204
    v_or_b32 v207, v207, v205
    v_cmp_ne_u32 vcc, 0, v207
    v_cmp_eq_u32 s[62:63], 0, v204
    s_nop 0
    s_or_b64 vcc, vcc, s[62:63]
    s_add_u32 s61, s61, 1
    s_cmp_eq_u64 vcc, 0
    s_cbranch_scc1 L_k1_cs0_2_ok
    s_sleep 4
    v_mov_b32 v207, s41
    buffer_load_dword v204, v207, s[44:47], 0 offen sc0 sc1
    buffer_load_dwordx4 v[216:219], v193, s[28:31], s40 offen offset:0 sc0 sc1
    buffer_load_dwordx4 v[220:223], v193, s[28:31], s40 offen offset:16 sc0 sc1
    buffer_load_dwordx4 v[224:227], v193, s[28:31], s40 offen offset:32 sc0 sc1
    buffer_load_dwordx4 v[228:231], v193, s[28:31], s40 offen offset:48 sc0 sc1
    buffer_load_dwordx4 v[198:201], v193, s[28:31], s40 offen offset:64 sc0 sc1
    buffer_load_dwordx4 v[8:11], v193, s[28:31], s40 offen offset:80 sc0 sc1
    s_cmp_lt_u32 s61, 0x40000
    s_cbranch_scc1 L_k1_cs0_2_chk
L_k1_cs0_2_ok:
    v_mov_b32 v194, v15
    v_mov_b32 v195, v192
    s_nop 0
    v_permlane32_swap_b32 v15, v194
    v_permlane32_swap_b32 v192, v195
    v_add_f32 v202, v15, v194
    v_add_f32 v204, v192, v195
    s_cmp_eq_u32 s51, 0
    s_cbranch_scc1 L_k1_nopub0
    s_mul_i32 s55, s48, 14
    s_lshl_b32 s59, s55, 11
    s_lshl_b32 s60, s66, 9
    s_add_u32 s59, s59, s60
    s_add_u32 s59, s59, 20971520
    s_lshl_b32 s60, s50, 12
    s_add_u32 s60, s60, s59
    v_and_b32 v196, 31, v0
    v_lshlrev_b32 v196, 4, v196
    v_mov_b32 v205, v203
    s_mov_b32 exec_hi, 0
    buffer_store_dwordx4 v[202:205], v196, s[28:31], s60 offen offset:0 sc0 sc1
    s_mov_b64 exec, -1
    s_branch L_k1_pubd0
L_k1_nopub0:
    s_mul_i32 s55, s52, 56
    s_lshl_b32 s60, s50, 3
    s_add_u32 s55, s55, s60
    s_lshl_b32 s55, s55, 10
    s_add_u32 s55, s55, 6291456
    v_cvt_pk_bf16_f32 v128, v128, v129
    v_cvt_pk_bf16_f32 v129, v130, v131
    v_cvt_pk_bf16_f32 v130, v132, v133
    v_cvt_pk_bf16_f32 v131, v134, v135
    v_cvt_pk_bf16_f32 v132, v136, v137
    v_cvt_pk_bf16_f32 v133, v138, v139
    v_cvt_pk_bf16_f32 v134, v140, v141
    v_cvt_pk_bf16_f32 v135, v142, v143
    buffer_store_dwordx4 v[128:131], v1, s[28:31], s55 offen offset:0
    buffer_store_dwordx4 v[132:135], v1, s[28:31], s55 offen offset:1024
    v_cvt_pk_bf16_f32 v144, v144, v145
    v_cvt_pk_bf16_f32 v145, v146, v147
    v_cvt_pk_bf16_f32 v146, v148, v149
    v_cvt_pk_bf16_f32 v147, v150, v151
    v_cvt_pk_bf16_f32 v148, v152, v153
    v_cvt_pk_bf16_f32 v149, v154, v155
    v_cvt_pk_bf16_f32 v150, v156, v157
    v_cvt_pk_bf16_f32 v151, v158, v159
    buffer_store_dwordx4 v[144:147], v1, s[28:31], s55 offen offset:2048
    buffer_store_dwordx4 v[148:151], v1, s[28:31], s55 offen offset:3072
L_k1_pubd0:
    s_waitcnt lgkmcnt(2)
    v_mfma_f32_32x32x16_bf16 v[160:175], a[16:19], v[92:95], v[160:175]
    ds_read_b64_tr_b16 a[8:9], v5 offset:28672
    ds_read_b64_tr_b16 a[10:11], v5 offset:29440
    s_waitcnt lgkmcnt(2)
    v_mfma_f32_32x32x16_bf16 v[160:175], a[0:3], v[96:99], v[160:175]
    ds_read_b64_tr_b16 a[16:17], v6 offset:0
    ds_read_b64_tr_b16 a[18:19], v6 offset:768
    s_waitcnt lgkmcnt(2)
    v_mfma_f32_32x32x16_bf16 v[160:175], a[8:11], v[100:103], v[160:175]
    ds_read_b64_tr_b16 a[0:1], v6 offset:28672
    ds_read_b64_tr_b16 a[2:3], v6 offset:29440
    s_waitcnt lgkmcnt(2)
    v_mfma_f32_32x32x16_bf16 v[160:175], a[16:19], v[104:107], v[160:175]
    ds_read_b64_tr_b16 a[8:9], v5 offset:4096
    ds_read_b64_tr_b16 a[10:11], v5 offset:4864
    s_waitcnt lgkmcnt(2)
    v_mfma_f32_32x32x16_bf16 v[160:175], a[0:3], v[108:111], v[160:175]
    ds_read_b64_tr_b16 a[16:17], v5 offset:32768
    ds_read_b64_tr_b16 a[18:19], v5 offset:33536
    s_waitcnt lgkmcnt(2)
    v_mfma_f32_32x32x16_bf16 v[160:175], a[8:11], v[112:115], v[160:175]
    ds_read_b64_tr_b16 a[0:1], v6 offset:4096
    ds_read_b64_tr_b16 a[2:3], v6 offset:4864
    s_waitcnt lgkmcnt(2)
    v_mfma_f32_32x32x16_bf16 v[160:175], a[16:19], v[116:119], v[160:175]
    ds_read_b64_tr_b16 a[8:9], v6 offset:32768
    ds_read_b64_tr_b16 a[10:11], v6 offset:33536
    s_waitcnt lgkmcnt(2)
    v_mfma_f32_32x32x16_bf16 v[160:175], a[0:3], v[120:123], v[160:175]
    ds_read_b64_tr_b16 a[4:5], v5 offset:16512
    ds_read_b64_tr_b16 a[6:7], v5 offset:17280
    s_waitcnt lgkmcnt(2)
    v_mfma_f32_32x32x16_bf16 v[160:175], a[8:11], v[124:127], v[160:175]
    ds_read_b64_tr_b16 a[12:13], v5 offset:45184
    ds_read_b64_tr_b16 a[14:15], v5 offset:45952
    s_cmp_eq_u32 s51, 0
    s_cselect_b32 s62, 0x3e8b97f6, 1.0
    s_cselect_b32 s63, 17, 18
    s_cselect_b32 s64, 11, 12
    s_lshl_b32 s64, s52, s64
    s_mul_i32 s65, s51, 2097152
    s_add_u32 s64, s64, s65
    s_lshl_b32 s55, s50, 4
    s_waitcnt lgkmcnt(2)
    v_mfma_f32_32x32x16_bf16 v[176:191], v[16:19], a[4:7], 0
    ds_read_b64_tr_b16 a[20:21], v5 offset:20608
    ds_read_b64_tr_b16 a[22:23], v5 offset:21376
    v_and_b32 v24, 31, v0
    v_lshrrev_b32 v25, 5, v0
    v_lshlrev_b32 v24, 4, v24
    v_add_u32 v25, s55, v25
    v_mul_f32 v26, s62, v12
    v_add_u32 v56, 0, v25
    v_mul_u32_u24 v57, 9363, v56
    s_waitcnt lgkmcnt(2)
    v_mfma_f32_32x32x16_bf16 v[176:191], v[20:23], a[12:15], v[176:191]
    ds_read_b64_tr_b16 a[4:5], v5 offset:49280
    ds_read_b64_tr_b16 a[6:7], v5 offset:50048
    v_lshrrev_b32 v57, 16, v57
    v_mad_i32_i24 v56, v57, -7, v56
    v_lshlrev_b32 v57, s63, v57
    v_add_u32 v57, v57, v24
    v_and_b32 v58, 4, v56
    v_lshl_add_u32 v57, v58, 8, v57
    v_and_b32 v58, 1, v56
    s_waitcnt lgkmcnt(2)
    v_mfma_f32_32x32x16_bf16 v[176:191], v[32:35], a[20:23], v[176:191]
    ds_read_b64_tr_b16 a[12:13], v7 offset:128
    ds_read_b64_tr_b16 a[14:15], v7 offset:896
    v_lshl_add_u32 v57, v58, 9, v57
    v_and_b32 v58, 2, v56
    v_lshl_add_u32 v57, v58, 2, v57
    v_fma_f32 v160, v13, v216, v160
    v_fma_f32 v161, v13, v217, v161
    v_fma_f32 v162, v13, v218, v162
    v_fma_f32 v163, v13, v220, v163
    v_mul_f32 v160, v160, v26
    s_waitcnt lgkmcnt(2)
    v_mfma_f32_32x32x16_bf16 v[176:191], v[36:39], a[4:7], v[176:191]
    ds_read_b64_tr_b16 a[20:21], v7 offset:4224
    ds_read_b64_tr_b16 a[22:23], v7 offset:4992
    v_mul_f32 v161, v161, v26
    v_mul_f32 v162, v162, v26
    v_mul_f32 v163, v163, v26
    v_cvt_pk_bf16_f32 v40, v160, v161
    v_cvt_pk_bf16_f32 v41, v162, v163
    buffer_store_dwordx2 v[40:41], v57, s[28:31], s64 offen
    v_add_u32 v60, 2, v25
    s_waitcnt lgkmcnt(2)
    v_mfma_f32_32x32x16_bf16 v[176:191], v[48:51], a[12:15], v[176:191]
    ds_read_b64_tr_b16 a[4:5], v7 offset:16512
    ds_read_b64_tr_b16 a[6:7], v7 offset:17280
    v_mul_u32_u24 v61, 9363, v60
    v_lshrrev_b32 v61, 16, v61
    v_mad_i32_i24 v60, v61, -7, v60
    v_lshlrev_b32 v61, s63, v61
    v_add_u32 v61, v61, v24
    v_and_b32 v62, 4, v60
    v_lshl_add_u32 v61, v62, 8, v61
    v_and_b32 v62, 1, v60
    s_waitcnt lgkmcnt(2)
    v_mfma_f32_32x32x16_bf16 v[176:191], v[52:55], a[20:23], v[176:191]
    ds_read_b64_tr_b16 a[12:13], v7 offset:20608
    ds_read_b64_tr_b16 a[14:15], v7 offset:21376
    v_lshl_add_u32 v61, v62, 9, v61
    v_and_b32 v62, 2, v60
    v_lshl_add_u32 v61, v62, 2, v61
    v_fma_f32 v164, v13, v221, v164
    v_fma_f32 v165, v13, v222, v165
    v_fma_f32 v166, v13, v224, v166
    v_fma_f32 v167, v13, v225, v167
    s_waitcnt lgkmcnt(2)
    v_mfma_f32_32x32x16_bf16 v[176:191], v[64:67], a[4:7], v[176:191]
    ds_read_b64_tr_b16 a[20:21], v7 offset:32896
    ds_read_b64_tr_b16 a[22:23], v7 offset:33664
    v_mul_f32 v164, v164, v26
    v_mul_f32 v165, v165, v26
    v_mul_f32 v166, v166, v26
    v_mul_f32 v167, v167, v26
    v_cvt_pk_bf16_f32 v42, v164, v165
    v_cvt_pk_bf16_f32 v43, v166, v167
    buffer_store_dwordx2 v[42:43], v61, s[28:31], s64 offen
    v_add_u32 v56, 4, v25
    s_waitcnt lgkmcnt(2)
    v_mfma_f32_32x32x16_bf16 v[176:191], v[68:71], a[12:15], v[176:191]
    ds_read_b64_tr_b16 a[4:5], v7 offset:36992
    ds_read_b64_tr_b16 a[6:7], v7 offset:37760
    v_mul_u32_u24 v57, 9363, v56
    v_lshrrev_b32 v57, 16, v57
    v_mad_i32_i24 v56, v57, -7, v56
    v_lshlrev_b32 v57, s63, v57
    v_add_u32 v57, v57, v24
    v_and_b32 v58, 4, v56
    v_lshl_add_u32 v57, v58, 8, v57
    s_waitcnt lgkmcnt(2)
    v_mfma_f32_32x32x16_bf16 v[176:191], v[80:83], a[20:23], v[176:191]
    ds_read_b64_tr_b16 a[12:13], v5 offset:128
    ds_read_b64_tr_b16 a[14:15], v5 offset:896
    v_and_b32 v58, 1, v56
    v_lshl_add_u32 v57, v58, 9, v57
    v_and_b32 v58, 2, v56
    v_lshl_add_u32 v57, v58, 2, v57
    v_fma_f32 v168, v13, v226, v168
    v_fma_f32 v169, v13, v228, v169
    v_fma_f32 v170, v13, v229, v170
    v_fma_f32 v171, v13, v230, v171
    s_waitcnt lgkmcnt(2)
    v_mfma_f32_32x32x16_bf16 v[176:191], v[84:87], a[4:7], v[176:191]
    ds_read_b64_tr_b16 a[20:21], v5 offset:28800
    ds_read_b64_tr_b16 a[22:23], v5 offset:29568
    v_mul_f32 v168, v168, v26
    v_mul_f32 v169, v169, v26
    v_mul_f32 v170, v170, v26
    v_mul_f32 v171, v171, v26
    v_cvt_pk_bf16_f32 v44, v168, v169
    v_cvt_pk_bf16_f32 v45, v170, v171
    buffer_store_dwordx2 v[44:45], v57, s[28:31], s64 offen
    s_waitcnt lgkmcnt(2)
    v_mfma_f32_32x32x16_bf16 v[176:191], v[96:99], a[12:15], v[176:191]
    ds_read_b64_tr_b16 a[4:5], v5 offset:4224
    ds_read_b64_tr_b16 a[6:7], v5 offset:4992
    v_add_u32 v60, 6, v25
    v_mul_u32_u24 v61, 9363, v60
    v_lshrrev_b32 v61, 16, v61
    v_mad_i32_i24 v60, v61, -7, v60
    v_lshlrev_b32 v61, s63, v61
    v_add_u32 v61, v61, v24
    v_and_b32 v62, 4, v60
    v_lshl_add_u32 v61, v62, 8, v61
    s_waitcnt lgkmcnt(2)
    v_mfma_f32_32x32x16_bf16 v[176:191], v[100:103], a[20:23], v[176:191]
    ds_read_b64_tr_b16 a[12:13], v5 offset:32896
    ds_read_b64_tr_b16 a[14:15], v5 offset:33664
    v_and_b32 v62, 1, v60
    v_lshl_add_u32 v61, v62, 9, v61
    v_and_b32 v62, 2, v60
    v_lshl_add_u32 v61, v62, 2, v61
    v_fma_f32 v172, v13, v198, v172
    v_fma_f32 v173, v13, v199, v173
    v_fma_f32 v174, v13, v200, v174
    s_waitcnt lgkmcnt(2)
    v_mfma_f32_32x32x16_bf16 v[176:191], v[112:115], a[4:7], v[176:191]
    v_fma_f32 v175, v13, v8, v175
    v_mul_f32 v172, v172, v26
    v_mul_f32 v173, v173, v26
    v_mul_f32 v174, v174, v26
    v_mul_f32 v175, v175, v26
    v_cvt_pk_bf16_f32 v46, v172, v173
    v_cvt_pk_bf16_f32 v47, v174, v175
    buffer_store_dwordx2 v[46:47], v61, s[28:31], s64 offen
    s_waitcnt lgkmcnt(0)
    v_mfma_f32_32x32x16_bf16 v[176:191], v[116:119], a[12:15], v[176:191]
    v_and_b32 v18, 31, v0
    v_lshrrev_b32 v19, 5, v0
    v_lshlrev_b32 v20, 4, v18
    s_cmp_eq_u32 s51, 0
    s_cbranch_scc1 L_k1_nopre0
    v_mul_u32_u24 v17, 14336, v19
    v_add_u32 v17, v17, v20
    s_add_u32 s60, s59, 4096
    s_add_u32 s67, s59, 8192
    s_add_u32 s68, s59, 12288
    buffer_load_dwordx4 v[32:35], v17, s[28:31], s59 offen offset:0 sc0 sc1
    buffer_load_dwordx4 v[36:39], v17, s[28:31], s59 offen offset:2048 sc0 sc1
    buffer_load_dwordx4 v[40:43], v17, s[28:31], s60 offen offset:0 sc0 sc1
    buffer_load_dwordx4 v[44:47], v17, s[28:31], s60 offen offset:2048 sc0 sc1
    buffer_load_dwordx4 v[48:51], v17, s[28:31], s67 offen offset:0 sc0 sc1
    buffer_load_dwordx4 v[52:55], v17, s[28:31], s67 offen offset:2048 sc0 sc1
    buffer_load_dwordx4 v[56:59], v17, s[28:31], s68 offen offset:0 sc0 sc1
L_k1_nopre0:
    v_add_u32 v21, s53, v1
    v_add_u32 v21, 8192, v21
    s_barrier
    ds_read_b128 v[112:115], v21 offset:0
    ds_read_b128 v[116:119], v21 offset:1024
    ds_read_b128 v[120:123], v21 offset:2048
    ds_read_b128 v[124:127], v21 offset:3072
    s_lshl_b32 s65, s52, 12
    s_add_u32 s65, s65, 2097152
    s_lshl_b32 s55, s49, 5
    v_add_u32 v22, s55, v18
    v_mul_u32_u24 v23, 2341, v22
    v_lshrrev_b32 v23, 16, v23
    s_mov_b32 s55, -28
    v_mad_i32_i24 v22, v23, s55, v22
    v_lshl_add_u32 v22, v19, 5, v22
    v_lshlrev_b32 v22, 4, v22
    v_lshl_add_u32 v22, v23, 18, v22
    v_lshlrev_b32 v24, 5, v19
    v_add_u32 v24, s53, v24
    ds_read_b128 v[64:67], v24 offset:25088
    ds_read_b128 v[68:71], v24 offset:25104
    ds_read_b128 v[72:75], v24 offset:25152
    ds_read_b128 v[76:79], v24 offset:25168
    ds_read_b128 v[80:83], v24 offset:25216
    ds_read_b128 v[84:87], v24 offset:25232
    ds_read_b128 v[88:91], v24 offset:25280
    ds_read_b128 v[92:95], v24 offset:25296
    s_waitcnt lgkmcnt(11)
    v_add_f32 v176, v176, v112
    v_add_f32 v177, v177, v113
    v_add_f32 v178, v178, v114
    v_add_f32 v179, v179, v115
    s_waitcnt lgkmcnt(10)
    v_add_f32 v180, v180, v116
    v_add_f32 v181, v181, v117
    v_add_f32 v182, v182, v118
    v_add_f32 v183, v183, v119
    s_waitcnt lgkmcnt(9)
    v_add_f32 v184, v184, v120
    v_add_f32 v185, v185, v121
    v_add_f32 v186, v186, v122
    v_add_f32 v187, v187, v123
    s_waitcnt lgkmcnt(8)
    v_add_f32 v188, v188, v124
    v_add_f32 v189, v189, v125
    v_add_f32 v190, v190, v126
    v_add_f32 v191, v191, v127
    s_mov_b32 s61, 0
L_k1_vpoll:
    s_waitcnt vmcnt(0)
    v_cmp_ne_u32 vcc, v211, v212
    v_cmp_eq_u32 s[62:63], 0, v212
    s_nop 0
    s_or_b64 vcc, vcc, s[62:63]
    s_add_u32 s61, s61, 1
    s_cmp_eq_u64 vcc, 0
    s_cbranch_scc1 L_k1_vok
    buffer_load_dwordx2 v[210:211], v213, s[28:31], s34 offen sc0 sc1
    buffer_load_dword v212, v214, s[44:47], 0 offen sc0 sc1
    s_cmp_lt_u32 s61, 0x40000
    s_cbranch_scc1 L_k1_vpoll
L_k1_vok:
    s_waitcnt lgkmcnt(7)
    v_mul_f32 v65, v65, v210
    v_mul_f32 v67, v67, v210
    s_waitcnt lgkmcnt(6)
    v_mul_f32 v69, v69, v210
    v_mul_f32 v71, v71, v210
    s_waitcnt lgkmcnt(5)
    v_mul_f32 v73, v73, v210
    v_mul_f32 v75, v75, v210
    s_waitcnt lgkmcnt(4)
    v_mul_f32 v77, v77, v210
    v_mul_f32 v79, v79, v210
    s_waitcnt lgkmcnt(3)
    v_mul_f32 v81, v81, v210
    v_mul_f32 v83, v83, v210
    s_waitcnt lgkmcnt(2)
    v_mul_f32 v85, v85, v210
    v_mul_f32 v87, v87, v210
    s_waitcnt lgkmcnt(1)
    v_mul_f32 v89, v89, v210
    v_mul_f32 v91, v91, v210
    s_waitcnt lgkmcnt(0)
    v_mul_f32 v93, v93, v210
    v_mul_f32 v95, v95, v210
    v_fma_f32 v176, v176, v64, v65
    v_fma_f32 v177, v177, v66, v67
    v_fma_f32 v178, v178, v68, v69
    v_fma_f32 v179, v179, v70, v71
    v_fma_f32 v180, v180, v72, v73
    v_fma_f32 v181, v181, v74, v75
    v_fma_f32 v182, v182, v76, v77
    v_fma_f32 v183, v183, v78, v79
    v_fma_f32 v184, v184, v80, v81
    v_fma_f32 v185, v185, v82, v83
    v_fma_f32 v186, v186, v84, v85
    v_fma_f32 v187, v187, v86, v87
    v_fma_f32 v188, v188, v88, v89
    v_fma_f32 v189, v189, v90, v91
    v_fma_f32 v190, v190, v92, v93
    v_fma_f32 v191, v191, v94, v95
    v_cvt_pk_bf16_f32 v96, v176, v177
    v_cvt_pk_bf16_f32 v97, v178, v179
    v_cvt_pk_bf16_f32 v98, v180, v181
    v_cvt_pk_bf16_f32 v99, v182, v183
    v_cvt_pk_bf16_f32 v100, v184, v185
    v_cvt_pk_bf16_f32 v101, v186, v187
    v_cvt_pk_bf16_f32 v102, v188, v189
    v_cvt_pk_bf16_f32 v103, v190, v191
    buffer_store_dwordx4 v[96:99], v22, s[28:31], s65 offen offset:2048
    buffer_store_dwordx4 v[100:103], v22, s[28:31], s65 offen offset:3072
    s_cmp_eq_u32 s51, 0
    s_cbranch_scc1 L_k1_fin
    s_mov_b32 s61, 0
L_k1_poll0:
    s_waitcnt vmcnt(6)
    v_xor_b32 v60, v33, v203
    v_xor_b32 v61, v35, v203
    v_or_b32 v60, v60, v61
    s_waitcnt vmcnt(5)
    v_xor_b32 v61, v37, v203
    v_or_b32 v60, v60, v61
    v_xor_b32 v61, v39, v203
    v_or_b32 v60, v60, v61
    s_waitcnt vmcnt(4)
    v_xor_b32 v61, v41, v203
    v_or_b32 v60, v60, v61
    v_xor_b32 v61, v43, v203
    v_or_b32 v60, v60, v61
    s_waitcnt vmcnt(3)
    v_xor_b32 v61, v45, v203
    v_or_b32 v60, v60, v61
    v_xor_b32 v61, v47, v203
    v_or_b32 v60, v60, v61
    s_waitcnt vmcnt(2)
    v_xor_b32 v61, v49, v203
    v_or_b32 v60, v60, v61
    v_xor_b32 v61, v51, v203
    v_or_b32 v60, v60, v61
    s_waitcnt vmcnt(1)
    v_xor_b32 v61, v53, v203
    v_or_b32 v60, v60, v61
    v_xor_b32 v61, v55, v203
    v_or_b32 v60, v60, v61
    s_waitcnt vmcnt(0)
    v_xor_b32 v61, v57, v203
    v_or_b32 v60, v60, v61
    v_xor_b32 v61, v59, v203
    v_or_b32 v60, v60, v61
    v_cmp_ne_u32 vcc, 0, v60
    s_add_u32 s61, s61, 1
    s_cmp_eq_u64 vcc, 0
    s_cbranch_scc1 L_k1_polled0
    s_sleep 1
    buffer_load_dwordx4 v[32:35], v17, s[28:31], s59 offen offset:0 sc0 sc1
    buffer_load_dwordx4 v[36:39], v17, s[28:31], s59 offen offset:2048 sc0 sc1
    buffer_load_dwordx4 v[40:43], v17, s[28:31], s60 offen offset:0 sc0 sc1
    buffer_load_dwordx4 v[44:47], v17, s[28:31], s60 offen offset:2048 sc0 sc1
    buffer_load_dwordx4 v[48:51], v17, s[28:31], s67 offen offset:0 sc0 sc1
    buffer_load_dwordx4 v[52:55], v17, s[28:31], s67 offen offset:2048 sc0 sc1
    buffer_load_dwordx4 v[56:59], v17, s[28:31], s68 offen offset:0 sc0 sc1
    s_cmp_lt_u32 s61, 0x40000
    s_cbranch_scc1 L_k1_poll0
L_k1_polled0:
    v_add_f32 v32, v32, v36
    v_add_f32 v34, v34, v38
    v_add_f32 v32, v32, v40
    v_add_f32 v34, v34, v42
    v_add_f32 v32, v32, v44
    v_add_f32 v34, v34, v46
    v_add_f32 v32, v32, v48
    v_add_f32 v34, v34, v50
    v_add_f32 v32, v32, v52
    v_add_f32 v34, v34, v54
    v_add_f32 v32, v32, v56
    v_add_f32 v34, v34, v58
    v_mov_b32 v33, v32
    v_mov_b32 v35, v34
    s_nop 0
    v_permlane32_swap_b32 v32, v33
    v_permlane32_swap_b32 v34, v35
    v_add_f32 v32, v32, v33
    v_add_f32 v34, v34, v35
    v_mul_f32 v32, 0x3a924925, v32
    v_mul_f32 v34, 0x3a924925, v34
    v_fma_f32 v34, -v32, v32, v34
    v_max_f32 v34, 0, v34
    v_add_f32 v34, 0x361367a4, v34
    v_rsq_f32 v12, v34
    s_nop 0
    v_mul_f32 v13, v32, v12
    v_sub_f32 v13, 0, v13
    s_add_u32 s55, s53, 8192
    v_mul_u32_u24 v21, 576, v19
    v_add_u32 v21, v21, v20
    v_add_u32 v21, s55, v21
    v_bfe_u32 v22, v0, 4, 1
    v_and_b32 v23, 1, v0
    v_lshl_add_u32 v22, v22, 1, v23
    v_mul_u32_u24 v22, 576, v22
    v_bfe_u32 v23, v0, 2, 2
    v_lshl_add_u32 v23, v19, 3, v23
    v_lshl_add_u32 v22, v23, 4, v22
    v_bfe_u32 v23, v0, 1, 1
    v_lshl_add_u32 v22, v23, 3, v22
    v_add_u32 v22, s55, v22
    s_lshl_b32 s55, s50, 9
    s_lshl_b32 s59, s52, 1
    s_add_u32 s55, s55, s59
    s_lshl_b32 s55, s55, 10
    s_add_u32 s55, s55, 10485760
    v_fma_f32 v128, v128, v12, v13
    v_fma_f32 v129, v129, v12, v13
    v_fma_f32 v130, v130, v12, v13
    v_fma_f32 v131, v131, v12, v13
    v_fma_f32 v132, v132, v12, v13
    v_fma_f32 v133, v133, v12, v13
    v_fma_f32 v134, v134, v12, v13
    v_fma_f32 v135, v135, v12, v13
    v_fma_f32 v136, v136, v12, v13
    v_fma_f32 v137, v137, v12, v13
    v_fma_f32 v138, v138, v12, v13
    v_fma_f32 v139, v139, v12, v13
    v_fma_f32 v140, v140, v12, v13
    v_fma_f32 v141, v141, v12, v13
    v_fma_f32 v142, v142, v12, v13
    v_fma_f32 v143, v143, v12, v13
    v_cvt_pk_bf16_f32 v64, v128, v129
    v_cvt_pk_bf16_f32 v65, v130, v131
    v_cvt_pk_bf16_f32 v66, v132, v133
    v_cvt_pk_bf16_f32 v67, v134, v135
    v_cvt_pk_bf16_f32 v68, v136, v137
    v_cvt_pk_bf16_f32 v69, v138, v139
    v_cvt_pk_bf16_f32 v70, v140, v141
    v_cvt_pk_bf16_f32 v71, v142, v143
    ds_write_b128 v21, v[64:67] offset:0
    ds_write_b128 v21, v[68:71] offset:1152
    ds_read_b64_tr_b16 v[80:81], v22 offset:0
    ds_read_b64_tr_b16 v[82:83], v22 offset:64
    ds_read_b64_tr_b16 v[84:85], v22 offset:256
    ds_read_b64_tr_b16 v[86:87], v22 offset:320
    v_fma_f32 v144, v144, v12, v13
    v_fma_f32 v145, v145, v12, v13
    v_fma_f32 v146, v146, v12, v13
    v_fma_f32 v147, v147, v12, v13
    v_fma_f32 v148, v148, v12, v13
    v_fma_f32 v149, v149, v12, v13
    v_fma_f32 v150, v150, v12, v13
    v_fma_f32 v151, v151, v12, v13
    v_fma_f32 v152, v152, v12, v13
    v_fma_f32 v153, v153, v12, v13
    v_fma_f32 v154, v154, v12, v13
    v_fma_f32 v155, v155, v12, v13
    v_fma_f32 v156, v156, v12, v13
    v_fma_f32 v157, v157, v12, v13
    v_fma_f32 v158, v158, v12, v13
    v_fma_f32 v159, v159, v12, v13
    v_cvt_pk_bf16_f32 v72, v144, v145
    v_cvt_pk_bf16_f32 v73, v146, v147
    v_cvt_pk_bf16_f32 v74, v148, v149
    v_cvt_pk_bf16_f32 v75, v150, v151
    v_cvt_pk_bf16_f32 v76, v152, v153
    v_cvt_pk_bf16_f32 v77, v154, v155
    v_cvt_pk_bf16_f32 v78, v156, v157
    v_cvt_pk_bf16_f32 v79, v158, v159
    ds_write_b128 v21, v[72:75] offset:2304
    ds_write_b128 v21, v[76:79] offset:3456
    ds_read_b64_tr_b16 v[88:89], v22 offset:2304
    ds_read_b64_tr_b16 v[90:91], v22 offset:2368
    ds_read_b64_tr_b16 v[92:93], v22 offset:2560
    ds_read_b64_tr_b16 v[94:95], v22 offset:2624
    s_waitcnt lgkmcnt(8)
    buffer_store_dwordx4 v[80:83], v1, s[28:31], s55 offen
    s_waitcnt lgkmcnt(6)
    buffer_store_dwordx4 v[84:87], v1, s[28:31], s55 offen offset:1024
    s_add_u32 s55, s55, 131072
    s_waitcnt lgkmcnt(2)
    buffer_store_dwordx4 v[88:91], v1, s[28:31], s55 offen
    s_waitcnt lgkmcnt(0)
    buffer_store_dwordx4 v[92:95], v1, s[28:31], s55 offen offset:1024
    s_branch L_k1_fin
L_k1_role1:
    s_add_u32 s55, s54, 128
    s_add_u32 m0, s53, 4096
    s_nop 0
    buffer_load_dwordx4 v194, s[16:19], s55 offen lds
    s_add_u32 s55, s54, 7296
    s_add_u32 m0, s53, 5120
    s_nop 0
    buffer_load_dwordx4 v195, s[16:19], s55 offen lds
    s_add_u32 s55, s54, 14464
    s_add_u32 m0, s53, 6144
    s_nop 0
    buffer_load_dwordx4 v194, s[16:19], s55 offen lds
    s_add_u32 s55, s54, 21632
    s_add_u32 m0, s53, 7168
    s_nop 0
    buffer_load_dwordx4 v195, s[16:19], s55 offen lds
    s_add_u32 s55, s56, 0
    s_add_u32 m0, s57, 0
    s_nop 0
    buffer_load_dwordx4 v2, s[24:27], s55 offen lds
    s_add_u32 s55, s56, 14336
    s_add_u32 m0, s57, 1024
    s_nop 0
    buffer_load_dwordx4 v2, s[24:27], s55 offen lds
    s_add_u32 s55, s54, 384
    s_add_u32 m0, s53, 12288
    s_nop 0
    buffer_load_dwordx4 v194, s[16:19], s55 offen lds
    s_add_u32 s55, s54, 7552
    s_add_u32 m0, s53, 13312
    s_nop 0
    buffer_load_dwordx4 v195, s[16:19], s55 offen lds
    s_add_u32 s55, s54, 14720
    s_add_u32 m0, s53, 14336
    s_nop 0
    buffer_load_dwordx4 v194, s[16:19], s55 offen lds
    s_add_u32 s55, s54, 21888
    s_add_u32 m0, s53, 15360
    s_nop 0
    buffer_load_dwordx4 v195, s[16:19], s55 offen lds
    s_add_u32 s55, s56, 229376
    s_add_u32 m0, s57, 16384
    s_nop 0
    buffer_load_dwordx4 v2, s[24:27], s55 offen lds
    s_add_u32 s55, s56, 243712
    s_add_u32 m0, s57, 17408
    s_nop 0
    buffer_load_dwordx4 v2, s[24:27], s55 offen lds
    v_bfe_u32 v196, v0, 2, 2
    v_bfe_u32 v197, v0, 5, 1
    v_lshl_add_u32 v198, v197, 3, v196
    v_bfe_u32 v199, v0, 4, 1
    v_bfe_u32 v200, v0, 1, 1
    v_lshl_add_u32 v200, v199, 1, v200
    v_lshl_add_u32 v200, v196, 2, v200
    v_and_b32 v201, 1, v0
    v_lshlrev_b32 v201, 3, v201
    v_lshl_add_u32 v201, v198, 8, v201
    v_add_u32 v205, 8, v200
    v_and_b32 v205, 15, v205
    v_lshl_add_u32 v210, v205, 4, v201
    v_add_u32 v211, 57344, v210
    v_add_u32 v212, 114688, v210
    v_add_u32 v205, 12, v200
    v_and_b32 v205, 15, v205
    v_lshl_add_u32 v213, v205, 4, v201
    v_add_u32 v214, 57344, v213
    v_add_u32 v215, 114688, v213
    v_mul_u32_u24 v5, 192, v198
    v_lshl_add_u32 v5, v199, 5, v5
    v_and_b32 v201, 3, v0
    v_lshl_add_u32 v5, v201, 3, v5
    v_add_u32 v6, 57344, v5
    v_add_u32 v7, 114688, v5
    v_lshlrev_b32 v1, 4, v0
    v_mul_u32_u24 v193, 96, v197
    v_and_b32 v196, 31, v0
    v_lshrrev_b32 v198, 1, v196
    v_add_u32 v198, v198, v197
    v_lshlrev_b32 v196, 7, v196
    v_add_u32 v196, s53, v196
    v_add_u32 v205, 0, v198
    v_and_b32 v205, 7, v205
    v_lshl_add_u32 v8, v205, 4, v196
    v_add_u32 v205, 2, v198
    v_and_b32 v205, 7, v205
    v_lshl_add_u32 v9, v205, 4, v196
    v_add_u32 v205, 4, v198
    v_and_b32 v205, 7, v205
    v_lshl_add_u32 v10, v205, 4, v196
    v_add_u32 v205, 6, v198
    v_and_b32 v205, 7, v205
    v_lshl_add_u32 v11, v205, 4, v196
    v_mov_b32 v216, v194
    v_mov_b32 v217, v195
    s_mov_b32 s20, s6
    s_and_b32 s21, s7, 0xffff
    s_mov_b32 s22, 1204224
    s_mov_b32 s23, 0x20000
    s_mov_b32 s28, s14
    s_and_b32 s29, s15, 0xffff
    s_mov_b32 s30, 25165824
    s_mov_b32 s31, 0x20000
    s_mov_b32 s44, s12
    s_and_b32 s45, s13, 0xffff
    s_mov_b32 s46, 256
    s_mov_b32 s47, 0x20000
    s_lshl_b32 s58, s3, 6
    s_lshl_b32 s59, s49, 7
    s_lshl_b32 s60, s49, 6
    s_add_u32 s60, s60, 1664
    s_mov_b32 s61, 43691
    v_add_u32 v196, s58, v0
    v_mul_lo_u32 v197, v196, s61
    v_lshrrev_b32 v197, 19, v197
    v_mad_i32_i24 v198, v197, -12, v196
    v_mov_b32 v199, s59
    v_mov_b32 v200, s60
    v_cmp_gt_u32 vcc, 8, v198
    s_nop 1
    v_cndmask_b32 v199, v200, v199, vcc
    v_lshl_add_u32 v199, v198, 4, v199
    v_mul_u32_u24 v197, 2688, v197
    v_add_u32 v3, v197, v199
    s_add_u32 s58, s3, 0
    s_mul_i32 s59, s58, 43
    s_lshr_b32 s59, s59, 7
    s_mul_i32 s60, s59, 3
    s_sub_u32 s60, s58, s60
    s_lshl_b32 s60, s60, 10
    s_lshl_b32 s61, s59, 12
    s_add_u32 s61, s61, s60
    s_add_u32 s36, s61, 114688
    s_mul_i32 s61, s59, 28672
    s_add_u32 s38, s61, s60
    v_mov_b32 v14, 0x409d30fc
    v_mov_b32 v198, 0
    v_mov_b32 v199, 0
    v_mov_b32 v200, 0
    v_mov_b32 v201, 0
    v_mov_b32 v15, 0
    v_mov_b32 v192, 0
    s_waitcnt vmcnt(8)
    s_waitcnt vmcnt(6)
    s_barrier
    ds_read_b128 v[16:19], v8 offset:0
    ds_read_b128 v[20:23], v9 offset:0
    ds_read_b128 v[24:27], v10 offset:0
    ds_read_b128 v[28:31], v11 offset:0
    ds_read_b64_tr_b16 a[0:1], v212 offset:0
    ds_read_b64_tr_b16 a[2:3], v212 offset:1024
    ds_read_b64_tr_b16 a[4:5], v215 offset:0
    ds_read_b64_tr_b16 a[6:7], v215 offset:1024
    ds_read_b64_tr_b16 a[8:9], v212 offset:4096
    ds_read_b64_tr_b16 a[10:11], v212 offset:5120
    ds_read_b64_tr_b16 a[12:13], v215 offset:4096
    ds_read_b64_tr_b16 a[14:15], v215 offset:5120
    ds_read_b128 v[32:35], v8 offset:4096
    ds_read_b128 v[36:39], v9 offset:4096
    ds_read_b128 v[40:43], v10 offset:4096
    ds_read_b128 v[44:47], v11 offset:4096
    s_add_u32 s55, s54, 640
    s_add_u32 m0, s53, 20480
    s_nop 0
    buffer_load_dwordx4 v216, s[16:19], s55 offen lds
    s_add_u32 s55, s54, 7808
    s_add_u32 m0, s53, 21504
    s_nop 0
    buffer_load_dwordx4 v217, s[16:19], s55 offen lds
    s_add_u32 s55, s54, 14976
    s_add_u32 m0, s53, 22528
    s_nop 0
    buffer_load_dwordx4 v216, s[16:19], s55 offen lds
    s_add_u32 s55, s54, 22144
    s_add_u32 m0, s53, 23552
    s_nop 0
    buffer_load_dwordx4 v217, s[16:19], s55 offen lds
    s_add_u32 s55, s56, 458752
    s_add_u32 m0, s57, 32768
    s_nop 0
    buffer_load_dwordx4 v2, s[24:27], s55 offen lds
    s_add_u32 s55, s56, 473088
    s_add_u32 m0, s57, 33792
    s_nop 0
    buffer_load_dwordx4 v2, s[24:27], s55 offen lds
    v_mov_b32 v196, 0x3f803f80
    s_waitcnt lgkmcnt(3)
    v_dot2_f32_bf16 v198, v32, v196, v198
    v_dot2_f32_bf16 v200, v32, v32, v200
    v_dot2_f32_bf16 v199, v33, v196, v199
    v_dot2_f32_bf16 v201, v33, v33, v201
    v_dot2_f32_bf16 v198, v34, v196, v198
    v_dot2_f32_bf16 v200, v34, v34, v200
    v_dot2_f32_bf16 v199, v35, v196, v199
    v_dot2_f32_bf16 v201, v35, v35, v201
    s_waitcnt lgkmcnt(2)
    v_dot2_f32_bf16 v198, v36, v196, v198
    v_dot2_f32_bf16 v200, v36, v36, v200
    v_dot2_f32_bf16 v199, v37, v196, v199
    v_dot2_f32_bf16 v201, v37, v37, v201
    v_dot2_f32_bf16 v198, v38, v196, v198
    v_dot2_f32_bf16 v200, v38, v38, v200
    v_dot2_f32_bf16 v199, v39, v196, v199
    v_dot2_f32_bf16 v201, v39, v39, v201
    s_waitcnt lgkmcnt(1)
    v_dot2_f32_bf16 v198, v40, v196, v198
    v_dot2_f32_bf16 v200, v40, v40, v200
    v_dot2_f32_bf16 v199, v41, v196, v199
    v_dot2_f32_bf16 v201, v41, v41, v201
    v_dot2_f32_bf16 v198, v42, v196, v198
    v_dot2_f32_bf16 v200, v42, v42, v200
    v_dot2_f32_bf16 v199, v43, v196, v199
    v_dot2_f32_bf16 v201, v43, v43, v201
    s_waitcnt lgkmcnt(0)
    v_dot2_f32_bf16 v198, v44, v196, v198
    v_dot2_f32_bf16 v200, v44, v44, v200
    v_dot2_f32_bf16 v199, v45, v196, v199
    v_dot2_f32_bf16 v201, v45, v45, v201
    v_dot2_f32_bf16 v198, v46, v196, v198
    v_dot2_f32_bf16 v200, v46, v46, v200
    v_dot2_f32_bf16 v199, v47, v196, v199
    v_dot2_f32_bf16 v201, v47, v47, v201
    s_nop 2
    v_mfma_f32_32x32x16_bf16 v[128:143], a[0:3], v[16:19], 0
    ds_read_b64_tr_b16 a[16:17], v212 offset:8192
    ds_read_b64_tr_b16 a[18:19], v212 offset:9216
    ds_read_b64_tr_b16 a[20:21], v215 offset:8192
    ds_read_b64_tr_b16 a[22:23], v215 offset:9216
    v_mfma_f32_32x32x16_bf16 v[144:159], a[4:7], v[16:19], 0
    v_mfma_f32_32x32x16_bf16 v[128:143], a[8:11], v[20:23], v[128:143]
    ds_read_b64_tr_b16 a[0:1], v212 offset:12288
    ds_read_b64_tr_b16 a[2:3], v212 offset:13312
    ds_read_b64_tr_b16 a[4:5], v215 offset:12288
    ds_read_b64_tr_b16 a[6:7], v215 offset:13312
    v_mfma_f32_32x32x16_bf16 v[144:159], a[12:15], v[20:23], v[144:159]
    s_waitcnt lgkmcnt(0)
    s_waitcnt vmcnt(8)
    s_waitcnt vmcnt(6)
    s_barrier
    ds_read_b128 v[64:67], v8 offset:12288
    ds_read_b128 v[68:71], v9 offset:12288
    ds_read_b128 v[72:75], v10 offset:12288
    ds_read_b128 v[76:79], v11 offset:12288
    ds_read_b128 v[48:51], v8 offset:8192
    ds_read_b128 v[52:55], v9 offset:8192
    ds_read_b128 v[56:59], v10 offset:8192
    ds_read_b128 v[60:63], v11 offset:8192
    s_waitcnt lgkmcnt(7)
    v_dot2_f32_bf16 v198, v64, v196, v198
    v_dot2_f32_bf16 v200, v64, v64, v200
    v_dot2_f32_bf16 v199, v65, v196, v199
    v_dot2_f32_bf16 v201, v65, v65, v201
    v_dot2_f32_bf16 v198, v66, v196, v198
    v_dot2_f32_bf16 v200, v66, v66, v200
    v_dot2_f32_bf16 v199, v67, v196, v199
    v_dot2_f32_bf16 v201, v67, v67, v201
    s_waitcnt lgkmcnt(6)
    v_dot2_f32_bf16 v198, v68, v196, v198
    v_dot2_f32_bf16 v200, v68, v68, v200
    v_dot2_f32_bf16 v199, v69, v196, v199
    v_dot2_f32_bf16 v201, v69, v69, v201
    v_dot2_f32_bf16 v198, v70, v196, v198
    v_dot2_f32_bf16 v200, v70, v70, v200
    v_dot2_f32_bf16 v199, v71, v196, v199
    v_dot2_f32_bf16 v201, v71, v71, v201
    s_waitcnt lgkmcnt(5)
    v_dot2_f32_bf16 v198, v72, v196, v198
    v_dot2_f32_bf16 v200, v72, v72, v200
    v_dot2_f32_bf16 v199, v73, v196, v199
    v_dot2_f32_bf16 v201, v73, v73, v201
    v_dot2_f32_bf16 v198, v74, v196, v198
    v_dot2_f32_bf16 v200, v74, v74, v200
    v_dot2_f32_bf16 v199, v75, v196, v199
    v_dot2_f32_bf16 v201, v75, v75, v201
    s_waitcnt lgkmcnt(4)
    v_dot2_f32_bf16 v198, v76, v196, v198
    v_dot2_f32_bf16 v200, v76, v76, v200
    v_dot2_f32_bf16 v199, v77, v196, v199
    v_dot2_f32_bf16 v201, v77, v77, v201
    v_dot2_f32_bf16 v198, v78, v196, v198
    v_dot2_f32_bf16 v200, v78, v78, v200
    v_dot2_f32_bf16 v199, v79, v196, v199
    v_dot2_f32_bf16 v201, v79, v79, v201
    s_nop 2
    v_mfma_f32_32x32x16_bf16 v[128:143], a[16:19], v[24:27], v[128:143]
    ds_read_b64_tr_b16 a[8:9], v212 offset:16384
    ds_read_b64_tr_b16 a[10:11], v212 offset:17408
    ds_read_b64_tr_b16 a[12:13], v215 offset:16384
    ds_read_b64_tr_b16 a[14:15], v215 offset:17408
    s_add_u32 s55, s56, 688128
    s_add_u32 m0, s69, 0
    s_nop 0
    buffer_load_dwordx4 v2, s[24:27], s55 offen lds
    s_add_u32 s55, s56, 702464
    s_add_u32 m0, s69, 1024
    s_nop 0
    buffer_load_dwordx4 v2, s[24:27], s55 offen lds
    v_mfma_f32_32x32x16_bf16 v[144:159], a[20:23], v[24:27], v[144:159]
    v_mfma_f32_32x32x16_bf16 v[128:143], a[0:3], v[28:31], v[128:143]
    ds_read_b64_tr_b16 a[16:17], v212 offset:20480
    ds_read_b64_tr_b16 a[18:19], v212 offset:21504
    ds_read_b64_tr_b16 a[20:21], v215 offset:20480
    ds_read_b64_tr_b16 a[22:23], v215 offset:21504
    s_add_u32 s55, s56, 917504
    s_add_u32 m0, s69, 4096
    s_nop 0
    buffer_load_dwordx4 v2, s[24:27], s55 offen lds
    s_add_u32 s55, s56, 931840
    s_add_u32 m0, s69, 5120
    s_nop 0
    buffer_load_dwordx4 v2, s[24:27], s55 offen lds
    v_mfma_f32_32x32x16_bf16 v[144:159], a[4:7], v[28:31], v[144:159]
    s_waitcnt lgkmcnt(6)
    v_mfma_f32_32x32x16_bf16 v[128:143], a[8:11], v[32:35], v[128:143]
    ds_read_b64_tr_b16 a[0:1], v212 offset:24576
    ds_read_b64_tr_b16 a[2:3], v212 offset:25600
    ds_read_b64_tr_b16 a[4:5], v215 offset:24576
    ds_read_b64_tr_b16 a[6:7], v215 offset:25600
    s_mov_b32 s55, 344064
    s_add_u32 m0, s36, 0
    s_nop 0
    buffer_load_dwordx4 v3, s[20:23], s55 offen lds
    s_waitcnt lgkmcnt(8)
    v_mfma_f32_32x32x16_bf16 v[144:159], a[12:15], v[32:35], v[144:159]
    s_waitcnt lgkmcnt(6)
    v_mfma_f32_32x32x16_bf16 v[128:143], a[16:19], v[36:39], v[128:143]
    ds_read_b64_tr_b16 a[8:9], v212 offset:28672
    ds_read_b64_tr_b16 a[10:11], v212 offset:29696
    ds_read_b64_tr_b16 a[12:13], v215 offset:28672
    ds_read_b64_tr_b16 a[14:15], v215 offset:29696
    s_waitcnt lgkmcnt(8)
    v_mfma_f32_32x32x16_bf16 v[144:159], a[20:23], v[36:39], v[144:159]
    s_waitcnt lgkmcnt(0)
    s_waitcnt vmcnt(7)
    s_waitcnt vmcnt(5)
    s_barrier
    ds_read_b128 v[96:99], v8 offset:20480
    ds_read_b128 v[100:103], v9 offset:20480
    ds_read_b128 v[104:107], v10 offset:20480
    ds_read_b128 v[108:111], v11 offset:20480
    ds_read_b128 v[80:83], v8 offset:16384
    ds_read_b128 v[84:87], v9 offset:16384
    ds_read_b128 v[88:91], v10 offset:16384
    ds_read_b128 v[92:95], v11 offset:16384
    s_waitcnt lgkmcnt(7)
    v_dot2_f32_bf16 v198, v96, v196, v198
    v_dot2_f32_bf16 v200, v96, v96, v200
    v_dot2_f32_bf16 v199, v97, v196, v199
    v_dot2_f32_bf16 v201, v97, v97, v201
    v_dot2_f32_bf16 v198, v98, v196, v198
    v_dot2_f32_bf16 v200, v98, v98, v200
    v_dot2_f32_bf16 v199, v99, v196, v199
    v_dot2_f32_bf16 v201, v99, v99, v201
    s_waitcnt lgkmcnt(6)
    v_dot2_f32_bf16 v198, v100, v196, v198
    v_dot2_f32_bf16 v200, v100, v100, v200
    v_dot2_f32_bf16 v199, v101, v196, v199
    v_dot2_f32_bf16 v201, v101, v101, v201
    v_dot2_f32_bf16 v198, v102, v196, v198
    v_dot2_f32_bf16 v200, v102, v102, v200
    v_dot2_f32_bf16 v199, v103, v196, v199
    v_dot2_f32_bf16 v201, v103, v103, v201
    s_waitcnt lgkmcnt(5)
    v_dot2_f32_bf16 v198, v104, v196, v198
    v_dot2_f32_bf16 v200, v104, v104, v200
    v_dot2_f32_bf16 v199, v105, v196, v199
    v_dot2_f32_bf16 v201, v105, v105, v201
    v_dot2_f32_bf16 v198, v106, v196, v198
    v_dot2_f32_bf16 v200, v106, v106, v200
    v_dot2_f32_bf16 v199, v107, v196, v199
    v_dot2_f32_bf16 v201, v107, v107, v201
    s_waitcnt lgkmcnt(4)
    v_dot2_f32_bf16 v198, v108, v196, v198
    v_dot2_f32_bf16 v200, v108, v108, v200
    v_dot2_f32_bf16 v199, v109, v196, v199
    v_dot2_f32_bf16 v201, v109, v109, v201
    v_dot2_f32_bf16 v198, v110, v196, v198
    v_dot2_f32_bf16 v200, v110, v110, v200
    v_dot2_f32_bf16 v199, v111, v196, v199
    v_dot2_f32_bf16 v201, v111, v111, v201
    s_nop 2
    v_mfma_f32_32x32x16_bf16 v[128:143], a[0:3], v[40:43], v[128:143]
    ds_read_b64_tr_b16 a[16:17], v212 offset:32768
    ds_read_b64_tr_b16 a[18:19], v212 offset:33792
    ds_read_b64_tr_b16 a[20:21], v215 offset:32768
    ds_read_b64_tr_b16 a[22:23], v215 offset:33792
    s_add_u32 s55, s56, 1146880
    s_add_u32 m0, s69, 8192
    s_nop 0
    buffer_load_dwordx4 v2, s[24:27], s55 offen lds
    s_add_u32 s55, s56, 1161216
    s_add_u32 m0, s69, 9216
    s_nop 0
    buffer_load_dwordx4 v2, s[24:27], s55 offen lds
    v_mfma_f32_32x32x16_bf16 v[144:159], a[4:7], v[40:43], v[144:159]
    v_mfma_f32_32x32x16_bf16 v[128:143], a[8:11], v[44:47], v[128:143]
    ds_read_b64_tr_b16 a[0:1], v212 offset:36864
    ds_read_b64_tr_b16 a[2:3], v212 offset:37888
    ds_read_b64_tr_b16 a[4:5], v215 offset:36864
    ds_read_b64_tr_b16 a[6:7], v215 offset:37888
    s_add_u32 s55, s56, 1376256
    s_add_u32 m0, s69, 12288
    s_nop 0
    buffer_load_dwordx4 v2, s[24:27], s55 offen lds
    s_add_u32 s55, s56, 1390592
    s_add_u32 m0, s69, 13312
    s_nop 0
    buffer_load_dwordx4 v2, s[24:27], s55 offen lds
    v_mfma_f32_32x32x16_bf16 v[144:159], a[12:15], v[44:47], v[144:159]
    s_waitcnt lgkmcnt(6)
    v_mfma_f32_32x32x16_bf16 v[128:143], a[16:19], v[48:51], v[128:143]
    ds_read_b64_tr_b16 a[8:9], v212 offset:40960
    ds_read_b64_tr_b16 a[10:11], v212 offset:41984
    ds_read_b64_tr_b16 a[12:13], v215 offset:40960
    ds_read_b64_tr_b16 a[14:15], v215 offset:41984
    s_mov_b32 s55, 516096
    s_add_u32 m0, s36, 16384
    s_nop 0
    buffer_load_dwordx4 v3, s[20:23], s55 offen lds
    s_waitcnt lgkmcnt(8)
    v_mfma_f32_32x32x16_bf16 v[144:159], a[20:23], v[48:51], v[144:159]
    s_waitcnt lgkmcnt(6)
    v_mfma_f32_32x32x16_bf16 v[128:143], a[0:3], v[52:55], v[128:143]
    ds_read_b64_tr_b16 a[16:17], v212 offset:45056
    ds_read_b64_tr_b16 a[18:19], v212 offset:46080
    ds_read_b64_tr_b16 a[20:21], v215 offset:45056
    ds_read_b64_tr_b16 a[22:23], v215 offset:46080
    s_waitcnt lgkmcnt(8)
    v_mfma_f32_32x32x16_bf16 v[144:159], a[4:7], v[52:55], v[144:159]
    s_waitcnt lgkmcnt(0)
    s_waitcnt vmcnt(8)
    s_waitcnt vmcnt(6)
    s_barrier
    ds_read_b128 v[112:115], v8 offset:24576
    ds_read_b128 v[116:119], v9 offset:24576
    ds_read_b128 v[120:123], v10 offset:24576
    ds_read_b128 v[124:127], v11 offset:24576
    v_mfma_f32_32x32x16_bf16 v[128:143], a[8:11], v[56:59], v[128:143]
    ds_read_b64_tr_b16 a[0:1], v210 offset:0
    ds_read_b64_tr_b16 a[2:3], v210 offset:1024
    ds_read_b64_tr_b16 a[4:5], v213 offset:0
    ds_read_b64_tr_b16 a[6:7], v213 offset:1024
    s_mov_b32 s55, 0
    s_add_u32 m0, s38, 16384
    s_nop 0
    buffer_load_dwordx4 v3, s[20:23], s55 offen lds
    v_mfma_f32_32x32x16_bf16 v[144:159], a[12:15], v[56:59], v[144:159]
    v_mfma_f32_32x32x16_bf16 v[128:143], a[16:19], v[60:63], v[128:143]
    ds_read_b64_tr_b16 a[8:9], v210 offset:28672
    ds_read_b64_tr_b16 a[10:11], v210 offset:29696
    ds_read_b64_tr_b16 a[12:13], v213 offset:28672
    ds_read_b64_tr_b16 a[14:15], v213 offset:29696
    s_mov_b32 s55, 172032
    s_add_u32 m0, s38, 20480
    s_nop 0
    buffer_load_dwordx4 v3, s[20:23], s55 offen lds
    v_mfma_f32_32x32x16_bf16 v[144:159], a[20:23], v[60:63], v[144:159]
    s_waitcnt lgkmcnt(6)
    v_mfma_f32_32x32x16_bf16 v[128:143], a[0:3], v[64:67], v[128:143]
    ds_read_b64_tr_b16 a[16:17], v211 offset:0
    ds_read_b64_tr_b16 a[18:19], v211 offset:1024
    ds_read_b64_tr_b16 a[20:21], v214 offset:0
    ds_read_b64_tr_b16 a[22:23], v214 offset:1024
    s_mov_b32 s55, 688128
    s_add_u32 m0, s36, 32768
    s_nop 0
    buffer_load_dwordx4 v3, s[20:23], s55 offen lds
    s_waitcnt lgkmcnt(8)
    v_mfma_f32_32x32x16_bf16 v[144:159], a[4:7], v[64:67], v[144:159]
    s_waitcnt lgkmcnt(6)
    v_mfma_f32_32x32x16_bf16 v[128:143], a[8:11], v[68:71], v[128:143]
    ds_read_b64_tr_b16 a[0:1], v211 offset:28672
    ds_read_b64_tr_b16 a[2:3], v211 offset:29696
    ds_read_b64_tr_b16 a[4:5], v214 offset:28672
    ds_read_b64_tr_b16 a[6:7], v214 offset:29696
    s_waitcnt lgkmcnt(8)
    v_mfma_f32_32x32x16_bf16 v[144:159], a[12:15], v[68:71], v[144:159]
    s_waitcnt lgkmcnt(6)
    v_mfma_f32_32x32x16_bf16 v[128:143], a[16:19], v[72:75], v[128:143]
    ds_read_b64_tr_b16 a[8:9], v210 offset:4096
    ds_read_b64_tr_b16 a[10:11], v210 offset:5120
    ds_read_b64_tr_b16 a[12:13], v213 offset:4096
    ds_read_b64_tr_b16 a[14:15], v213 offset:5120
    s_waitcnt lgkmcnt(8)
    v_mfma_f32_32x32x16_bf16 v[144:159], a[20:23], v[72:75], v[144:159]
    s_waitcnt lgkmcnt(6)
    v_mfma_f32_32x32x16_bf16 v[128:143], a[0:3], v[76:79], v[128:143]
    ds_read_b64_tr_b16 a[16:17], v210 offset:32768
    ds_read_b64_tr_b16 a[18:19], v210 offset:33792
    ds_read_b64_tr_b16 a[20:21], v213 offset:32768
    ds_read_b64_tr_b16 a[22:23], v213 offset:33792
    s_waitcnt lgkmcnt(8)
    v_mfma_f32_32x32x16_bf16 v[144:159], a[4:7], v[76:79], v[144:159]
    s_waitcnt lgkmcnt(6)
    v_mfma_f32_32x32x16_bf16 v[128:143], a[8:11], v[80:83], v[128:143]
    ds_read_b64_tr_b16 a[0:1], v211 offset:4096
    ds_read_b64_tr_b16 a[2:3], v211 offset:5120
    ds_read_b64_tr_b16 a[4:5], v214 offset:4096
    ds_read_b64_tr_b16 a[6:7], v214 offset:5120
    s_waitcnt lgkmcnt(8)
    v_mfma_f32_32x32x16_bf16 v[144:159], a[12:15], v[80:83], v[144:159]
    s_waitcnt lgkmcnt(6)
    v_mfma_f32_32x32x16_bf16 v[128:143], a[16:19], v[84:87], v[128:143]
    ds_read_b64_tr_b16 a[8:9], v211 offset:32768
    ds_read_b64_tr_b16 a[10:11], v211 offset:33792
    ds_read_b64_tr_b16 a[12:13], v214 offset:32768
    ds_read_b64_tr_b16 a[14:15], v214 offset:33792
    s_waitcnt lgkmcnt(8)
    v_mfma_f32_32x32x16_bf16 v[144:159], a[20:23], v[84:87], v[144:159]
    s_waitcnt lgkmcnt(0)
    s_waitcnt vmcnt(6)
    s_waitcnt vmcnt(4)
    s_barrier
    v_mfma_f32_32x32x16_bf16 v[128:143], a[0:3], v[88:91], v[128:143]
    ds_read_b64_tr_b16 a[16:17], v210 offset:8192
    ds_read_b64_tr_b16 a[18:19], v210 offset:9216
    ds_read_b64_tr_b16 a[20:21], v213 offset:8192
    ds_read_b64_tr_b16 a[22:23], v213 offset:9216
    v_mfma_f32_32x32x16_bf16 v[144:159], a[4:7], v[88:91], v[144:159]
    v_mfma_f32_32x32x16_bf16 v[128:143], a[8:11], v[92:95], v[128:143]
    ds_read_b64_tr_b16 a[0:1], v210 offset:36864
    ds_read_b64_tr_b16 a[2:3], v210 offset:37888
    ds_read_b64_tr_b16 a[4:5], v213 offset:36864
    ds_read_b64_tr_b16 a[6:7], v213 offset:37888
    v_mfma_f32_32x32x16_bf16 v[144:159], a[12:15], v[92:95], v[144:159]
    s_waitcnt lgkmcnt(6)
    v_mfma_f32_32x32x16_bf16 v[128:143], a[16:19], v[96:99], v[128:143]
    ds_read_b64_tr_b16 a[8:9], v211 offset:8192
    ds_read_b64_tr_b16 a[10:11], v211 offset:9216
    ds_read_b64_tr_b16 a[12:13], v214 offset:8192
    ds_read_b64_tr_b16 a[14:15], v214 offset:9216
    s_waitcnt lgkmcnt(8)
    v_mfma_f32_32x32x16_bf16 v[144:159], a[20:23], v[96:99], v[144:159]
    s_waitcnt lgkmcnt(6)
    v_mfma_f32_32x32x16_bf16 v[128:143], a[0:3], v[100:103], v[128:143]
    ds_read_b64_tr_b16 a[16:17], v211 offset:36864
    ds_read_b64_tr_b16 a[18:19], v211 offset:37888
    ds_read_b64_tr_b16 a[20:21], v214 offset:36864
    ds_read_b64_tr_b16 a[22:23], v214 offset:37888
    s_waitcnt lgkmcnt(8)
    v_mfma_f32_32x32x16_bf16 v[144:159], a[4:7], v[100:103], v[144:159]
    v_add_f32 v198, v198, v199
    v_add_f32 v199, v200, v201
    v_mov_b32 v200, v198
    v_mov_b32 v201, v199
    s_nop 0
    v_permlane32_swap_b32 v198, v200
    v_permlane32_swap_b32 v199, v201
    v_and_b32 v206, 31, v0
    v_lshlrev_b32 v206, 3, v206
    v_add_u32 v206, s53, v206
    v_add_f32 v198, v198, v200
    v_add_f32 v199, v199, v201
    ds_write_b64 v206, v[198:199] offset:24832
    s_waitcnt lgkmcnt(0)
    s_waitcnt vmcnt(2)
    s_waitcnt vmcnt(1)
    s_waitcnt vmcnt(0)
    s_barrier
    ds_read_b64 v[200:201], v206 offset:24576
    v_mov_b32 v207, 112640
    ds_read_b32 v203, v207
    v_mfma_f32_32x32x16_bf16 v[128:143], a[8:11], v[104:107], v[128:143]
    ds_read_b64_tr_b16 a[0:1], v210 offset:12288
    ds_read_b64_tr_b16 a[2:3], v210 offset:13312
    ds_read_b64_tr_b16 a[4:5], v213 offset:12288
    ds_read_b64_tr_b16 a[6:7], v213 offset:13312
    s_mov_b32 s55, 860160
    s_add_u32 m0, s38, 0
    s_nop 0
    buffer_load_dwordx4 v3, s[20:23], s55 offen lds
    v_mfma_f32_32x32x16_bf16 v[144:159], a[12:15], v[104:107], v[144:159]
    v_mfma_f32_32x32x16_bf16 v[128:143], a[16:19], v[108:111], v[128:143]
    ds_read_b64_tr_b16 a[8:9], v210 offset:40960
    ds_read_b64_tr_b16 a[10:11], v210 offset:41984
    ds_read_b64_tr_b16 a[12:13], v213 offset:40960
    ds_read_b64_tr_b16 a[14:15], v213 offset:41984
    s_mov_b32 s55, 1032192
    s_add_u32 m0, s38, 4096
    s_nop 0
    buffer_load_dwordx4 v3, s[20:23], s55 offen lds
    v_mfma_f32_32x32x16_bf16 v[144:159], a[20:23], v[108:111], v[144:159]
    s_waitcnt lgkmcnt(9)
    v_add_f32 v198, v198, v200
    v_add_f32 v199, v199, v201
    v_mul_f32 v198, 0x3b124925, v198
    v_mul_f32 v199, 0x3b124925, v199
    v_fma_f32 v199, -v198, v198, v199
    v_max_f32 v199, 0, v199
    v_add_f32 v199, 0x3727c5ac, v199
    v_rsq_f32 v12, v199
    v_sub_f32 v13, 0, v198
    v_mul_f32 v208, 0x3eeff558, v12
    s_waitcnt lgkmcnt(6)
    v_mfma_f32_32x32x16_bf16 v[128:143], a[0:3], v[112:115], v[128:143]
    ds_read_b64_tr_b16 a[16:17], v211 offset:12288
    ds_read_b64_tr_b16 a[18:19], v211 offset:13312
    ds_read_b64_tr_b16 a[20:21], v214 offset:12288
    ds_read_b64_tr_b16 a[22:23], v214 offset:13312
    s_waitcnt lgkmcnt(8)
    v_mfma_f32_32x32x16_bf16 v[144:159], a[4:7], v[112:115], v[144:159]
    s_waitcnt lgkmcnt(6)
    v_mfma_f32_32x32x16_bf16 v[128:143], a[8:11], v[116:119], v[128:143]
    ds_read_b64_tr_b16 a[0:1], v211 offset:40960
    ds_read_b64_tr_b16 a[2:3], v211 offset:41984
    ds_read_b64_tr_b16 a[4:5], v214 offset:40960
    ds_read_b64_tr_b16 a[6:7], v214 offset:41984
    s_waitcnt lgkmcnt(8)
    v_mfma_f32_32x32x16_bf16 v[144:159], a[12:15], v[116:119], v[144:159]
    s_lshl_b32 s40, s49, 2
    s_add_u32 s40, s40, 44
    s_and_b32 s41, s40, 0xfffc
    s_add_u32 s41, s41, 128
    s_mul_i32 s40, s40, 192
    s_add_u32 s40, s40, 22020096
    s_mov_b32 s61, 0
L_k1_cs1_0:
    v_mov_b32 v207, s41
    buffer_load_dword v204, v207, s[44:47], 0 offen sc0 sc1
    buffer_load_dwordx4 v[216:219], v193, s[28:31], s40 offen offset:0 sc0 sc1
    buffer_load_dwordx4 v[220:223], v193, s[28:31], s40 offen offset:16 sc0 sc1
    buffer_load_dwordx4 v[224:227], v193, s[28:31], s40 offen offset:32 sc0 sc1
    buffer_load_dwordx4 v[228:231], v193, s[28:31], s40 offen offset:48 sc0 sc1
    buffer_load_dwordx4 v[198:201], v193, s[28:31], s40 offen offset:64 sc0 sc1
    buffer_load_dwordx4 v[8:11], v193, s[28:31], s40 offen offset:80 sc0 sc1
    s_waitcnt lgkmcnt(6)
    v_mfma_f32_32x32x16_bf16 v[128:143], a[16:19], v[120:123], v[128:143]
    ds_read_b64_tr_b16 a[8:9], v5 offset:16448
    ds_read_b64_tr_b16 a[10:11], v5 offset:17216
    s_waitcnt lgkmcnt(6)
    v_mfma_f32_32x32x16_bf16 v[144:159], a[20:23], v[120:123], v[144:159]
    s_waitcnt lgkmcnt(4)
    v_mfma_f32_32x32x16_bf16 v[128:143], a[0:3], v[124:127], v[128:143]
    ds_read_b64_tr_b16 a[16:17], v5 offset:45120
    ds_read_b64_tr_b16 a[18:19], v5 offset:45888
    s_waitcnt lgkmcnt(4)
    v_mfma_f32_32x32x16_bf16 v[144:159], a[4:7], v[124:127], v[144:159]
    s_waitcnt lgkmcnt(2)
    v_mfma_f32_32x32x16_bf16 v[160:175], a[8:11], v[16:19], 0
    ds_read_b64_tr_b16 a[0:1], v6 offset:16448
    ds_read_b64_tr_b16 a[2:3], v6 offset:17216
L_k1_cs1_0_chk:
    s_waitcnt vmcnt(5)
    v_xor_b32 v207, v219, v204
    s_waitcnt vmcnt(4)
    v_xor_b32 v205, v223, v204
    v_or_b32 v207, v207, v205
    s_waitcnt vmcnt(3)
    v_xor_b32 v205, v227, v204
    v_or_b32 v207, v207, v205
    s_waitcnt vmcnt(2)
    v_xor_b32 v205, v231, v204
    v_or_b32 v207, v207, v205
    s_waitcnt vmcnt(1)
    v_xor_b32 v205, v201, v204
    v_or_b32 v207, v207, v205
    s_waitcnt vmcnt(0)
    v_xor_b32 v205, v11, v204
    v_or_b32 v207, v207, v205
    v_cmp_ne_u32 vcc, 0, v207
    v_cmp_eq_u32 s[62:63], 0, v204
    s_nop 0
    s_or_b64 vcc, vcc, s[62:63]
    s_add_u32 s61, s61, 1
    s_cmp_eq_u64 vcc, 0
    s_cbranch_scc1 L_k1_cs1_0_ok
    s_sleep 4
    v_mov_b32 v207, s41
    buffer_load_dword v204, v207, s[44:47], 0 offen sc0 sc1
    buffer_load_dwordx4 v[216:219], v193, s[28:31], s40 offen offset:0 sc0 sc1
    buffer_load_dwordx4 v[220:223], v193, s[28:31], s40 offen offset:16 sc0 sc1
    buffer_load_dwordx4 v[224:227], v193, s[28:31], s40 offen offset:32 sc0 sc1
    buffer_load_dwordx4 v[228:231], v193, s[28:31], s40 offen offset:48 sc0 sc1
    buffer_load_dwordx4 v[198:201], v193, s[28:31], s40 offen offset:64 sc0 sc1
    buffer_load_dwordx4 v[8:11], v193, s[28:31], s40 offen offset:80 sc0 sc1
    s_cmp_lt_u32 s61, 0x40000
    s_cbranch_scc1 L_k1_cs1_0_chk
L_k1_cs1_0_ok:
    v_fma_f32 v128, v13, v216, v128
    v_fma_f32 v129, v13, v217, v129
    v_fma_f32 v130, v13, v218, v130
    v_fma_f32 v131, v13, v220, v131
    v_fma_f32 v132, v13, v221, v132
    v_fma_f32 v133, v13, v222, v133
    v_fma_f32 v134, v13, v224, v134
    v_fma_f32 v135, v13, v225, v135
    v_fma_f32 v136, v13, v226, v136
    v_fma_f32 v137, v13, v228, v137
    v_fma_f32 v138, v13, v229, v138
    v_fma_f32 v139, v13, v230, v139
    v_fma_f32 v140, v13, v198, v140
    v_fma_f32 v141, v13, v199, v141
    v_fma_f32 v142, v13, v200, v142
    v_fma_f32 v143, v13, v8, v143
    v_mul_f32 v128, v128, v208
    s_waitcnt lgkmcnt(2)
    v_mfma_f32_32x32x16_bf16 v[160:175], a[16:19], v[20:23], v[160:175]
    ds_read_b64_tr_b16 a[8:9], v6 offset:45120
    ds_read_b64_tr_b16 a[10:11], v6 offset:45888
    v_mul_f32 v129, v129, v208
    v_mul_f32 v130, v130, v208
    v_mul_f32 v131, v131, v208
    v_mul_f32 v132, v132, v208
    v_mul_f32 v133, v133, v208
    v_mul_f32 v134, v134, v208
    v_mul_f32 v135, v135, v208
    v_mul_f32 v136, v136, v208
    v_mul_f32 v137, v137, v208
    v_mul_f32 v138, v138, v208
    v_mul_f32 v139, v139, v208
    v_mul_f32 v140, v140, v208
    v_mul_f32 v141, v141, v208
    v_mul_f32 v142, v142, v208
    v_mul_f32 v143, v143, v208
    s_add_u32 s40, s40, 192
    s_mov_b32 s61, 0
L_k1_cs1_1:
    v_mov_b32 v207, s41
    buffer_load_dword v204, v207, s[44:47], 0 offen sc0 sc1
    buffer_load_dwordx4 v[216:219], v193, s[28:31], s40 offen offset:0 sc0 sc1
    buffer_load_dwordx4 v[220:223], v193, s[28:31], s40 offen offset:16 sc0 sc1
    buffer_load_dwordx4 v[224:227], v193, s[28:31], s40 offen offset:32 sc0 sc1
    buffer_load_dwordx4 v[228:231], v193, s[28:31], s40 offen offset:48 sc0 sc1
    buffer_load_dwordx4 v[198:201], v193, s[28:31], s40 offen offset:64 sc0 sc1
    buffer_load_dwordx4 v[8:11], v193, s[28:31], s40 offen offset:80 sc0 sc1
    v_fma_f32 v194, v128, v128, v14
    v_fma_f32 v195, v129, v129, v14
    s_waitcnt lgkmcnt(2)
    v_mfma_f32_32x32x16_bf16 v[160:175], a[0:3], v[24:27], v[160:175]
    ds_read_b64_tr_b16 a[16:17], v5 offset:20544
    ds_read_b64_tr_b16 a[18:19], v5 offset:21312
    v_mul_f32 v194, v194, v128
    v_mul_f32 v195, v195, v129
    v_exp_f32_e64 v194, -v194
    v_exp_f32_e64 v195, -v195
    v_add_f32 v194, 1.0, v194
    v_add_f32 v195, 1.0, v195
    v_rcp_f32 v194, v194
    v_rcp_f32 v195, v195
    v_mul_f32 v128, v128, v194
    v_mul_f32 v129, v129, v195
    v_add_f32 v15, v15, v128
    v_fmac_f32 v192, v128, v128
    v_add_f32 v15, v15, v129
    v_fmac_f32 v192, v129, v129
    v_fma_f32 v196, v130, v130, v14
    v_fma_f32 v197, v131, v131, v14
    v_mul_f32 v196, v196, v130
    v_mul_f32 v197, v197, v131
    s_waitcnt lgkmcnt(2)
    v_mfma_f32_32x32x16_bf16 v[160:175], a[8:11], v[28:31], v[160:175]
    ds_read_b64_tr_b16 a[0:1], v5 offset:49216
    ds_read_b64_tr_b16 a[2:3], v5 offset:49984
    v_exp_f32_e64 v196, -v196
    v_exp_f32_e64 v197, -v197
    v_add_f32 v196, 1.0, v196
    v_add_f32 v197, 1.0, v197
    v_rcp_f32 v196, v196
    v_rcp_f32 v197, v197
    v_mul_f32 v130, v130, v196
    v_mul_f32 v131, v131, v197
    v_add_f32 v15, v15, v130
    v_fmac_f32 v192, v130, v130
    v_add_f32 v15, v15, v131
    v_fmac_f32 v192, v131, v131
    v_fma_f32 v194, v132, v132, v14
    v_fma_f32 v195, v133, v133, v14
    v_mul_f32 v194, v194, v132
    v_mul_f32 v195, v195, v133
    v_exp_f32_e64 v194, -v194
    v_exp_f32_e64 v195, -v195
    s_waitcnt lgkmcnt(2)
    v_mfma_f32_32x32x16_bf16 v[160:175], a[16:19], v[32:35], v[160:175]
    ds_read_b64_tr_b16 a[8:9], v6 offset:20544
    ds_read_b64_tr_b16 a[10:11], v6 offset:21312
    v_add_f32 v194, 1.0, v194
    v_add_f32 v195, 1.0, v195
    v_rcp_f32 v194, v194
    v_rcp_f32 v195, v195
    v_mul_f32 v132, v132, v194
    v_mul_f32 v133, v133, v195
    v_add_f32 v15, v15, v132
    v_fmac_f32 v192, v132, v132
    v_add_f32 v15, v15, v133
    v_fmac_f32 v192, v133, v133
    v_fma_f32 v196, v134, v134, v14
    v_fma_f32 v197, v135, v135, v14
    v_mul_f32 v196, v196, v134
    v_mul_f32 v197, v197, v135
    v_exp_f32_e64 v196, -v196
    v_exp_f32_e64 v197, -v197
    v_add_f32 v196, 1.0, v196
    v_add_f32 v197, 1.0, v197
    s_waitcnt lgkmcnt(2)
    v_mfma_f32_32x32x16_bf16 v[160:175], a[0:3], v[36:39], v[160:175]
    ds_read_b64_tr_b16 a[16:17], v6 offset:49216
    ds_read_b64_tr_b16 a[18:19], v6 offset:49984
    v_rcp_f32 v196, v196
    v_rcp_f32 v197, v197
    v_mul_f32 v134, v134, v196
    v_mul_f32 v135, v135, v197
    v_add_f32 v15, v15, v134
    v_fmac_f32 v192, v134, v134
    v_add_f32 v15, v15, v135
    v_fmac_f32 v192, v135, v135
    v_fma_f32 v194, v136, v136, v14
    v_fma_f32 v195, v137, v137, v14
    v_mul_f32 v194, v194, v136
    v_mul_f32 v195, v195, v137
    v_exp_f32_e64 v194, -v194
    v_exp_f32_e64 v195, -v195
    v_add_f32 v194, 1.0, v194
    v_add_f32 v195, 1.0, v195
    v_rcp_f32 v194, v194
    v_rcp_f32 v195, v195
    s_waitcnt lgkmcnt(2)
    v_mfma_f32_32x32x16_bf16 v[160:175], a[8:11], v[40:43], v[160:175]
    ds_read_b64_tr_b16 a[0:1], v7 offset:64
    ds_read_b64_tr_b16 a[2:3], v7 offset:832
    v_mul_f32 v136, v136, v194
    v_mul_f32 v137, v137, v195
    v_add_f32 v15, v15, v136
    v_fmac_f32 v192, v136, v136
    v_add_f32 v15, v15, v137
    v_fmac_f32 v192, v137, v137
    v_fma_f32 v196, v138, v138, v14
    v_fma_f32 v197, v139, v139, v14
    v_mul_f32 v196, v196, v138
    v_mul_f32 v197, v197, v139
    v_exp_f32_e64 v196, -v196
    v_exp_f32_e64 v197, -v197
    v_add_f32 v196, 1.0, v196
    v_add_f32 v197, 1.0, v197
    v_rcp_f32 v196, v196
    v_rcp_f32 v197, v197
    v_mul_f32 v138, v138, v196
    v_mul_f32 v139, v139, v197
    s_waitcnt lgkmcnt(2)
    v_mfma_f32_32x32x16_bf16 v[160:175], a[16:19], v[44:47], v[160:175]
    ds_read_b64_tr_b16 a[8:9], v7 offset:4160
    ds_read_b64_tr_b16 a[10:11], v7 offset:4928
    v_add_f32 v15, v15, v138
    v_fmac_f32 v192, v138, v138
    v_add_f32 v15, v15, v139
    v_fmac_f32 v192, v139, v139
    v_fma_f32 v194, v140, v140, v14
    v_fma_f32 v195, v141, v141, v14
    v_mul_f32 v194, v194, v140
    v_mul_f32 v195, v195, v141
    v_exp_f32_e64 v194, -v194
    v_exp_f32_e64 v195, -v195
    v_add_f32 v194, 1.0, v194
    v_add_f32 v195, 1.0, v195
    v_rcp_f32 v194, v194
    v_rcp_f32 v195, v195
    v_mul_f32 v140, v140, v194
    v_mul_f32 v141, v141, v195
    v_add_f32 v15, v15, v140
    v_fmac_f32 v192, v140, v140
    s_waitcnt lgkmcnt(2)
    v_mfma_f32_32x32x16_bf16 v[160:175], a[0:3], v[48:51], v[160:175]
    ds_read_b64_tr_b16 a[16:17], v7 offset:8256
    ds_read_b64_tr_b16 a[18:19], v7 offset:9024
    v_add_f32 v15, v15, v141
    v_fmac_f32 v192, v141, v141
    v_fma_f32 v196, v142, v142, v14
    v_fma_f32 v197, v143, v143, v14
    v_mul_f32 v196, v196, v142
    v_mul_f32 v197, v197, v143
    v_exp_f32_e64 v196, -v196
    v_exp_f32_e64 v197, -v197
    v_add_f32 v196, 1.0, v196
    v_add_f32 v197, 1.0, v197
    v_rcp_f32 v196, v196
    v_rcp_f32 v197, v197
    v_mul_f32 v142, v142, v196
    v_mul_f32 v143, v143, v197
    v_add_f32 v15, v15, v142
    v_fmac_f32 v192, v142, v142
    v_add_f32 v15, v15, v143
    v_fmac_f32 v192, v143, v143
    s_waitcnt lgkmcnt(2)
    v_mfma_f32_32x32x16_bf16 v[160:175], a[8:11], v[52:55], v[160:175]
    ds_read_b64_tr_b16 a[0:1], v7 offset:12352
    ds_read_b64_tr_b16 a[2:3], v7 offset:13120
L_k1_cs1_1_chk:
    s_waitcnt vmcnt(5)
    v_xor_b32 v207, v219, v204
    s_waitcnt vmcnt(4)
    v_xor_b32 v205, v223, v204
    v_or_b32 v207, v207, v205
    s_waitcnt vmcnt(3)
    v_xor_b32 v205, v227, v204
    v_or_b32 v207, v207, v205
    s_waitcnt vmcnt(2)
    v_xor_b32 v205, v231, v204
    v_or_b32 v207, v207, v205
    s_waitcnt vmcnt(1)
    v_xor_b32 v205, v201, v204
    v_or_b32 v207, v207, v205
    s_waitcnt vmcnt(0)
    v_xor_b32 v205, v11, v204
    v_or_b32 v207, v207, v205
    v_cmp_ne_u32 vcc, 0, v207
    v_cmp_eq_u32 s[62:63], 0, v204
    s_nop 0
    s_or_b64 vcc, vcc, s[62:63]
    s_add_u32 s61, s61, 1
    s_cmp_eq_u64 vcc, 0
    s_cbranch_scc1 L_k1_cs1_1_ok
    s_sleep 4
    v_mov_b32 v207, s41
    buffer_load_dword v204, v207, s[44:47], 0 offen sc0 sc1
    buffer_load_dwordx4 v[216:219], v193, s[28:31], s40 offen offset:0 sc0 sc1
    buffer_load_dwordx4 v[220:223], v193, s[28:31], s40 offen offset:16 sc0 sc1
    buffer_load_dwordx4 v[224:227], v193, s[28:31], s40 offen offset:32 sc0 sc1
    buffer_load_dwordx4 v[228:231], v193, s[28:31], s40 offen offset:48 sc0 sc1
    buffer_load_dwordx4 v[198:201], v193, s[28:31], s40 offen offset:64 sc0 sc1
    buffer_load_dwordx4 v[8:11], v193, s[28:31], s40 offen offset:80 sc0 sc1
    s_cmp_lt_u32 s61, 0x40000
    s_cbranch_scc1 L_k1_cs1_1_chk
L_k1_cs1_1_ok:
    v_fma_f32 v144, v13, v216, v144
    v_fma_f32 v145, v13, v217, v145
    v_fma_f32 v146, v13, v218, v146
    v_fma_f32 v147, v13, v220, v147
    v_fma_f32 v148, v13, v221, v148
    v_fma_f32 v149, v13, v222, v149
    v_fma_f32 v150, v13, v224, v150
    v_fma_f32 v151, v13, v225, v151
    v_fma_f32 v152, v13, v226, v152
    v_fma_f32 v153, v13, v228, v153
    v_fma_f32 v154, v13, v229, v154
    v_fma_f32 v155, v13, v230, v155
    v_fma_f32 v156, v13, v198, v156
    v_fma_f32 v157, v13, v199, v157
    v_fma_f32 v158, v13, v200, v158
    v_fma_f32 v159, v13, v8, v159
    v_mul_f32 v144, v144, v208
    s_waitcnt lgkmcnt(2)
    v_mfma_f32_32x32x16_bf16 v[160:175], a[16:19], v[56:59], v[160:175]
    ds_read_b64_tr_b16 a[8:9], v7 offset:16448
    ds_read_b64_tr_b16 a[10:11], v7 offset:17216
    v_mul_f32 v145, v145, v208
    v_mul_f32 v146, v146, v208
    v_mul_f32 v147, v147, v208
    v_mul_f32 v148, v148, v208
    v_mul_f32 v149, v149, v208
    v_mul_f32 v150, v150, v208
    v_mul_f32 v151, v151, v208
    v_mul_f32 v152, v152, v208
    v_mul_f32 v153, v153, v208
    v_mul_f32 v154, v154, v208
    v_mul_f32 v155, v155, v208
    v_mul_f32 v156, v156, v208
    v_mul_f32 v157, v157, v208
    v_mul_f32 v158, v158, v208
    v_mul_f32 v159, v159, v208
    s_lshl_b32 s40, s49, 1
    s_add_u32 s40, s40, 1
    s_and_b32 s41, s40, 0xfffc
    s_add_u32 s41, s41, 128
    s_mul_i32 s40, s40, 192
    s_add_u32 s40, s40, 22020096
    s_mov_b32 s61, 0
L_k1_cs1_2:
    v_mov_b32 v207, s41
    buffer_load_dword v204, v207, s[44:47], 0 offen sc0 sc1
    buffer_load_dwordx4 v[216:219], v193, s[28:31], s40 offen offset:0 sc0 sc1
    buffer_load_dwordx4 v[220:223], v193, s[28:31], s40 offen offset:16 sc0 sc1
    buffer_load_dwordx4 v[224:227], v193, s[28:31], s40 offen offset:32 sc0 sc1
    buffer_load_dwordx4 v[228:231], v193, s[28:31], s40 offen offset:48 sc0 sc1
    buffer_load_dwordx4 v[198:201], v193, s[28:31], s40 offen offset:64 sc0 sc1
    buffer_load_dwordx4 v[8:11], v193, s[28:31], s40 offen offset:80 sc0 sc1
    v_fma_f32 v194, v144, v144, v14
    v_fma_f32 v195, v145, v145, v14
    s_waitcnt lgkmcnt(2)
    v_mfma_f32_32x32x16_bf16 v[160:175], a[0:3], v[60:63], v[160:175]
    ds_read_b64_tr_b16 a[16:17], v7 offset:20544
    ds_read_b64_tr_b16 a[18:19], v7 offset:21312
    v_mul_f32 v194, v194, v144
    v_mul_f32 v195, v195, v145
    v_exp_f32_e64 v194, -v194
    v_exp_f32_e64 v195, -v195
    v_add_f32 v194, 1.0, v194
    v_add_f32 v195, 1.0, v195
    v_rcp_f32 v194, v194
    v_rcp_f32 v195, v195
    v_mul_f32 v144, v144, v194
    v_mul_f32 v145, v145, v195
    v_add_f32 v15, v15, v144
    v_fmac_f32 v192, v144, v144
    v_add_f32 v15, v15, v145
    v_fmac_f32 v192, v145, v145
    v_fma_f32 v196, v146, v146, v14
    v_fma_f32 v197, v147, v147, v14
    v_mul_f32 v196, v196, v146
    v_mul_f32 v197, v197, v147
    s_waitcnt lgkmcnt(2)
    v_mfma_f32_32x32x16_bf16 v[160:175], a[8:11], v[64:67], v[160:175]
    ds_read_b64_tr_b16 a[0:1], v7 offset:24640
    ds_read_b64_tr_b16 a[2:3], v7 offset:25408
    v_exp_f32_e64 v196, -v196
    v_exp_f32_e64 v197, -v197
    v_add_f32 v196, 1.0, v196
    v_add_f32 v197, 1.0, v197
    v_rcp_f32 v196, v196
    v_rcp_f32 v197, v197
    v_mul_f32 v146, v146, v196
    v_mul_f32 v147, v147, v197
    v_add_f32 v15, v15, v146
    v_fmac_f32 v192, v146, v146
    v_add_f32 v15, v15, v147
    v_fmac_f32 v192, v147, v147
    v_fma_f32 v194, v148, v148, v14
    v_fma_f32 v195, v149, v149, v14
    v_mul_f32 v194, v194, v148
    v_mul_f32 v195, v195, v149
    v_exp_f32_e64 v194, -v194
    v_exp_f32_e64 v195, -v195
    s_waitcnt lgkmcnt(2)
    v_mfma_f32_32x32x16_bf16 v[160:175], a[16:19], v[68:71], v[160:175]
    ds_read_b64_tr_b16 a[8:9], v7 offset:28736
    ds_read_b64_tr_b16 a[10:11], v7 offset:29504
    v_add_f32 v194, 1.0, v194
    v_add_f32 v195, 1.0, v195
    v_rcp_f32 v194, v194
    v_rcp_f32 v195, v195
    v_mul_f32 v148, v148, v194
    v_mul_f32 v149, v149, v195
    v_add_f32 v15, v15, v148
    v_fmac_f32 v192, v148, v148
    v_add_f32 v15, v15, v149
    v_fmac_f32 v192, v149, v149
    v_fma_f32 v196, v150, v150, v14
    v_fma_f32 v197, v151, v151, v14
    v_mul_f32 v196, v196, v150
    v_mul_f32 v197, v197, v151
    v_exp_f32_e64 v196, -v196
    v_exp_f32_e64 v197, -v197
    v_add_f32 v196, 1.0, v196
    v_add_f32 v197, 1.0, v197
    s_waitcnt lgkmcnt(0)
    s_barrier
    v_mfma_f32_32x32x16_bf16 v[160:175], a[0:3], v[72:75], v[160:175]
    ds_read_b64_tr_b16 a[16:17], v7 offset:32832
    ds_read_b64_tr_b16 a[18:19], v7 offset:33600
    v_rcp_f32 v196, v196
    v_rcp_f32 v197, v197
    v_mul_f32 v150, v150, v196
    v_mul_f32 v151, v151, v197
    v_add_f32 v15, v15, v150
    v_fmac_f32 v192, v150, v150
    v_add_f32 v15, v15, v151
    v_fmac_f32 v192, v151, v151
    v_fma_f32 v194, v152, v152, v14
    v_fma_f32 v195, v153, v153, v14
    v_mul_f32 v194, v194, v152
    v_mul_f32 v195, v195, v153
    v_exp_f32_e64 v194, -v194
    v_exp_f32_e64 v195, -v195
    v_add_f32 v194, 1.0, v194
    v_add_f32 v195, 1.0, v195
    v_rcp_f32 v194, v194
    v_rcp_f32 v195, v195
    v_mfma_f32_32x32x16_bf16 v[160:175], a[8:11], v[76:79], v[160:175]
    ds_read_b64_tr_b16 a[0:1], v7 offset:36928
    ds_read_b64_tr_b16 a[2:3], v7 offset:37696
    v_mul_f32 v152, v152, v194
    v_mul_f32 v153, v153, v195
    v_add_f32 v15, v15, v152
    v_fmac_f32 v192, v152, v152
    v_add_f32 v15, v15, v153
    v_fmac_f32 v192, v153, v153
    v_fma_f32 v196, v154, v154, v14
    v_fma_f32 v197, v155, v155, v14
    v_mul_f32 v196, v196, v154
    v_mul_f32 v197, v197, v155
    v_exp_f32_e64 v196, -v196
    v_exp_f32_e64 v197, -v197
    v_add_f32 v196, 1.0, v196
    v_add_f32 v197, 1.0, v197
    v_rcp_f32 v196, v196
    v_rcp_f32 v197, v197
    v_mul_f32 v154, v154, v196
    v_mul_f32 v155, v155, v197
    s_waitcnt lgkmcnt(2)
    v_mfma_f32_32x32x16_bf16 v[160:175], a[16:19], v[80:83], v[160:175]
    ds_read_b64_tr_b16 a[8:9], v7 offset:41024
    ds_read_b64_tr_b16 a[10:11], v7 offset:41792
    v_add_f32 v15, v15, v154
    v_fmac_f32 v192, v154, v154
    v_add_f32 v15, v15, v155
    v_fmac_f32 v192, v155, v155
    v_fma_f32 v194, v156, v156, v14
    v_fma_f32 v195, v157, v157, v14
    v_mul_f32 v194, v194, v156
    v_mul_f32 v195, v195, v157
    v_exp_f32_e64 v194, -v194
    v_exp_f32_e64 v195, -v195
    v_add_f32 v194, 1.0, v194
    v_add_f32 v195, 1.0, v195
    v_rcp_f32 v194, v194
    v_rcp_f32 v195, v195
    v_mul_f32 v156, v156, v194
    v_mul_f32 v157, v157, v195
    v_add_f32 v15, v15, v156
    v_fmac_f32 v192, v156, v156
    s_waitcnt lgkmcnt(2)
    v_mfma_f32_32x32x16_bf16 v[160:175], a[0:3], v[84:87], v[160:175]
    ds_read_b64_tr_b16 a[16:17], v7 offset:45120
    ds_read_b64_tr_b16 a[18:19], v7 offset:45888
    v_add_f32 v15, v15, v157
    v_fmac_f32 v192, v157, v157
    v_fma_f32 v196, v158, v158, v14
    v_fma_f32 v197, v159, v159, v14
    v_mul_f32 v196, v196, v158
    v_mul_f32 v197, v197, v159
    v_exp_f32_e64 v196, -v196
    v_exp_f32_e64 v197, -v197
    v_add_f32 v196, 1.0, v196
    v_add_f32 v197, 1.0, v197
    v_rcp_f32 v196, v196
    v_rcp_f32 v197, v197
    v_mul_f32 v158, v158, v196
    v_mul_f32 v159, v159, v197
    v_add_f32 v15, v15, v158
    v_fmac_f32 v192, v158, v158
    v_add_f32 v15, v15, v159
    v_fmac_f32 v192, v159, v159
    s_waitcnt lgkmcnt(2)
    v_mfma_f32_32x32x16_bf16 v[160:175], a[8:11], v[88:91], v[160:175]
    ds_read_b64_tr_b16 a[0:1], v5 offset:64
    ds_read_b64_tr_b16 a[2:3], v5 offset:832
L_k1_cs1_2_chk:
    s_waitcnt vmcnt(5)
    v_xor_b32 v207, v219, v204
    s_waitcnt vmcnt(4)
    v_xor_b32 v205, v223, v204
    v_or_b32 v207, v207, v205
    s_waitcnt vmcnt(3)
    v_xor_b32 v205, v227, v204
    v_or_b32 v207, v207, v205
    s_waitcnt vmcnt(2)
    v_xor_b32 v205, v231, v204
    v_or_b32 v207, v207, v205
    s_waitcnt vmcnt(1)
    v_xor_b32 v205, v201, v204
    v_or_b32 v207, v207, v205
    s_waitcnt vmcnt(0)
    v_xor_b32 v205, v11, v204
    v_or_b32 v207, v207, v205
    v_cmp_ne_u32 vcc, 0, v207
    v_cmp_eq_u32 s[62:63], 0, v204
    s_nop 0
    s_or_b64 vcc, vcc, s[62:63]
    s_add_u32 s61, s61, 1
    s_cmp_eq_u64 vcc, 0
    s_cbranch_scc1 L_k1_cs1_2_ok
    s_sleep 4
    v_mov_b32 v207, s41
    buffer_load_dword v204, v207, s[44:47], 0 offen sc0 sc1
    buffer_load_dwordx4 v[216:219], v193, s[28:31], s40 offen offset:0 sc0 sc1
    buffer_load_dwordx4 v[220:223], v193, s[28:31], s40 offen offset:16 sc0 sc1
    buffer_load_dwordx4 v[224:227], v193, s[28:31], s40 offen offset:32 sc0 sc1
    buffer_load_dwordx4 v[228:231], v193, s[28:31], s40 offen offset:48 sc0 sc1
    buffer_load_dwordx4 v[198:201], v193, s[28:31], s40 offen offset:64 sc0 sc1
    buffer_load_dwordx4 v[8:11], v193, s[28:31], s40 offen offset:80 sc0 sc1
    s_cmp_lt_u32 s61, 0x40000
    s_cbranch_scc1 L_k1_cs1_2_chk
L_k1_cs1_2_ok:
    v_mov_b32 v194, v15
    v_mov_b32 v195, v192
    s_nop 0
    v_permlane32_swap_b32 v15, v194
    v_permlane32_swap_b32 v192, v195
    v_add_f32 v202, v15, v194
    v_add_f32 v204, v192, v195
    s_cmp_eq_u32 s51, 0
    s_cbranch_scc1 L_k1_nopub1
    s_mul_i32 s55, s48, 14
    s_lshl_b32 s59, s55, 11
    s_lshl_b32 s60, s66, 9
    s_add_u32 s59, s59, s60
    s_add_u32 s59, s59, 20971520
    s_lshl_b32 s60, s50, 12
    s_add_u32 s60, s60, s59
    v_and_b32 v196, 31, v0
    v_lshlrev_b32 v196, 4, v196
    v_mov_b32 v205, v203
    s_mov_b32 exec_hi, 0
    buffer_store_dwordx4 v[202:205], v196, s[28:31], s60 offen offset:2048 sc0 sc1
    s_mov_b64 exec, -1
    s_branch L_k1_pubd1
L_k1_nopub1:
    s_mul_i32 s55, s52, 56
    s_lshl_b32 s60, s50, 3
    s_add_u32 s55, s55, s60
    s_lshl_b32 s55, s55, 10
    s_add_u32 s55, s55, 6295552
    v_cvt_pk_bf16_f32 v128, v128, v129
    v_cvt_pk_bf16_f32 v129, v130, v131
    v_cvt_pk_bf16_f32 v130, v132, v133
    v_cvt_pk_bf16_f32 v131, v134, v135
    v_cvt_pk_bf16_f32 v132, v136, v137
    v_cvt_pk_bf16_f32 v133, v138, v139
    v_cvt_pk_bf16_f32 v134, v140, v141
    v_cvt_pk_bf16_f32 v135, v142, v143
    buffer_store_dwordx4 v[128:131], v1, s[28:31], s55 offen offset:0
    buffer_store_dwordx4 v[132:135], v1, s[28:31], s55 offen offset:1024
    v_cvt_pk_bf16_f32 v144, v144, v145
    v_cvt_pk_bf16_f32 v145, v146, v147
    v_cvt_pk_bf16_f32 v146, v148, v149
    v_cvt_pk_bf16_f32 v147, v150, v151
    v_cvt_pk_bf16_f32 v148, v152, v153
    v_cvt_pk_bf16_f32 v149, v154, v155
    v_cvt_pk_bf16_f32 v150, v156, v157
    v_cvt_pk_bf16_f32 v151, v158, v159
    buffer_store_dwordx4 v[144:147], v1, s[28:31], s55 offen offset:2048
    buffer_store_dwordx4 v[148:151], v1, s[28:31], s55 offen offset:3072
L_k1_pubd1:
    s_waitcnt lgkmcnt(2)
    v_mfma_f32_32x32x16_bf16 v[160:175], a[16:19], v[92:95], v[160:175]
    ds_read_b64_tr_b16 a[8:9], v5 offset:28736
    ds_read_b64_tr_b16 a[10:11], v5 offset:29504
    s_waitcnt lgkmcnt(2)
    v_mfma_f32_32x32x16_bf16 v[160:175], a[0:3], v[96:99], v[160:175]
    ds_read_b64_tr_b16 a[16:17], v6 offset:64
    ds_read_b64_tr_b16 a[18:19], v6 offset:832
    s_waitcnt lgkmcnt(2)
    v_mfma_f32_32x32x16_bf16 v[160:175], a[8:11], v[100:103], v[160:175]
    ds_read_b64_tr_b16 a[0:1], v6 offset:28736
    ds_read_b64_tr_b16 a[2:3], v6 offset:29504
    s_waitcnt lgkmcnt(2)
    v_mfma_f32_32x32x16_bf16 v[160:175], a[16:19], v[104:107], v[160:175]
    ds_read_b64_tr_b16 a[8:9], v5 offset:4160
    ds_read_b64_tr_b16 a[10:11], v5 offset:4928
    s_waitcnt lgkmcnt(2)
    v_mfma_f32_32x32x16_bf16 v[160:175], a[0:3], v[108:111], v[160:175]
    ds_read_b64_tr_b16 a[16:17], v5 offset:32832
    ds_read_b64_tr_b16 a[18:19], v5 offset:33600
    s_waitcnt lgkmcnt(2)
    v_mfma_f32_32x32x16_bf16 v[160:175], a[8:11], v[112:115], v[160:175]
    ds_read_b64_tr_b16 a[0:1], v6 offset:4160
    ds_read_b64_tr_b16 a[2:3], v6 offset:4928
    s_waitcnt lgkmcnt(2)
    v_mfma_f32_32x32x16_bf16 v[160:175], a[16:19], v[116:119], v[160:175]
    ds_read_b64_tr_b16 a[8:9], v6 offset:32832
    ds_read_b64_tr_b16 a[10:11], v6 offset:33600
    s_waitcnt lgkmcnt(2)
    v_mfma_f32_32x32x16_bf16 v[160:175], a[0:3], v[120:123], v[160:175]
    ds_read_b64_tr_b16 a[4:5], v6 offset:16512
    ds_read_b64_tr_b16 a[6:7], v6 offset:17280
    s_waitcnt lgkmcnt(2)
    v_mfma_f32_32x32x16_bf16 v[160:175], a[8:11], v[124:127], v[160:175]
    ds_read_b64_tr_b16 a[12:13], v6 offset:45184
    ds_read_b64_tr_b16 a[14:15], v6 offset:45952
    s_cmp_eq_u32 s51, 0
    s_cselect_b32 s62, 0x3e8b97f6, 1.0
    s_cselect_b32 s63, 17, 18
    s_cselect_b32 s64, 11, 12
    s_lshl_b32 s64, s52, s64
    s_mul_i32 s65, s51, 2097152
    s_add_u32 s64, s64, s65
    s_lshl_b32 s55, s50, 4
    s_waitcnt lgkmcnt(2)
    v_mfma_f32_32x32x16_bf16 v[176:191], v[24:27], a[4:7], 0
    ds_read_b64_tr_b16 a[20:21], v6 offset:20608
    ds_read_b64_tr_b16 a[22:23], v6 offset:21376
    v_and_b32 v16, 31, v0
    v_lshrrev_b32 v17, 5, v0
    v_lshlrev_b32 v16, 4, v16
    v_add_u32 v17, s55, v17
    v_mul_f32 v18, s62, v12
    v_add_u32 v48, 8, v17
    v_mul_u32_u24 v49, 9363, v48
    s_waitcnt lgkmcnt(2)
    v_mfma_f32_32x32x16_bf16 v[176:191], v[28:31], a[12:15], v[176:191]
    ds_read_b64_tr_b16 a[4:5], v6 offset:49280
    ds_read_b64_tr_b16 a[6:7], v6 offset:50048
    v_lshrrev_b32 v49, 16, v49
    v_mad_i32_i24 v48, v49, -7, v48
    v_lshlrev_b32 v49, s63, v49
    v_add_u32 v49, v49, v16
    v_and_b32 v50, 4, v48
    v_lshl_add_u32 v49, v50, 8, v49
    v_and_b32 v50, 1, v48
    s_waitcnt lgkmcnt(2)
    v_mfma_f32_32x32x16_bf16 v[176:191], v[40:43], a[20:23], v[176:191]
    ds_read_b64_tr_b16 a[12:13], v7 offset:8320
    ds_read_b64_tr_b16 a[14:15], v7 offset:9088
    v_lshl_add_u32 v49, v50, 9, v49
    v_and_b32 v50, 2, v48
    v_lshl_add_u32 v49, v50, 2, v49
    v_fma_f32 v160, v13, v216, v160
    v_fma_f32 v161, v13, v217, v161
    v_fma_f32 v162, v13, v218, v162
    v_fma_f32 v163, v13, v220, v163
    v_mul_f32 v160, v160, v18
    s_waitcnt lgkmcnt(2)
    v_mfma_f32_32x32x16_bf16 v[176:191], v[44:47], a[4:7], v[176:191]
    ds_read_b64_tr_b16 a[20:21], v7 offset:12416
    ds_read_b64_tr_b16 a[22:23], v7 offset:13184
    v_mul_f32 v161, v161, v18
    v_mul_f32 v162, v162, v18
    v_mul_f32 v163, v163, v18
    v_cvt_pk_bf16_f32 v32, v160, v161
    v_cvt_pk_bf16_f32 v33, v162, v163
    buffer_store_dwordx2 v[32:33], v49, s[28:31], s64 offen
    v_add_u32 v52, 10, v17
    s_waitcnt lgkmcnt(2)
    v_mfma_f32_32x32x16_bf16 v[176:191], v[56:59], a[12:15], v[176:191]
    ds_read_b64_tr_b16 a[4:5], v7 offset:24704
    ds_read_b64_tr_b16 a[6:7], v7 offset:25472
    v_mul_u32_u24 v53, 9363, v52
    v_lshrrev_b32 v53, 16, v53
    v_mad_i32_i24 v52, v53, -7, v52
    v_lshlrev_b32 v53, s63, v53
    v_add_u32 v53, v53, v16
    v_and_b32 v54, 4, v52
    v_lshl_add_u32 v53, v54, 8, v53
    v_and_b32 v54, 1, v52
    s_waitcnt lgkmcnt(2)
    v_mfma_f32_32x32x16_bf16 v[176:191], v[60:63], a[20:23], v[176:191]
    ds_read_b64_tr_b16 a[12:13], v7 offset:28800
    ds_read_b64_tr_b16 a[14:15], v7 offset:29568
    v_lshl_add_u32 v53, v54, 9, v53
    v_and_b32 v54, 2, v52
    v_lshl_add_u32 v53, v54, 2, v53
    v_fma_f32 v164, v13, v221, v164
    v_fma_f32 v165, v13, v222, v165
    v_fma_f32 v166, v13, v224, v166
    v_fma_f32 v167, v13, v225, v167
    s_waitcnt lgkmcnt(2)
    v_mfma_f32_32x32x16_bf16 v[176:191], v[72:75], a[4:7], v[176:191]
    ds_read_b64_tr_b16 a[20:21], v7 offset:41088
    ds_read_b64_tr_b16 a[22:23], v7 offset:41856
    v_mul_f32 v164, v164, v18
    v_mul_f32 v165, v165, v18
    v_mul_f32 v166, v166, v18
    v_mul_f32 v167, v167, v18
    v_cvt_pk_bf16_f32 v34, v164, v165
    v_cvt_pk_bf16_f32 v35, v166, v167
    buffer_store_dwordx2 v[34:35], v53, s[28:31], s64 offen
    v_add_u32 v48, 12, v17
    s_waitcnt lgkmcnt(2)
    v_mfma_f32_32x32x16_bf16 v[176:191], v[76:79], a[12:15], v[176:191]
    ds_read_b64_tr_b16 a[4:5], v7 offset:45184
    ds_read_b64_tr_b16 a[6:7], v7 offset:45952
    v_mul_u32_u24 v49, 9363, v48
    v_lshrrev_b32 v49, 16, v49
    v_mad_i32_i24 v48, v49, -7, v48
    v_lshlrev_b32 v49, s63, v49
    v_add_u32 v49, v49, v16
    v_and_b32 v50, 4, v48
    v_lshl_add_u32 v49, v50, 8, v49
    s_waitcnt lgkmcnt(2)
    v_mfma_f32_32x32x16_bf16 v[176:191], v[88:91], a[20:23], v[176:191]
    ds_read_b64_tr_b16 a[12:13], v6 offset:128
    ds_read_b64_tr_b16 a[14:15], v6 offset:896
    v_and_b32 v50, 1, v48
    v_lshl_add_u32 v49, v50, 9, v49
    v_and_b32 v50, 2, v48
    v_lshl_add_u32 v49, v50, 2, v49
    v_fma_f32 v168, v13, v226, v168
    v_fma_f32 v169, v13, v228, v169
    v_fma_f32 v170, v13, v229, v170
    v_fma_f32 v171, v13, v230, v171
    s_waitcnt lgkmcnt(2)
    v_mfma_f32_32x32x16_bf16 v[176:191], v[92:95], a[4:7], v[176:191]
    ds_read_b64_tr_b16 a[20:21], v6 offset:28800
    ds_read_b64_tr_b16 a[22:23], v6 offset:29568
    v_mul_f32 v168, v168, v18
    v_mul_f32 v169, v169, v18
    v_mul_f32 v170, v170, v18
    v_mul_f32 v171, v171, v18
    v_cvt_pk_bf16_f32 v36, v168, v169
    v_cvt_pk_bf16_f32 v37, v170, v171
    buffer_store_dwordx2 v[36:37], v49, s[28:31], s64 offen
    s_waitcnt lgkmcnt(2)
    v_mfma_f32_32x32x16_bf16 v[176:191], v[104:107], a[12:15], v[176:191]
    ds_read_b64_tr_b16 a[4:5], v6 offset:4224
    ds_read_b64_tr_b16 a[6:7], v6 offset:4992
    v_add_u32 v52, 14, v17
    v_mul_u32_u24 v53, 9363, v52
    v_lshrrev_b32 v53, 16, v53
    v_mad_i32_i24 v52, v53, -7, v52
    v_lshlrev_b32 v53, s63, v53
    v_add_u32 v53, v53, v16
    v_and_b32 v54, 4, v52
    v_lshl_add_u32 v53, v54, 8, v53
    s_waitcnt lgkmcnt(2)
    v_mfma_f32_32x32x16_bf16 v[176:191], v[108:111], a[20:23], v[176:191]
    ds_read_b64_tr_b16 a[12:13], v6 offset:32896
    ds_read_b64_tr_b16 a[14:15], v6 offset:33664
    v_and_b32 v54, 1, v52
    v_lshl_add_u32 v53, v54, 9, v53
    v_and_b32 v54, 2, v52
    v_lshl_add_u32 v53, v54, 2, v53
    v_fma_f32 v172, v13, v198, v172
    v_fma_f32 v173, v13, v199, v173
    v_fma_f32 v174, v13, v200, v174
    s_waitcnt lgkmcnt(2)
    v_mfma_f32_32x32x16_bf16 v[176:191], v[120:123], a[4:7], v[176:191]
    v_fma_f32 v175, v13, v8, v175
    v_mul_f32 v172, v172, v18
    v_mul_f32 v173, v173, v18
    v_mul_f32 v174, v174, v18
    v_mul_f32 v175, v175, v18
    v_cvt_pk_bf16_f32 v38, v172, v173
    v_cvt_pk_bf16_f32 v39, v174, v175
    buffer_store_dwordx2 v[38:39], v53, s[28:31], s64 offen
    s_waitcnt lgkmcnt(0)
    v_mfma_f32_32x32x16_bf16 v[176:191], v[124:127], a[12:15], v[176:191]
    v_and_b32 v18, 31, v0
    v_lshrrev_b32 v19, 5, v0
    v_lshlrev_b32 v20, 4, v18
    s_cmp_eq_u32 s51, 0
    s_cbranch_scc1 L_k1_nopre1
    v_mul_u32_u24 v17, 14336, v19
    v_add_u32 v17, v17, v20
    s_add_u32 s60, s59, 4096
    s_add_u32 s67, s59, 8192
    s_add_u32 s68, s59, 12288
    buffer_load_dwordx4 v[32:35], v17, s[28:31], s59 offen offset:0 sc0 sc1
    buffer_load_dwordx4 v[36:39], v17, s[28:31], s59 offen offset:2048 sc0 sc1
    buffer_load_dwordx4 v[40:43], v17, s[28:31], s60 offen offset:0 sc0 sc1
    buffer_load_dwordx4 v[44:47], v17, s[28:31], s60 offen offset:2048 sc0 sc1
    buffer_load_dwordx4 v[48:51], v17, s[28:31], s67 offen offset:0 sc0 sc1
    buffer_load_dwordx4 v[52:55], v17, s[28:31], s67 offen offset:2048 sc0 sc1
    buffer_load_dwordx4 v[56:59], v17, s[28:31], s68 offen offset:0 sc0 sc1
L_k1_nopre1:
    v_add_u32 v21, s53, v1
    v_add_u32 v21, 8192, v21
    s_nop 4
    ds_write_b128 v21, v[176:179] offset:0
    ds_write_b128 v21, v[180:183] offset:1024
    ds_write_b128 v21, v[184:187] offset:2048
    ds_write_b128 v21, v[188:191] offset:3072
    s_waitcnt lgkmcnt(0)
    s_barrier
    s_lshl_b32 s65, s52, 12
    s_add_u32 s65, s65, 2097152
    s_add_u32 s55, s49, 14
    s_cmp_lt_u32 s49, 2
    s_cselect_b32 s55, s55, s49
    s_sub_u32 s55, s55, s49
    v_mul_u32_u24 v23, s55, v19
    v_add_u32 v23, s49, v23
    v_lshlrev_b32 v23, 18, v23
    v_add_u32 v22, v23, v20
    v_mov_b32 v96, 0x3f803f80
    v_mov_b32 v97, 0x3f80
    buffer_store_dwordx2 v[96:97], v22, s[28:31], s65 offen offset:1544
    v_and_b32 v98, 3, v0
    v_bfe_u32 v99, v0, 2, 1
    v_lshl_add_u32 v99, v99, 5, v98
    v_lshlrev_b32 v99, 4, v99
    v_bfe_u32 v100, v0, 3, 1
    v_lshl_add_u32 v99, v100, 10, v99
    v_add_u32 v99, v99, v23
    v_cmp_eq_u32 vcc, 0, v98
    s_nop 1
    v_cndmask_b32 v100, 0, v96, vcc
    v_mov_b32 v101, v100
    v_mov_b32 v102, v100
    v_mov_b32 v103, v100
    buffer_store_dwordx4 v[100:103], v99, s[28:31], s65 offen offset:2496
    s_cmp_eq_u32 s51, 0
    s_cbranch_scc1 L_k1_fin
    s_mov_b32 s61, 0
L_k1_poll1:
    s_waitcnt vmcnt(6)
    v_xor_b32 v60, v33, v203
    v_xor_b32 v61, v35, v203
    v_or_b32 v60, v60, v61
    s_waitcnt vmcnt(5)
    v_xor_b32 v61, v37, v203
    v_or_b32 v60, v60, v61
    v_xor_b32 v61, v39, v203
    v_or_b32 v60, v60, v61
    s_waitcnt vmcnt(4)
    v_xor_b32 v61, v41, v203
    v_or_b32 v60, v60, v61
    v_xor_b32 v61, v43, v203
    v_or_b32 v60, v60, v61
    s_waitcnt vmcnt(3)
    v_xor_b32 v61, v45, v203
    v_or_b32 v60, v60, v61
    v_xor_b32 v61, v47, v203
    v_or_b32 v60, v60, v61
    s_waitcnt vmcnt(2)
    v_xor_b32 v61, v49, v203
    v_or_b32 v60, v60, v61
    v_xor_b32 v61, v51, v203
    v_or_b32 v60, v60, v61
    s_waitcnt vmcnt(1)
    v_xor_b32 v61, v53, v203
    v_or_b32 v60, v60, v61
    v_xor_b32 v61, v55, v203
    v_or_b32 v60, v60, v61
    s_waitcnt vmcnt(0)
    v_xor_b32 v61, v57, v203
    v_or_b32 v60, v60, v61
    v_xor_b32 v61, v59, v203
    v_or_b32 v60, v60, v61
    v_cmp_ne_u32 vcc, 0, v60
    s_add_u32 s61, s61, 1
    s_cmp_eq_u64 vcc, 0
    s_cbranch_scc1 L_k1_polled1
    s_sleep 1
    buffer_load_dwordx4 v[32:35], v17, s[28:31], s59 offen offset:0 sc0 sc1
    buffer_load_dwordx4 v[36:39], v17, s[28:31], s59 offen offset:2048 sc0 sc1
    buffer_load_dwordx4 v[40:43], v17, s[28:31], s60 offen offset:0 sc0 sc1
    buffer_load_dwordx4 v[44:47], v17, s[28:31], s60 offen offset:2048 sc0 sc1
    buffer_load_dwordx4 v[48:51], v17, s[28:31], s67 offen offset:0 sc0 sc1
    buffer_load_dwordx4 v[52:55], v17, s[28:31], s67 offen offset:2048 sc0 sc1
    buffer_load_dwordx4 v[56:59], v17, s[28:31], s68 offen offset:0 sc0 sc1
    s_cmp_lt_u32 s61, 0x40000
    s_cbranch_scc1 L_k1_poll1
L_k1_polled1:
    v_add_f32 v32, v32, v36
    v_add_f32 v34, v34, v38
    v_add_f32 v32, v32, v40
    v_add_f32 v34, v34, v42
    v_add_f32 v32, v32, v44
    v_add_f32 v34, v34, v46
    v_add_f32 v32, v32, v48
    v_add_f32 v34, v34, v50
    v_add_f32 v32, v32, v52
    v_add_f32 v34, v34, v54
    v_add_f32 v32, v32, v56
    v_add_f32 v34, v34, v58
    v_mov_b32 v33, v32
    v_mov_b32 v35, v34
    s_nop 0
    v_permlane32_swap_b32 v32, v33
    v_permlane32_swap_b32 v34, v35
    v_add_f32 v32, v32, v33
    v_add_f32 v34, v34, v35
    v_mul_f32 v32, 0x3a924925, v32
    v_mul_f32 v34, 0x3a924925, v34
    v_fma_f32 v34, -v32, v32, v34
    v_max_f32 v34, 0, v34
    v_add_f32 v34, 0x361367a4, v34
    v_rsq_f32 v12, v34
    s_nop 0
    v_mul_f32 v13, v32, v12
    v_sub_f32 v13, 0, v13
    s_add_u32 s55, s53, 12800
    v_mul_u32_u24 v21, 576, v19
    v_add_u32 v21, v21, v20
    v_add_u32 v21, s55, v21
    v_bfe_u32 v22, v0, 4, 1
    v_and_b32 v23, 1, v0
    v_lshl_add_u32 v22, v22, 1, v23
    v_mul_u32_u24 v22, 576, v22
    v_bfe_u32 v23, v0, 2, 2
    v_lshl_add_u32 v23, v19, 3, v23
    v_lshl_add_u32 v22, v23, 4, v22
    v_bfe_u32 v23, v0, 1, 1
    v_lshl_add_u32 v22, v23, 3, v22
    v_add_u32 v22, s55, v22
    s_lshl_b32 s55, s50, 9
    s_lshl_b32 s59, s52, 1
    s_add_u32 s55, s55, s59
    s_lshl_b32 s55, s55, 10
    s_add_u32 s55, s55, 10747904
    v_fma_f32 v128, v128, v12, v13
    v_fma_f32 v129, v129, v12, v13
    v_fma_f32 v130, v130, v12, v13
    v_fma_f32 v131, v131, v12, v13
    v_fma_f32 v132, v132, v12, v13
    v_fma_f32 v133, v133, v12, v13
    v_fma_f32 v134, v134, v12, v13
    v_fma_f32 v135, v135, v12, v13
    v_fma_f32 v136, v136, v12, v13
    v_fma_f32 v137, v137, v12, v13
    v_fma_f32 v138, v138, v12, v13
    v_fma_f32 v139, v139, v12, v13
    v_fma_f32 v140, v140, v12, v13
    v_fma_f32 v141, v141, v12, v13
    v_fma_f32 v142, v142, v12, v13
    v_fma_f32 v143, v143, v12, v13
    v_cvt_pk_bf16_f32 v64, v128, v129
    v_cvt_pk_bf16_f32 v65, v130, v131
    v_cvt_pk_bf16_f32 v66, v132, v133
    v_cvt_pk_bf16_f32 v67, v134, v135
    v_cvt_pk_bf16_f32 v68, v136, v137
    v_cvt_pk_bf16_f32 v69, v138, v139
    v_cvt_pk_bf16_f32 v70, v140, v141
    v_cvt_pk_bf16_f32 v71, v142, v143
    ds_write_b128 v21, v[64:67] offset:0
    ds_write_b128 v21, v[68:71] offset:1152
    ds_read_b64_tr_b16 v[80:81], v22 offset:0
    ds_read_b64_tr_b16 v[82:83], v22 offset:64
    ds_read_b64_tr_b16 v[84:85], v22 offset:256
    ds_read_b64_tr_b16 v[86:87], v22 offset:320
    v_fma_f32 v144, v144, v12, v13
    v_fma_f32 v145, v145, v12, v13
    v_fma_f32 v146, v146, v12, v13
    v_fma_f32 v147, v147, v12, v13
    v_fma_f32 v148, v148, v12, v13
    v_fma_f32 v149, v149, v12, v13
    v_fma_f32 v150, v150, v12, v13
    v_fma_f32 v151, v151, v12, v13
    v_fma_f32 v152, v152, v12, v13
    v_fma_f32 v153, v153, v12, v13
    v_fma_f32 v154, v154, v12, v13
    v_fma_f32 v155, v155, v12, v13
    v_fma_f32 v156, v156, v12, v13
    v_fma_f32 v157, v157, v12, v13
    v_fma_f32 v158, v158, v12, v13
    v_fma_f32 v159, v159, v12, v13
    v_cvt_pk_bf16_f32 v72, v144, v145
    v_cvt_pk_bf16_f32 v73, v146, v147
    v_cvt_pk_bf16_f32 v74, v148, v149
    v_cvt_pk_bf16_f32 v75, v150, v151
    v_cvt_pk_bf16_f32 v76, v152, v153
    v_cvt_pk_bf16_f32 v77, v154, v155
    v_cvt_pk_bf16_f32 v78, v156, v157
    v_cvt_pk_bf16_f32 v79, v158, v159
    ds_write_b128 v21, v[72:75] offset:2304
    ds_write_b128 v21, v[76:79] offset:3456
    ds_read_b64_tr_b16 v[88:89], v22 offset:2304
    ds_read_b64_tr_b16 v[90:91], v22 offset:2368
    ds_read_b64_tr_b16 v[92:93], v22 offset:2560
    ds_read_b64_tr_b16 v[94:95], v22 offset:2624
    s_waitcnt lgkmcnt(8)
    buffer_store_dwordx4 v[80:83], v1, s[28:31], s55 offen
    s_waitcnt lgkmcnt(6)
    buffer_store_dwordx4 v[84:87], v1, s[28:31], s55 offen offset:1024
    s_add_u32 s55, s55, 131072
    s_waitcnt lgkmcnt(2)
    buffer_store_dwordx4 v[88:91], v1, s[28:31], s55 offen
    s_waitcnt lgkmcnt(0)
    buffer_store_dwordx4 v[92:95], v1, s[28:31], s55 offen offset:1024
    s_branch L_k1_fin
L_k1_fin:
L_k1_end:
    s_endpgm
L_k1_pref:
    s_load_dwordx2 s[4:5], s[0:1], 40
    s_load_dwordx2 s[12:13], s[0:1], 8
    s_load_dwordx2 s[14:15], s[0:1], 32
    s_load_dwordx4 s[16:19], s[0:1], 72
    s_memrealtime s[30:31]
    s_mov_b32 s3, s2
    v_lshlrev_b32 v1, 4, v0
    v_lshrrev_b32 v2, 6, v0
    v_and_b32 v3, 63, v0
    v_readfirstlane_b32 s6, v2
    s_cmp_ge_u32 s3, 25
    s_cbranch_scc1 L_k1_pref2
    s_lshr_b32 s7, s6, 2
    s_lshl_b32 s20, s3, 1
    s_add_u32 s20, s20, s7
    s_and_b32 s21, s6, 3
    s_waitcnt lgkmcnt(0)
    s_mov_b32 s26, 1605632
    s_mov_b32 s22, 3584
    s_cmp_lt_u32 s20, 21
    s_cselect_b32 s24, s12, s14
    s_cselect_b32 s25, s13, s15
    s_cselect_b32 s26, 1204224, s26
    s_cselect_b32 s22, 2688, s22
    s_cselect_b32 s23, 0, 21
    s_and_b32 s25, s25, 0xffff
    s_mov_b32 s27, 0x20000
    s_sub_u32 s23, s20, s23
    s_lshl_b32 s23, s23, 7
    s_cmp_ge_u32 s20, 49
    s_cselect_b32 s26, 0, s26
    s_mul_i32 s28, s21, 112
    s_mul_i32 s28, s28, s22
    s_add_u32 s28, s28, s23
    s_lshl_b32 s29, s22, 3
    v_lshrrev_b32 v6, 3, v3
    v_mul_lo_u32 v6, v6, s22
    v_and_b32 v7, 7, v3
    v_lshl_add_u32 v6, v7, 4, v6
    buffer_load_dwordx4 v[16:19], v6, s[24:27], s28 offen
    s_add_u32 s28, s28, s29
    buffer_load_dwordx4 v[20:23], v6, s[24:27], s28 offen
    s_add_u32 s28, s28, s29
    buffer_load_dwordx4 v[24:27], v6, s[24:27], s28 offen
    s_add_u32 s28, s28, s29
    buffer_load_dwordx4 v[28:31], v6, s[24:27], s28 offen
    s_add_u32 s28, s28, s29
    buffer_load_dwordx4 v[32:35], v6, s[24:27], s28 offen
    s_add_u32 s28, s28, s29
    buffer_load_dwordx4 v[36:39], v6, s[24:27], s28 offen
    s_add_u32 s28, s28, s29
    buffer_load_dwordx4 v[40:43], v6, s[24:27], s28 offen
    s_add_u32 s28, s28, s29
    buffer_load_dwordx4 v[44:47], v6, s[24:27], s28 offen
    s_add_u32 s28, s28, s29
    buffer_load_dwordx4 v[48:51], v6, s[24:27], s28 offen
    s_add_u32 s28, s28, s29
    buffer_load_dwordx4 v[52:55], v6, s[24:27], s28 offen
    s_add_u32 s28, s28, s29
    buffer_load_dwordx4 v[56:59], v6, s[24:27], s28 offen
    s_add_u32 s28, s28, s29
    buffer_load_dwordx4 v[60:63], v6, s[24:27], s28 offen
    s_add_u32 s28, s28, s29
    buffer_load_dwordx4 v[64:67], v6, s[24:27], s28 offen
    s_add_u32 s28, s28, s29
    buffer_load_dwordx4 v[68:71], v6, s[24:27], s28 offen
    s_add_u32 s28, s28, s29
    v_mov_b32 v8, 0x3f80
    v_mov_b32 v9, 0x3f800000
    v_mov_b32 v80, 0
    v_mov_b32 v81, 0
    v_mov_b32 v82, 0
    v_mov_b32 v83, 0
    v_mov_b32 v84, 0
    v_mov_b32 v85, 0
    v_mov_b32 v86, 0
    v_mov_b32 v87, 0
    s_waitcnt vmcnt(13)
    v_dot2_f32_bf16 v80, v16, v8, v80
    v_dot2_f32_bf16 v81, v16, v9, v81
    v_dot2_f32_bf16 v82, v17, v8, v82
    v_dot2_f32_bf16 v83, v17, v9, v83
    v_dot2_f32_bf16 v84, v18, v8, v84
    v_dot2_f32_bf16 v85, v18, v9, v85
    v_dot2_f32_bf16 v86, v19, v8, v86
    v_dot2_f32_bf16 v87, v19, v9, v87
    s_waitcnt vmcnt(12)
    v_dot2_f32_bf16 v80, v20, v8, v80
    v_dot2_f32_bf16 v81, v20, v9, v81
    v_dot2_f32_bf16 v82, v21, v8, v82
    v_dot2_f32_bf16 v83, v21, v9, v83
    v_dot2_f32_bf16 v84, v22, v8, v84
    v_dot2_f32_bf16 v85, v22, v9, v85
    v_dot2_f32_bf16 v86, v23, v8, v86
    v_dot2_f32_bf16 v87, v23, v9, v87
    s_waitcnt vmcnt(11)
    v_dot2_f32_bf16 v80, v24, v8, v80
    v_dot2_f32_bf16 v81, v24, v9, v81
    v_dot2_f32_bf16 v82, v25, v8, v82
    v_dot2_f32_bf16 v83, v25, v9, v83
    v_dot2_f32_bf16 v84, v26, v8, v84
    v_dot2_f32_bf16 v85, v26, v9, v85
    v_dot2_f32_bf16 v86, v27, v8, v86
    v_dot2_f32_bf16 v87, v27, v9, v87
    s_waitcnt vmcnt(10)
    v_dot2_f32_bf16 v80, v28, v8, v80
    v_dot2_f32_bf16 v81, v28, v9, v81
    v_dot2_f32_bf16 v82, v29, v8, v82
    v_dot2_f32_bf16 v83, v29, v9, v83
    v_dot2_f32_bf16 v84, v30, v8, v84
    v_dot2_f32_bf16 v85, v30, v9, v85
    v_dot2_f32_bf16 v86, v31, v8, v86
    v_dot2_f32_bf16 v87, v31, v9, v87
    s_waitcnt vmcnt(9)
    v_dot2_f32_bf16 v80, v32, v8, v80
    v_dot2_f32_bf16 v81, v32, v9, v81
    v_dot2_f32_bf16 v82, v33, v8, v82
    v_dot2_f32_bf16 v83, v33, v9, v83
    v_dot2_f32_bf16 v84, v34, v8, v84
    v_dot2_f32_bf16 v85, v34, v9, v85
    v_dot2_f32_bf16 v86, v35, v8, v86
    v_dot2_f32_bf16 v87, v35, v9, v87
    s_waitcnt vmcnt(8)
    v_dot2_f32_bf16 v80, v36, v8, v80
    v_dot2_f32_bf16 v81, v36, v9, v81
    v_dot2_f32_bf16 v82, v37, v8, v82
    v_dot2_f32_bf16 v83, v37, v9, v83
    v_dot2_f32_bf16 v84, v38, v8, v84
    v_dot2_f32_bf16 v85, v38, v9, v85
    v_dot2_f32_bf16 v86, v39, v8, v86
    v_dot2_f32_bf16 v87, v39, v9, v87
    s_waitcnt vmcnt(7)
    v_dot2_f32_bf16 v80, v40, v8, v80
    v_dot2_f32_bf16 v81, v40, v9, v81
    v_dot2_f32_bf16 v82, v41, v8, v82
    v_dot2_f32_bf16 v83, v41, v9, v83
    v_dot2_f32_bf16 v84, v42, v8, v84
    v_dot2_f32_bf16 v85, v42, v9, v85
    v_dot2_f32_bf16 v86, v43, v8, v86
    v_dot2_f32_bf16 v87, v43, v9, v87
    s_waitcnt vmcnt(6)
    v_dot2_f32_bf16 v80, v44, v8, v80
    v_dot2_f32_bf16 v81, v44, v9, v81
    v_dot2_f32_bf16 v82, v45, v8, v82
    v_dot2_f32_bf16 v83, v45, v9, v83
    v_dot2_f32_bf16 v84, v46, v8, v84
    v_dot2_f32_bf16 v85, v46, v9, v85
    v_dot2_f32_bf16 v86, v47, v8, v86
    v_dot2_f32_bf16 v87, v47, v9, v87
    s_waitcnt vmcnt(5)
    v_dot2_f32_bf16 v80, v48, v8, v80
    v_dot2_f32_bf16 v81, v48, v9, v81
    v_dot2_f32_bf16 v82, v49, v8, v82
    v_dot2_f32_bf16 v83, v49, v9, v83
    v_dot2_f32_bf16 v84, v50, v8, v84
    v_dot2_f32_bf16 v85, v50, v9, v85
    v_dot2_f32_bf16 v86, v51, v8, v86
    v_dot2_f32_bf16 v87, v51, v9, v87
    s_waitcnt vmcnt(4)
    v_dot2_f32_bf16 v80, v52, v8, v80
    v_dot2_f32_bf16 v81, v52, v9, v81
    v_dot2_f32_bf16 v82, v53, v8, v82
    v_dot2_f32_bf16 v83, v53, v9, v83
    v_dot2_f32_bf16 v84, v54, v8, v84
    v_dot2_f32_bf16 v85, v54, v9, v85
    v_dot2_f32_bf16 v86, v55, v8, v86
    v_dot2_f32_bf16 v87, v55, v9, v87
    s_waitcnt vmcnt(3)
    v_dot2_f32_bf16 v80, v56, v8, v80
    v_dot2_f32_bf16 v81, v56, v9, v81
    v_dot2_f32_bf16 v82, v57, v8, v82
    v_dot2_f32_bf16 v83, v57, v9, v83
    v_dot2_f32_bf16 v84, v58, v8, v84
    v_dot2_f32_bf16 v85, v58, v9, v85
    v_dot2_f32_bf16 v86, v59, v8, v86
    v_dot2_f32_bf16 v87, v59, v9, v87
    s_waitcnt vmcnt(2)
    v_dot2_f32_bf16 v80, v60, v8, v80
    v_dot2_f32_bf16 v81, v60, v9, v81
    v_dot2_f32_bf16 v82, v61, v8, v82
    v_dot2_f32_bf16 v83, v61, v9, v83
    v_dot2_f32_bf16 v84, v62, v8, v84
    v_dot2_f32_bf16 v85, v62, v9, v85
    v_dot2_f32_bf16 v86, v63, v8, v86
    v_dot2_f32_bf16 v87, v63, v9, v87
    s_waitcnt vmcnt(1)
    v_dot2_f32_bf16 v80, v64, v8, v80
    v_dot2_f32_bf16 v81, v64, v9, v81
    v_dot2_f32_bf16 v82, v65, v8, v82
    v_dot2_f32_bf16 v83, v65, v9, v83
    v_dot2_f32_bf16 v84, v66, v8, v84
    v_dot2_f32_bf16 v85, v66, v9, v85
    v_dot2_f32_bf16 v86, v67, v8, v86
    v_dot2_f32_bf16 v87, v67, v9, v87
    s_waitcnt vmcnt(0)
    v_dot2_f32_bf16 v80, v68, v8, v80
    v_dot2_f32_bf16 v81, v68, v9, v81
    v_dot2_f32_bf16 v82, v69, v8, v82
    v_dot2_f32_bf16 v83, v69, v9, v83
    v_dot2_f32_bf16 v84, v70, v8, v84
    v_dot2_f32_bf16 v85, v70, v9, v85
    v_dot2_f32_bf16 v86, v71, v8, v86
    v_dot2_f32_bf16 v87, v71, v9, v87
    s_lshl_b32 s7, s6, 8
    v_lshlrev_b32 v7, 5, v7
    v_add_u32 v7, s7, v7
    s_nop 2
    v_add_f32_dpp v80, v80, v80 row_ror:8 row_mask:0xf bank_mask:0xf
    v_add_f32_dpp v81, v81, v81 row_ror:8 row_mask:0xf bank_mask:0xf
    v_add_f32_dpp v82, v82, v82 row_ror:8 row_mask:0xf bank_mask:0xf
    v_add_f32_dpp v83, v83, v83 row_ror:8 row_mask:0xf bank_mask:0xf
    v_add_f32_dpp v84, v84, v84 row_ror:8 row_mask:0xf bank_mask:0xf
    v_add_f32_dpp v85, v85, v85 row_ror:8 row_mask:0xf bank_mask:0xf
    v_add_f32_dpp v86, v86, v86 row_ror:8 row_mask:0xf bank_mask:0xf
    v_add_f32_dpp v87, v87, v87 row_ror:8 row_mask:0xf bank_mask:0xf
    v_mov_b32 v88, v80
    v_mov_b32 v89, v81
    v_mov_b32 v90, v82
    v_mov_b32 v91, v83
    v_mov_b32 v92, v84
    v_mov_b32 v93, v85
    v_mov_b32 v94, v86
    v_mov_b32 v95, v87
    v_permlane16_swap_b32 v80, v88
    v_permlane16_swap_b32 v81, v89
    v_permlane16_swap_b32 v82, v90
    v_permlane16_swap_b32 v83, v91
    v_permlane16_swap_b32 v84, v92
    v_permlane16_swap_b32 v85, v93
    v_permlane16_swap_b32 v86, v94
    v_permlane16_swap_b32 v87, v95
    v_add_f32 v80, v80, v88
    v_add_f32 v81, v81, v89
    v_add_f32 v82, v82, v90
    v_add_f32 v83, v83, v91
    v_add_f32 v84, v84, v92
    v_add_f32 v85, v85, v93
    v_add_f32 v86, v86, v94
    v_add_f32 v87, v87, v95
    v_mov_b32 v88, v80
    v_mov_b32 v89, v81
    v_mov_b32 v90, v82
    v_mov_b32 v91, v83
    v_mov_b32 v92, v84
    v_mov_b32 v93, v85
    v_mov_b32 v94, v86
    v_mov_b32 v95, v87
    v_permlane32_swap_b32 v80, v88
    v_permlane32_swap_b32 v81, v89
    v_permlane32_swap_b32 v82, v90
    v_permlane32_swap_b32 v83, v91
    v_permlane32_swap_b32 v84, v92
    v_permlane32_swap_b32 v85, v93
    v_permlane32_swap_b32 v86, v94
    v_permlane32_swap_b32 v87, v95
    v_add_f32 v80, v80, v88
    v_add_f32 v81, v81, v89
    v_add_f32 v82, v82, v90
    v_add_f32 v83, v83, v91
    v_add_f32 v84, v84, v92
    v_add_f32 v85, v85, v93
    v_add_f32 v86, v86, v94
    v_add_f32 v87, v87, v95
    s_mov_b64 exec, 0xff
    ds_write_b128 v7, v[80:83]
    ds_write_b128 v7, v[84:87] offset:16
    s_mov_b64 exec, -1
    s_waitcnt lgkmcnt(0)
    s_barrier
    s_cmp_lg_u32 s6, 0
    s_cbranch_scc1 L_k1_pref2
    s_add_u32 s24, s18, 22020096
    s_addc_u32 s25, s19, 0
    s_and_b32 s25, s25, 0xffff
    s_mov_b32 s26, 133120
    s_mov_b32 s27, 0x20000
    s_mov_b32 s32, s16
    s_and_b32 s33, s17, 0xffff
    s_mov_b32 s34, 256
    s_mov_b32 s35, 0x20000
    s_or_b32 s30, s30, 1
    v_lshlrev_b32 v4, 7, v3
    v_mov_b32 v5, 0
    v_add_u32 v4, 131072, v4
    buffer_store_dword v5, v4, s[24:27], 0 offen
    v_mul_u32_u24 v4, 43, v3
    v_lshrrev_b32 v4, 8, v4
    v_mad_i32_i24 v5, v4, -6, v3
    v_mul_u32_u24 v5, 3, v5
    v_lshrrev_b32 v6, 1, v4
    v_and_b32 v7, 1, v4
    v_lshlrev_b32 v6, 5, v6
    v_lshl_add_u32 v6, v7, 2, v6
    v_add_u32 v8, 0, v5
    v_min_u32 v8, 15, v8
    v_and_b32 v9, 3, v8
    v_lshrrev_b32 v8, 2, v8
    v_lshl_add_u32 v8, v8, 3, v9
    v_add_u32 v8, v8, v6
    v_bfe_u32 v9, v8, 6, 1
    v_and_b32 v8, 63, v8
    v_lshlrev_b32 v8, 2, v8
    v_lshl_add_u32 v8, v9, 10, v8
    ds_read_b32 v24, v8 offset:0
    ds_read_b32 v25, v8 offset:256
    ds_read_b32 v26, v8 offset:512
    ds_read_b32 v27, v8 offset:768
    v_add_u32 v8, 1, v5
    v_min_u32 v8, 15, v8
    v_and_b32 v9, 3, v8
    v_lshrrev_b32 v8, 2, v8
    v_lshl_add_u32 v8, v8, 3, v9
    v_add_u32 v8, v8, v6
    v_bfe_u32 v9, v8, 6, 1
    v_and_b32 v8, 63, v8
    v_lshlrev_b32 v8, 2, v8
    v_lshl_add_u32 v8, v9, 10, v8
    ds_read_b32 v28, v8 offset:0
    ds_read_b32 v29, v8 offset:256
    ds_read_b32 v30, v8 offset:512
    ds_read_b32 v31, v8 offset:768
    v_add_u32 v8, 2, v5
    v_min_u32 v8, 15, v8
    v_and_b32 v9, 3, v8
    v_lshrrev_b32 v8, 2, v8
    v_lshl_add_u32 v8, v8, 3, v9
    v_add_u32 v8, v8, v6
    v_bfe_u32 v9, v8, 6, 1
    v_and_b32 v8, 63, v8
    v_lshlrev_b32 v8, 2, v8
    v_lshl_add_u32 v8, v9, 10, v8
    ds_read_b32 v32, v8 offset:0
    ds_read_b32 v33, v8 offset:256
    ds_read_b32 v34, v8 offset:512
    ds_read_b32 v35, v8 offset:768
    v_and_b32 v4, 31, v3
    v_lshlrev_b32 v4, 3, v4
    v_lshrrev_b32 v9, 5, v3
    v_lshl_add_u32 v4, v9, 10, v4
    ds_read_b64 v[40:41], v4 offset:0
    ds_read_b64 v[42:43], v4 offset:256
    ds_read_b64 v[44:45], v4 offset:512
    ds_read_b64 v[46:47], v4 offset:768
    s_waitcnt lgkmcnt(14)
    v_add_f32 v24, v24, v25
    s_waitcnt lgkmcnt(12)
    v_add_f32 v26, v26, v27
    v_add_f32 v12, v24, v26
    s_waitcnt lgkmcnt(10)
    v_add_f32 v28, v28, v29
    s_waitcnt lgkmcnt(8)
    v_add_f32 v30, v30, v31
    v_add_f32 v13, v28, v30
    s_waitcnt lgkmcnt(6)
    v_add_f32 v32, v32, v33
    s_waitcnt lgkmcnt(4)
    v_add_f32 v34, v34, v35
    v_add_f32 v14, v32, v34
    s_waitcnt lgkmcnt(2)
    v_add_f32 v40, v40, v42
    s_waitcnt lgkmcnt(0)
    v_add_f32 v44, v44, v46
    v_add_f32 v16, v40, v44
    v_add_f32 v41, v41, v43
    v_add_f32 v45, v45, v47
    v_add_f32 v17, v41, v45
    v_mov_b32 v15, s30
    v_lshlrev_b32 v5, 4, v3
    s_mul_i32 s7, s3, 768
    s_mov_b32 exec_hi, 0xffff
    buffer_store_dwordx4 v[12:15], v5, s[24:27], s7 offen sc0 sc1
    s_mov_b64 exec, -1
    v_mov_b32 v20, v16
    v_mov_b32 v21, s30
    v_mov_b32 v22, v17
    v_mov_b32 v23, s30
    s_lshl_b32 s7, s3, 10
    s_add_u32 s7, s7, 65536
    buffer_store_dwordx4 v[20:23], v5, s[24:27], s7 offen sc0 sc1
    s_lshl_b32 s7, s3, 2
    s_add_u32 s7, s7, 128
    v_mov_b32 v4, 0
    s_mov_b64 exec, 1
    buffer_store_dword v15, v4, s[32:35], s7 offen sc0 sc1
    s_mov_b64 exec, -1
L_k1_pref2:
    s_lshl_b32 s3, s3, 18
    s_waitcnt lgkmcnt(0)
    s_mov_b32 s8, s4
    s_and_b32 s9, s5, 0xffff
    s_mov_b32 s10, 8388608
    s_mov_b32 s11, 0x20000
    s_mov_b32 s6, 2
L_k1_prefloop:
    s_waitcnt vmcnt(15)
    buffer_load_dwordx4 v[16:19], v1, s[8:11], s3 offen
    s_add_u32 s3, s3, 8192
    s_waitcnt vmcnt(15)
    buffer_load_dwordx4 v[20:23], v1, s[8:11], s3 offen
    s_add_u32 s3, s3, 8192
    s_waitcnt vmcnt(15)
    buffer_load_dwordx4 v[24:27], v1, s[8:11], s3 offen
    s_add_u32 s3, s3, 8192
    s_waitcnt vmcnt(15)
    buffer_load_dwordx4 v[28:31], v1, s[8:11], s3 offen
    s_add_u32 s3, s3, 8192
    s_waitcnt vmcnt(15)
    buffer_load_dwordx4 v[32:35], v1, s[8:11], s3 offen
    s_add_u32 s3, s3, 8192
    s_waitcnt vmcnt(15)
    buffer_load_dwordx4 v[36:39], v1, s[8:11], s3 offen
    s_add_u32 s3, s3, 8192
    s_waitcnt vmcnt(15)
    buffer_load_dwordx4 v[40:43], v1, s[8:11], s3 offen
    s_add_u32 s3, s3, 8192
    s_waitcnt vmcnt(15)
    buffer_load_dwordx4 v[44:47], v1, s[8:11], s3 offen
    s_add_u32 s3, s3, 8192
    s_waitcnt vmcnt(15)
    buffer_load_dwordx4 v[48:51], v1, s[8:11], s3 offen
    s_add_u32 s3, s3, 8192
    s_waitcnt vmcnt(15)
    buffer_load_dwordx4 v[52:55], v1, s[8:11], s3 offen
    s_add_u32 s3, s3, 8192
    s_waitcnt vmcnt(15)
    buffer_load_dwordx4 v[56:59], v1, s[8:11], s3 offen
    s_add_u32 s3, s3, 8192
    s_waitcnt vmcnt(15)
    buffer_load_dwordx4 v[60:63], v1, s[8:11], s3 offen
    s_add_u32 s3, s3, 8192
    s_waitcnt vmcnt(15)
    buffer_load_dwordx4 v[64:67], v1, s[8:11], s3 offen
    s_add_u32 s3, s3, 8192
    s_waitcnt vmcnt(15)
    buffer_load_dwordx4 v[68:71], v1, s[8:11], s3 offen
    s_add_u32 s3, s3, 8192
    s_waitcnt vmcnt(15)
    buffer_load_dwordx4 v[72:75], v1, s[8:11], s3 offen
    s_add_u32 s3, s3, 8192
    s_waitcnt vmcnt(15)
    buffer_load_dwordx4 v[76:79], v1, s[8:11], s3 offen
    s_add_u32 s3, s3, 8192
    s_sub_u32 s6, s6, 1
    s_cmp_lg_u32 s6, 0
    s_cbranch_scc1 L_k1_prefloop
    s_endpgm
.section .rodata,"a"
.p2align 6
.amdhsa_kernel k1_kernel
  .amdhsa_next_free_vgpr 256
  .amdhsa_next_free_sgpr 100
  .amdhsa_accum_offset 232
  .amdhsa_group_segment_fixed_size 0
  .amdhsa_kernarg_size 88
  .amdhsa_user_sgpr_count 2
  .amdhsa_user_sgpr_kernarg_segment_ptr 1
  .amdhsa_system_sgpr_workgroup_id_x 1
.end_amdhsa_kernel

.text
.globl k2_kernel
.p2align 8
.type k2_kernel,@function
k2_kernel:
    s_cmp_ge_u32 s2, 256
    s_cbranch_scc1 L_k2_end
    s_load_dwordx4 s[4:7], s[0:1], 40
    s_load_dwordx2 s[8:9], s[0:1], 80
    v_lshrrev_b32 v1, 6, v0
    v_and_b32 v0, 63, v0
    v_readfirstlane_b32 s3, v1
    v_lshlrev_b32 v1, 4, v0
    s_and_b32 s10, s2, 7
    s_lshr_b32 s11, s2, 3
    s_waitcnt lgkmcnt(0)
    s_mov_b32 s28, s8
    s_and_b32 s29, s9, 0xffff
    s_mov_b32 s30, 25165824
    s_mov_b32 s31, 0x20000
    s_cmp_ge_u32 s3, 4
    s_cbranch_scc1 L_k2_gemm
    s_setprio 2
    s_lshr_b32 s12, s11, 4
    s_lshl_b32 s13, s10, 1
    s_add_u32 s12, s12, s13
    s_and_b32 s13, s11, 15
    s_lshl_b32 s14, s12, 18
    s_lshl_b32 s15, s3, 16
    s_add_u32 s14, s14, s15
    s_add_u32 s14, s14, 2097152
    s_add_u32 s32, s8, s14
    s_addc_u32 s33, s9, 0
    s_and_b32 s33, s33, 0xffff
    s_mov_b32 s34, 65536
    s_mov_b32 s35, 0x20000
    buffer_load_dwordx4 a[64:67], v1, s[32:35], 0 offen offset:0
    buffer_load_dwordx4 a[68:71], v1, s[32:35], 0 offen offset:1024
    buffer_load_dwordx4 a[72:75], v1, s[32:35], 0 offen offset:2048
    buffer_load_dwordx4 a[76:79], v1, s[32:35], 0 offen offset:3072
    s_lshl_b32 s14, s12, 17
    s_lshl_b32 s15, s13, 13
    s_add_u32 s14, s14, s15
    s_add_u32 s15, s3, 0
    s_and_b32 s15, s15, 3
    s_lshl_b32 s15, s15, 11
    s_add_u32 s15, s15, s14
    buffer_load_dwordx4 v[56:59], v1, s[28:31], s15 offen
    buffer_load_dwordx4 v[60:63], v1, s[28:31], s15 offen offset:1024
    s_add_u32 s15, s3, 1
    s_and_b32 s15, s15, 3
    s_lshl_b32 s15, s15, 11
    s_add_u32 s15, s15, s14
    buffer_load_dwordx4 v[64:67], v1, s[28:31], s15 offen
    buffer_load_dwordx4 v[68:71], v1, s[28:31], s15 offen offset:1024
    s_add_u32 s15, s3, 2
    s_and_b32 s15, s15, 3
    s_lshl_b32 s15, s15, 11
    s_add_u32 s15, s15, s14
    buffer_load_dwordx4 v[72:75], v1, s[28:31], s15 offen
    buffer_load_dwordx4 v[76:79], v1, s[28:31], s15 offen offset:1024
    s_add_u32 s15, s3, 3
    s_and_b32 s15, s15, 3
    s_lshl_b32 s15, s15, 11
    s_add_u32 s15, s15, s14
    buffer_load_dwordx4 v[80:83], v1, s[28:31], s15 offen
    buffer_load_dwordx4 v[84:87], v1, s[28:31], s15 offen offset:1024
    s_mov_b32 s16, 4096
    s_mov_b32 s17, 8192
    buffer_load_dwordx4 a[80:83], v1, s[32:35], s16 offen offset:0
    buffer_load_dwordx4 a[84:87], v1, s[32:35], s16 offen offset:1024
    buffer_load_dwordx4 a[88:91], v1, s[32:35], s16 offen offset:2048
    buffer_load_dwordx4 a[92:95], v1, s[32:35], s16 offen offset:3072
    buffer_load_dwordx4 a[96:99], v1, s[32:35], s17 offen offset:0
    buffer_load_dwordx4 a[100:103], v1, s[32:35], s17 offen offset:1024
    buffer_load_dwordx4 a[104:107], v1, s[32:35], s17 offen offset:2048
    buffer_load_dwordx4 a[108:111], v1, s[32:35], s17 offen offset:3072
    s_mov_b32 s18, 0
    s_mov_b32 exec_lo, 0
    s_waitcnt vmcnt(14)
    v_mov_b32 v62, 0
    v_mov_b32 v63, 0
    s_waitcnt vmcnt(12)
    v_mov_b32 v70, 0
    v_mov_b32 v71, 0
    s_waitcnt vmcnt(10)
    v_mov_b32 v78, 0
    v_mov_b32 v79, 0
    s_waitcnt vmcnt(8)
    v_mov_b32 v86, 0
    v_mov_b32 v87, 0
    s_mov_b32 exec_lo, -1
    v_mfma_f32_32x32x16_bf16 v[16:31], a[64:67], v[56:59], 0
    v_mfma_f32_32x32x16_bf16 v[16:31], a[68:71], v[60:63], v[16:31]
    v_mfma_f32_32x32x16_bf16 v[32:47], a[64:67], v[64:67], 0
    v_mfma_f32_32x32x16_bf16 v[32:47], a[68:71], v[68:71], v[32:47]
    s_nop 9
    v_max3_f32 v88, v16, v17, v18
    v_max_f32 v88, v88, v19
    v_max3_f32 v88, v88, v20, v21
    v_max3_f32 v88, v88, v22, v23
    v_max3_f32 v88, v88, v24, v25
    v_max3_f32 v88, v88, v26, v27
    v_max3_f32 v88, v88, v28, v29
    v_max3_f32 v88, v88, v30, v31
    v_mfma_f32_32x32x16_bf16 v[16:31], a[64:67], v[72:75], 0
    v_mfma_f32_32x32x16_bf16 v[16:31], a[68:71], v[76:79], v[16:31]
    v_max3_f32 v89, v32, v33, v34
    v_max_f32 v89, v89, v35
    v_max3_f32 v89, v89, v36, v37
    v_max3_f32 v89, v89, v38, v39
    v_max3_f32 v89, v89, v40, v41
    v_max3_f32 v89, v89, v42, v43
    v_max3_f32 v89, v89, v44, v45
    v_max3_f32 v89, v89, v46, v47
    v_mfma_f32_32x32x16_bf16 v[32:47], a[64:67], v[80:83], 0
    v_mfma_f32_32x32x16_bf16 v[32:47], a[68:71], v[84:87], v[32:47]
    s_nop 1
    v_max3_f32 v90, v16, v17, v18
    v_max_f32 v90, v90, v19
    v_max3_f32 v90, v90, v20, v21
    v_max3_f32 v90, v90, v22, v23
    v_max3_f32 v90, v90, v24, v25
    v_max3_f32 v90, v90, v26, v27
    v_max3_f32 v90, v90, v28, v29
    v_max3_f32 v90, v90, v30, v31
    s_nop 1
    v_max3_f32 v91, v32, v33, v34
    v_max_f32 v91, v91, v35
    v_max3_f32 v91, v91, v36, v37
    v_max3_f32 v91, v91, v38, v39
    v_max3_f32 v91, v91, v40, v41
    v_max3_f32 v91, v91, v42, v43
    v_max3_f32 v91, v91, v44, v45
    v_max3_f32 v91, v91, v46, v47
    v_mov_b32 v92, v88
    v_mov_b32 v93, v89
    v_mov_b32 v94, v90
    v_mov_b32 v95, v91
    v_permlane32_swap_b32 v88, v92
    v_permlane32_swap_b32 v89, v93
    v_permlane32_swap_b32 v90, v94
    v_permlane32_swap_b32 v91, v95
    v_max_f32 v88, v88, v92
    v_add_f32 v88, 0x42c00000, v88
    v_max_f32 v89, v89, v93
    v_add_f32 v89, 0x42c00000, v89
    v_max_f32 v90, v90, v94
    v_add_f32 v90, 0x42c00000, v90
    v_max_f32 v91, v91, v95
    v_add_f32 v91, 0x42c00000, v91
    v_sub_f32 v99, 0, v88
    v_and_b32 v96, 0xffff0000, v99
    v_sub_f32 v99, v99, v96
    v_and_b32 v97, 0xffff0000, v99
    v_sub_f32 v99, v99, v97
    v_and_b32 v98, 0xffff0000, v99
    v_add_f32 v99, v96, v97
    v_add_f32 v99, v99, v98
    v_sub_f32 v88, 0, v99
    s_mov_b32 exec_lo, 0
    v_lshrrev_b32 v96, 16, v96
    v_or_b32 v62, v96, v97
    v_lshrrev_b32 v63, 16, v98
    s_mov_b32 exec_lo, -1
    v_sub_f32 v99, 0, v89
    v_and_b32 v96, 0xffff0000, v99
    v_sub_f32 v99, v99, v96
    v_and_b32 v97, 0xffff0000, v99
    v_sub_f32 v99, v99, v97
    v_and_b32 v98, 0xffff0000, v99
    v_add_f32 v99, v96, v97
    v_add_f32 v99, v99, v98
    v_sub_f32 v89, 0, v99
    s_mov_b32 exec_lo, 0
    v_lshrrev_b32 v96, 16, v96
    v_or_b32 v70, v96, v97
    v_lshrrev_b32 v71, 16, v98
    s_mov_b32 exec_lo, -1
    v_sub_f32 v99, 0, v90
    v_and_b32 v96, 0xffff0000, v99
    v_sub_f32 v99, v99, v96
    v_and_b32 v97, 0xffff0000, v99
    v_sub_f32 v99, v99, v97
    v_and_b32 v98, 0xffff0000, v99
    v_add_f32 v99, v96, v97
    v_add_f32 v99, v99, v98
    v_sub_f32 v90, 0, v99
    s_mov_b32 exec_lo, 0
    v_lshrrev_b32 v96, 16, v96
    v_or_b32 v78, v96, v97
    v_lshrrev_b32 v79, 16, v98
    s_mov_b32 exec_lo, -1
    v_sub_f32 v99, 0, v91
    v_and_b32 v96, 0xffff0000, v99
    v_sub_f32 v99, v99, v96
    v_and_b32 v97, 0xffff0000, v99
    v_sub_f32 v99, v99, v97
    v_and_b32 v98, 0xffff0000, v99
    v_add_f32 v99, v96, v97
    v_add_f32 v99, v99, v98
    v_sub_f32 v91, 0, v99
    s_mov_b32 exec_lo, 0
    v_lshrrev_b32 v96, 16, v96
    v_or_b32 v86, v96, v97
    v_lshrrev_b32 v87, 16, v98
    s_mov_b32 exec_lo, -1
L_k2_amain:
    v_mov_b32 v52, 0
    s_waitcnt vmcnt(12)
    v_accvgpr_write_b32 a124, 0
    v_mov_b32 v53, 0
    v_accvgpr_write_b32 a125, 0
    v_mov_b32 v54, 0
    v_accvgpr_write_b32 a126, 0
    v_mov_b32 v55, 0
    v_accvgpr_write_b32 a127, 0
    s_nop 0
    v_mfma_f32_32x32x16_bf16 a[0:15], v[52:55], v[52:55], 0
    v_mfma_f32_32x32x16_bf16 a[16:31], v[52:55], v[52:55], 0
    v_mfma_f32_32x32x16_bf16 a[32:47], v[52:55], v[52:55], 0
    v_mfma_f32_32x32x16_bf16 a[48:63], v[52:55], v[52:55], 0
    s_waitcnt vmcnt(11)
    v_mfma_f32_32x32x16_bf16 v[16:31], a[64:67], v[56:59], 0
    s_waitcnt vmcnt(10)
    v_mfma_f32_32x32x16_bf16 v[16:31], a[68:71], v[60:63], v[16:31]
    s_mov_b32 s16, 12288
    s_mov_b32 s19, 4
L_k2_aloop:
    v_mfma_f32_32x32x16_bf16 v[32:47], a[64:67], v[64:67], 0
    s_nop 8
    v_exp_f32 v16, v16
    v_exp_f32 v17, v17
    v_exp_f32 v18, v18
    v_exp_f32 v19, v19
    v_cvt_pk_bf16_f32 v48, v16, v17
    v_cvt_pk_bf16_f32 v49, v18, v19
    v_mfma_f32_32x32x16_bf16 a[48:63], a[124:127], v[52:55], a[48:63]
    v_exp_f32 v20, v20
    v_exp_f32 v21, v21
    v_exp_f32 v22, v22
    v_exp_f32 v23, v23
    v_cvt_pk_bf16_f32 v50, v20, v21
    v_cvt_pk_bf16_f32 v51, v22, v23
    v_mfma_f32_32x32x16_bf16 v[32:47], a[68:71], v[68:71], v[32:47]
    v_exp_f32 v24, v24
    v_exp_f32 v25, v25
    v_exp_f32 v26, v26
    v_exp_f32 v27, v27
    v_cvt_pk_bf16_f32 v52, v24, v25
    v_cvt_pk_bf16_f32 v53, v26, v27
    s_waitcnt vmcnt(9)
    v_mfma_f32_32x32x16_bf16 a[0:15], a[72:75], v[48:51], a[0:15]
    v_exp_f32 v28, v28
    v_exp_f32 v29, v29
    v_exp_f32 v30, v30
    v_exp_f32 v31, v31
    v_cvt_pk_bf16_f32 v54, v28, v29
    v_cvt_pk_bf16_f32 v55, v30, v31
    v_mfma_f32_32x32x16_bf16 v[16:31], a[64:67], v[72:75], 0
    v_exp_f32 v32, v32
    v_exp_f32 v33, v33
    v_exp_f32 v34, v34
    v_exp_f32 v35, v35
    v_cvt_pk_bf16_f32 v48, v32, v33
    v_cvt_pk_bf16_f32 v49, v34, v35
    s_waitcnt vmcnt(8)
    v_mfma_f32_32x32x16_bf16 a[0:15], a[76:79], v[52:55], a[0:15]
    v_exp_f32 v36, v36
    v_exp_f32 v37, v37
    v_exp_f32 v38, v38
    v_exp_f32 v39, v39
    v_cvt_pk_bf16_f32 v50, v36, v37
    v_cvt_pk_bf16_f32 v51, v38, v39
    v_mfma_f32_32x32x16_bf16 v[16:31], a[68:71], v[76:79], v[16:31]
    v_exp_f32 v40, v40
    v_exp_f32 v41, v41
    v_exp_f32 v42, v42
    v_exp_f32 v43, v43
    v_cvt_pk_bf16_f32 v52, v40, v41
    v_cvt_pk_bf16_f32 v53, v42, v43
    v_mfma_f32_32x32x16_bf16 a[16:31], a[72:75], v[48:51], a[16:31]
    v_exp_f32 v44, v44
    v_exp_f32 v45, v45
    v_exp_f32 v46, v46
    v_exp_f32 v47, v47
    v_cvt_pk_bf16_f32 v54, v44, v45
    v_cvt_pk_bf16_f32 v55, v46, v47
    buffer_load_dwordx4 a[112:115], v1, s[32:35], s16 offen offset:0
    buffer_load_dwordx4 a[116:119], v1, s[32:35], s16 offen offset:1024
    buffer_load_dwordx4 a[120:123], v1, s[32:35], s16 offen offset:2048
    buffer_load_dwordx4 a[124:127], v1, s[32:35], s16 offen offset:3072
    s_add_u32 s16, s16, 4096
    v_mfma_f32_32x32x16_bf16 v[32:47], a[64:67], v[80:83], 0
    v_exp_f32 v16, v16
    v_exp_f32 v17, v17
    v_exp_f32 v18, v18
    v_exp_f32 v19, v19
    v_cvt_pk_bf16_f32 v48, v16, v17
    v_cvt_pk_bf16_f32 v49, v18, v19
    v_mfma_f32_32x32x16_bf16 a[16:31], a[76:79], v[52:55], a[16:31]
    v_exp_f32 v20, v20
    v_exp_f32 v21, v21
    v_exp_f32 v22, v22
    v_exp_f32 v23, v23
    v_cvt_pk_bf16_f32 v50, v20, v21
    v_cvt_pk_bf16_f32 v51, v22, v23
    v_mfma_f32_32x32x16_bf16 v[32:47], a[68:71], v[84:87], v[32:47]
    v_exp_f32 v24, v24
    v_exp_f32 v25, v25
    v_exp_f32 v26, v26
    v_exp_f32 v27, v27
    v_cvt_pk_bf16_f32 v52, v24, v25
    v_cvt_pk_bf16_f32 v53, v26, v27
    v_mfma_f32_32x32x16_bf16 a[32:47], a[72:75], v[48:51], a[32:47]
    v_exp_f32 v28, v28
    v_exp_f32 v29, v29
    v_exp_f32 v30, v30
    v_exp_f32 v31, v31
    v_cvt_pk_bf16_f32 v54, v28, v29
    v_cvt_pk_bf16_f32 v55, v30, v31
    s_waitcnt vmcnt(11)
    v_mfma_f32_32x32x16_bf16 v[16:31], a[80:83], v[56:59], 0
    v_exp_f32 v32, v32
    v_exp_f32 v33, v33
    v_exp_f32 v34, v34
    v_exp_f32 v35, v35
    v_cvt_pk_bf16_f32 v48, v32, v33
    v_cvt_pk_bf16_f32 v49, v34, v35
    v_mfma_f32_32x32x16_bf16 a[32:47], a[76:79], v[52:55], a[32:47]
    v_exp_f32 v36, v36
    v_exp_f32 v37, v37
    v_exp_f32 v38, v38
    v_exp_f32 v39, v39
    v_cvt_pk_bf16_f32 v50, v36, v37
    v_cvt_pk_bf16_f32 v51, v38, v39
    s_waitcnt vmcnt(10)
    v_mfma_f32_32x32x16_bf16 v[16:31], a[84:87], v[60:63], v[16:31]
    v_exp_f32 v40, v40
    v_exp_f32 v41, v41
    v_exp_f32 v42, v42
    v_exp_f32 v43, v43
    v_cvt_pk_bf16_f32 v52, v40, v41
    v_cvt_pk_bf16_f32 v53, v42, v43
    v_mfma_f32_32x32x16_bf16 a[48:63], a[72:75], v[48:51], a[48:63]
    v_exp_f32 v44, v44
    v_exp_f32 v45, v45
    v_exp_f32 v46, v46
    v_exp_f32 v47, v47
    v_cvt_pk_bf16_f32 v54, v44, v45
    v_cvt_pk_bf16_f32 v55, v46, v47
    v_mfma_f32_32x32x16_bf16 v[32:47], a[80:83], v[64:67], 0
    v_exp_f32 v16, v16
    v_exp_f32 v17, v17
    v_exp_f32 v18, v18
    v_exp_f32 v19, v19
    v_cvt_pk_bf16_f32 v48, v16, v17
    v_cvt_pk_bf16_f32 v49, v18, v19
    v_mfma_f32_32x32x16_bf16 a[48:63], a[76:79], v[52:55], a[48:63]
    v_exp_f32 v20, v20
    v_exp_f32 v21, v21
    v_exp_f32 v22, v22
    v_exp_f32 v23, v23
    v_cvt_pk_bf16_f32 v50, v20, v21
    v_cvt_pk_bf16_f32 v51, v22, v23
    v_mfma_f32_32x32x16_bf16 v[32:47], a[84:87], v[68:71], v[32:47]
    v_exp_f32 v24, v24
    v_exp_f32 v25, v25
    v_exp_f32 v26, v26
    v_exp_f32 v27, v27
    v_cvt_pk_bf16_f32 v52, v24, v25
    v_cvt_pk_bf16_f32 v53, v26, v27
    s_waitcnt vmcnt(9)
    v_mfma_f32_32x32x16_bf16 a[0:15], a[88:91], v[48:51], a[0:15]
    v_exp_f32 v28, v28
    v_exp_f32 v29, v29
    v_exp_f32 v30, v30
    v_exp_f32 v31, v31
    v_cvt_pk_bf16_f32 v54, v28, v29
    v_cvt_pk_bf16_f32 v55, v30, v31
    v_mfma_f32_32x32x16_bf16 v[16:31], a[80:83], v[72:75], 0
    v_exp_f32 v32, v32
    v_exp_f32 v33, v33
    v_exp_f32 v34, v34
    v_exp_f32 v35, v35
    v_cvt_pk_bf16_f32 v48, v32, v33
    v_cvt_pk_bf16_f32 v49, v34, v35
    s_waitcnt vmcnt(8)
    v_mfma_f32_32x32x16_bf16 a[0:15], a[92:95], v[52:55], a[0:15]
    v_exp_f32 v36, v36
    v_exp_f32 v37, v37
    v_exp_f32 v38, v38
    v_exp_f32 v39, v39
    v_cvt_pk_bf16_f32 v50, v36, v37
    v_cvt_pk_bf16_f32 v51, v38, v39
    v_mfma_f32_32x32x16_bf16 v[16:31], a[84:87], v[76:79], v[16:31]
    v_exp_f32 v40, v40
    v_exp_f32 v41, v41
    v_exp_f32 v42, v42
    v_exp_f32 v43, v43
    v_cvt_pk_bf16_f32 v52, v40, v41
    v_cvt_pk_bf16_f32 v53, v42, v43
    v_mfma_f32_32x32x16_bf16 a[16:31], a[88:91], v[48:51], a[16:31]
    v_exp_f32 v44, v44
    v_exp_f32 v45, v45
    v_exp_f32 v46, v46
    v_exp_f32 v47, v47
    v_cvt_pk_bf16_f32 v54, v44, v45
    v_cvt_pk_bf16_f32 v55, v46, v47
    buffer_load_dwordx4 a[64:67], v1, s[32:35], s16 offen offset:0
    buffer_load_dwordx4 a[68:71], v1, s[32:35], s16 offen offset:1024
    buffer_load_dwordx4 a[72:75], v1, s[32:35], s16 offen offset:2048
    buffer_load_dwordx4 a[76:79], v1, s[32:35], s16 offen offset:3072
    s_add_u32 s16, s16, 4096
    v_mfma_f32_32x32x16_bf16 v[32:47], a[80:83], v[80:83], 0
    v_exp_f32 v16, v16
    v_exp_f32 v17, v17
    v_exp_f32 v18, v18
    v_exp_f32 v19, v19
    v_cvt_pk_bf16_f32 v48, v16, v17
    v_cvt_pk_bf16_f32 v49, v18, v19
    v_mfma_f32_32x32x16_bf16 a[16:31], a[92:95], v[52:55], a[16:31]
    v_exp_f32 v20, v20
    v_exp_f32 v21, v21
    v_exp_f32 v22, v22
    v_exp_f32 v23, v23
    v_cvt_pk_bf16_f32 v50, v20, v21
    v_cvt_pk_bf16_f32 v51, v22, v23
    v_mfma_f32_32x32x16_bf16 v[32:47], a[84:87], v[84:87], v[32:47]
    v_exp_f32 v24, v24
    v_exp_f32 v25, v25
    v_exp_f32 v26, v26
    v_exp_f32 v27, v27
    v_cvt_pk_bf16_f32 v52, v24, v25
    v_cvt_pk_bf16_f32 v53, v26, v27
    v_mfma_f32_32x32x16_bf16 a[32:47], a[88:91], v[48:51], a[32:47]
    v_exp_f32 v28, v28
    v_exp_f32 v29, v29
    v_exp_f32 v30, v30
    v_exp_f32 v31, v31
    v_cvt_pk_bf16_f32 v54, v28, v29
    v_cvt_pk_bf16_f32 v55, v30, v31
    s_waitcnt vmcnt(11)
    v_mfma_f32_32x32x16_bf16 v[16:31], a[96:99], v[56:59], 0
    v_exp_f32 v32, v32
    v_exp_f32 v33, v33
    v_exp_f32 v34, v34
    v_exp_f32 v35, v35
    v_cvt_pk_bf16_f32 v48, v32, v33
    v_cvt_pk_bf16_f32 v49, v34, v35
    v_mfma_f32_32x32x16_bf16 a[32:47], a[92:95], v[52:55], a[32:47]
    v_exp_f32 v36, v36
    v_exp_f32 v37, v37
    v_exp_f32 v38, v38
    v_exp_f32 v39, v39
    v_cvt_pk_bf16_f32 v50, v36, v37
    v_cvt_pk_bf16_f32 v51, v38, v39
    s_waitcnt vmcnt(10)
    v_mfma_f32_32x32x16_bf16 v[16:31], a[100:103], v[60:63], v[16:31]
    v_exp_f32 v40, v40
    v_exp_f32 v41, v41
    v_exp_f32 v42, v42
    v_exp_f32 v43, v43
    v_cvt_pk_bf16_f32 v52, v40, v41
    v_cvt_pk_bf16_f32 v53, v42, v43
    v_mfma_f32_32x32x16_bf16 a[48:63], a[88:91], v[48:51], a[48:63]
    v_exp_f32 v44, v44
    v_exp_f32 v45, v45
    v_exp_f32 v46, v46
    v_exp_f32 v47, v47
    v_cvt_pk_bf16_f32 v54, v44, v45
    v_cvt_pk_bf16_f32 v55, v46, v47
    v_mfma_f32_32x32x16_bf16 v[32:47], a[96:99], v[64:67], 0
    v_exp_f32 v16, v16
    v_exp_f32 v17, v17
    v_exp_f32 v18, v18
    v_exp_f32 v19, v19
    v_cvt_pk_bf16_f32 v48, v16, v17
    v_cvt_pk_bf16_f32 v49, v18, v19
    v_mfma_f32_32x32x16_bf16 a[48:63], a[92:95], v[52:55], a[48:63]
    v_exp_f32 v20, v20
    v_exp_f32 v21, v21
    v_exp_f32 v22, v22
    v_exp_f32 v23, v23
    v_cvt_pk_bf16_f32 v50, v20, v21
    v_cvt_pk_bf16_f32 v51, v22, v23
    v_mfma_f32_32x32x16_bf16 v[32:47], a[100:103], v[68:71], v[32:47]
    v_exp_f32 v24, v24
    v_exp_f32 v25, v25
    v_exp_f32 v26, v26
    v_exp_f32 v27, v27
    v_cvt_pk_bf16_f32 v52, v24, v25
    v_cvt_pk_bf16_f32 v53, v26, v27
    s_waitcnt vmcnt(9)
    v_mfma_f32_32x32x16_bf16 a[0:15], a[104:107], v[48:51], a[0:15]
    v_exp_f32 v28, v28
    v_exp_f32 v29, v29
    v_exp_f32 v30, v30
    v_exp_f32 v31, v31
    v_cvt_pk_bf16_f32 v54, v28, v29
    v_cvt_pk_bf16_f32 v55, v30, v31
    v_mfma_f32_32x32x16_bf16 v[16:31], a[96:99], v[72:75], 0
    v_exp_f32 v32, v32
    v_exp_f32 v33, v33
    v_exp_f32 v34, v34
    v_exp_f32 v35, v35
    v_cvt_pk_bf16_f32 v48, v32, v33
    v_cvt_pk_bf16_f32 v49, v34, v35
    s_waitcnt vmcnt(8)
    v_mfma_f32_32x32x16_bf16 a[0:15], a[108:111], v[52:55], a[0:15]
    v_exp_f32 v36, v36
    v_exp_f32 v37, v37
    v_exp_f32 v38, v38
    v_exp_f32 v39, v39
    v_cvt_pk_bf16_f32 v50, v36, v37
    v_cvt_pk_bf16_f32 v51, v38, v39
    v_mfma_f32_32x32x16_bf16 v[16:31], a[100:103], v[76:79], v[16:31]
    v_exp_f32 v40, v40
    v_exp_f32 v41, v41
    v_exp_f32 v42, v42
    v_exp_f32 v43, v43
    v_cvt_pk_bf16_f32 v52, v40, v41
    v_cvt_pk_bf16_f32 v53, v42, v43
    v_mfma_f32_32x32x16_bf16 a[16:31], a[104:107], v[48:51], a[16:31]
    v_exp_f32 v44, v44
    v_exp_f32 v45, v45
    v_exp_f32 v46, v46
    v_exp_f32 v47, v47
    v_cvt_pk_bf16_f32 v54, v44, v45
    v_cvt_pk_bf16_f32 v55, v46, v47
    buffer_load_dwordx4 a[80:83], v1, s[32:35], s16 offen offset:0
    buffer_load_dwordx4 a[84:87], v1, s[32:35], s16 offen offset:1024
    buffer_load_dwordx4 a[88:91], v1, s[32:35], s16 offen offset:2048
    buffer_load_dwordx4 a[92:95], v1, s[32:35], s16 offen offset:3072
    s_add_u32 s16, s16, 4096
    v_mfma_f32_32x32x16_bf16 v[32:47], a[96:99], v[80:83], 0
    v_exp_f32 v16, v16
    v_exp_f32 v17, v17
    v_exp_f32 v18, v18
    v_exp_f32 v19, v19
    v_cvt_pk_bf16_f32 v48, v16, v17
    v_cvt_pk_bf16_f32 v49, v18, v19
    v_mfma_f32_32x32x16_bf16 a[16:31], a[108:111], v[52:55], a[16:31]
    v_exp_f32 v20, v20
    v_exp_f32 v21, v21
    v_exp_f32 v22, v22
    v_exp_f32 v23, v23
    v_cvt_pk_bf16_f32 v50, v20, v21
    v_cvt_pk_bf16_f32 v51, v22, v23
    v_mfma_f32_32x32x16_bf16 v[32:47], a[100:103], v[84:87], v[32:47]
    v_exp_f32 v24, v24
    v_exp_f32 v25, v25
    v_exp_f32 v26, v26
    v_exp_f32 v27, v27
    v_cvt_pk_bf16_f32 v52, v24, v25
    v_cvt_pk_bf16_f32 v53, v26, v27
    v_mfma_f32_32x32x16_bf16 a[32:47], a[104:107], v[48:51], a[32:47]
    v_exp_f32 v28, v28
    v_exp_f32 v29, v29
    v_exp_f32 v30, v30
    v_exp_f32 v31, v31
    v_cvt_pk_bf16_f32 v54, v28, v29
    v_cvt_pk_bf16_f32 v55, v30, v31
    s_waitcnt vmcnt(11)
    v_mfma_f32_32x32x16_bf16 v[16:31], a[112:115], v[56:59], 0
    v_exp_f32 v32, v32
    v_exp_f32 v33, v33
    v_exp_f32 v34, v34
    v_exp_f32 v35, v35
    v_cvt_pk_bf16_f32 v48, v32, v33
    v_cvt_pk_bf16_f32 v49, v34, v35
    v_mfma_f32_32x32x16_bf16 a[32:47], a[108:111], v[52:55], a[32:47]
    v_exp_f32 v36, v36
    v_exp_f32 v37, v37
    v_exp_f32 v38, v38
    v_exp_f32 v39, v39
    v_cvt_pk_bf16_f32 v50, v36, v37
    v_cvt_pk_bf16_f32 v51, v38, v39
    s_waitcnt vmcnt(10)
    v_mfma_f32_32x32x16_bf16 v[16:31], a[116:119], v[60:63], v[16:31]
    v_exp_f32 v40, v40
    v_exp_f32 v41, v41
    v_exp_f32 v42, v42
    v_exp_f32 v43, v43
    v_cvt_pk_bf16_f32 v52, v40, v41
    v_cvt_pk_bf16_f32 v53, v42, v43
    v_mfma_f32_32x32x16_bf16 a[48:63], a[104:107], v[48:51], a[48:63]
    v_exp_f32 v44, v44
    v_exp_f32 v45, v45
    v_exp_f32 v46, v46
    v_exp_f32 v47, v47
    v_cvt_pk_bf16_f32 v54, v44, v45
    v_cvt_pk_bf16_f32 v55, v46, v47
    v_mfma_f32_32x32x16_bf16 v[32:47], a[112:115], v[64:67], 0
    v_exp_f32 v16, v16
    v_exp_f32 v17, v17
    v_exp_f32 v18, v18
    v_exp_f32 v19, v19
    v_cvt_pk_bf16_f32 v48, v16, v17
    v_cvt_pk_bf16_f32 v49, v18, v19
    v_mfma_f32_32x32x16_bf16 a[48:63], a[108:111], v[52:55], a[48:63]
    v_exp_f32 v20, v20
    v_exp_f32 v21, v21
    v_exp_f32 v22, v22
    v_exp_f32 v23, v23
    v_cvt_pk_bf16_f32 v50, v20, v21
    v_cvt_pk_bf16_f32 v51, v22, v23
    v_mfma_f32_32x32x16_bf16 v[32:47], a[116:119], v[68:71], v[32:47]
    v_exp_f32 v24, v24
    v_exp_f32 v25, v25
    v_exp_f32 v26, v26
    v_exp_f32 v27, v27
    v_cvt_pk_bf16_f32 v52, v24, v25
    v_cvt_pk_bf16_f32 v53, v26, v27
    s_waitcnt vmcnt(9)
    v_mfma_f32_32x32x16_bf16 a[0:15], a[120:123], v[48:51], a[0:15]
    v_exp_f32 v28, v28
    v_exp_f32 v29, v29
    v_exp_f32 v30, v30
    v_exp_f32 v31, v31
    v_cvt_pk_bf16_f32 v54, v28, v29
    v_cvt_pk_bf16_f32 v55, v30, v31
    v_mfma_f32_32x32x16_bf16 v[16:31], a[112:115], v[72:75], 0
    v_exp_f32 v32, v32
    v_exp_f32 v33, v33
    v_exp_f32 v34, v34
    v_exp_f32 v35, v35
    v_cvt_pk_bf16_f32 v48, v32, v33
    v_cvt_pk_bf16_f32 v49, v34, v35
    s_waitcnt vmcnt(8)
    v_mfma_f32_32x32x16_bf16 a[0:15], a[124:127], v[52:55], a[0:15]
    v_exp_f32 v36, v36
    v_exp_f32 v37, v37
    v_exp_f32 v38, v38
    v_exp_f32 v39, v39
    v_cvt_pk_bf16_f32 v50, v36, v37
    v_cvt_pk_bf16_f32 v51, v38, v39
    v_mfma_f32_32x32x16_bf16 v[16:31], a[116:119], v[76:79], v[16:31]
    v_exp_f32 v40, v40
    v_exp_f32 v41, v41
    v_exp_f32 v42, v42
    v_exp_f32 v43, v43
    v_cvt_pk_bf16_f32 v52, v40, v41
    v_cvt_pk_bf16_f32 v53, v42, v43
    v_mfma_f32_32x32x16_bf16 a[16:31], a[120:123], v[48:51], a[16:31]
    v_exp_f32 v44, v44
    v_exp_f32 v45, v45
    v_exp_f32 v46, v46
    v_exp_f32 v47, v47
    v_cvt_pk_bf16_f32 v54, v44, v45
    v_cvt_pk_bf16_f32 v55, v46, v47
    buffer_load_dwordx4 a[96:99], v1, s[32:35], s16 offen offset:0
    buffer_load_dwordx4 a[100:103], v1, s[32:35], s16 offen offset:1024
    buffer_load_dwordx4 a[104:107], v1, s[32:35], s16 offen offset:2048
    buffer_load_dwordx4 a[108:111], v1, s[32:35], s16 offen offset:3072
    s_add_u32 s16, s16, 4096
    v_mfma_f32_32x32x16_bf16 v[32:47], a[112:115], v[80:83], 0
    v_exp_f32 v16, v16
    v_exp_f32 v17, v17
    v_exp_f32 v18, v18
    v_exp_f32 v19, v19
    v_cvt_pk_bf16_f32 v48, v16, v17
    v_cvt_pk_bf16_f32 v49, v18, v19
    v_mfma_f32_32x32x16_bf16 a[16:31], a[124:127], v[52:55], a[16:31]
    v_exp_f32 v20, v20
    v_exp_f32 v21, v21
    v_exp_f32 v22, v22
    v_exp_f32 v23, v23
    v_cvt_pk_bf16_f32 v50, v20, v21
    v_cvt_pk_bf16_f32 v51, v22, v23
    v_mfma_f32_32x32x16_bf16 v[32:47], a[116:119], v[84:87], v[32:47]
    v_exp_f32 v24, v24
    v_exp_f32 v25, v25
    v_exp_f32 v26, v26
    v_exp_f32 v27, v27
    v_cvt_pk_bf16_f32 v52, v24, v25
    v_cvt_pk_bf16_f32 v53, v26, v27
    v_mfma_f32_32x32x16_bf16 a[32:47], a[120:123], v[48:51], a[32:47]
    v_exp_f32 v28, v28
    v_exp_f32 v29, v29
    v_exp_f32 v30, v30
    v_exp_f32 v31, v31
    v_cvt_pk_bf16_f32 v54, v28, v29
    v_cvt_pk_bf16_f32 v55, v30, v31
    s_waitcnt vmcnt(11)
    v_mfma_f32_32x32x16_bf16 v[16:31], a[64:67], v[56:59], 0
    v_exp_f32 v32, v32
    v_exp_f32 v33, v33
    v_exp_f32 v34, v34
    v_exp_f32 v35, v35
    v_cvt_pk_bf16_f32 v48, v32, v33
    v_cvt_pk_bf16_f32 v49, v34, v35
    v_mfma_f32_32x32x16_bf16 a[32:47], a[124:127], v[52:55], a[32:47]
    v_exp_f32 v36, v36
    v_exp_f32 v37, v37
    v_exp_f32 v38, v38
    v_exp_f32 v39, v39
    v_cvt_pk_bf16_f32 v50, v36, v37
    v_cvt_pk_bf16_f32 v51, v38, v39
    s_waitcnt vmcnt(10)
    v_mfma_f32_32x32x16_bf16 v[16:31], a[68:71], v[60:63], v[16:31]
    v_exp_f32 v40, v40
    v_exp_f32 v41, v41
    v_exp_f32 v42, v42
    v_exp_f32 v43, v43
    v_cvt_pk_bf16_f32 v52, v40, v41
    v_cvt_pk_bf16_f32 v53, v42, v43
    v_mfma_f32_32x32x16_bf16 a[48:63], a[120:123], v[48:51], a[48:63]
    v_exp_f32 v44, v44
    v_exp_f32 v45, v45
    v_exp_f32 v46, v46
    v_exp_f32 v47, v47
    v_cvt_pk_bf16_f32 v54, v44, v45
    v_cvt_pk_bf16_f32 v55, v46, v47
    s_sub_u32 s19, s19, 1
    s_cmp_lg_u32 s19, 0
    s_cbranch_scc1 L_k2_aloop
    v_mfma_f32_32x32x16_bf16 a[48:63], a[124:127], v[52:55], a[48:63]
    v_accvgpr_read_b32 v100, a12
    v_accvgpr_read_b32 v101, a28
    v_accvgpr_read_b32 v102, a44
    s_nop 8
    v_accvgpr_read_b32 v103, a60
    v_mov_b32 v92, v100
    v_mov_b32 v93, v101
    v_mov_b32 v94, v102
    v_mov_b32 v95, v103
    v_permlane32_swap_b32 v92, v100
    v_permlane32_swap_b32 v93, v101
    v_permlane32_swap_b32 v94, v102
    v_permlane32_swap_b32 v95, v103
    v_max3_f32 v92, v100, v101, v102
    v_max_f32 v92, v92, v103
    v_add_f32 v93, v100, v101
    v_add_f32 v94, v102, v103
    v_add_f32 v93, v93, v94
    v_mov_b32 v94, 0x6c800000
    v_cmp_nlt_f32 vcc, v93, v94
    s_nop 0
    s_cmp_eq_u64 vcc, 0
    s_cbranch_scc1 L_k2_aok
    s_cmp_lg_u32 s18, 0
    s_cbranch_scc1 L_k2_aok
    s_mov_b32 s18, 1
    s_waitcnt vmcnt(0)
    s_mov_b32 exec_lo, 0
    v_mov_b32 v62, 0
    v_mov_b32 v63, 0
    v_mov_b32 v70, 0
    v_mov_b32 v71, 0
    v_mov_b32 v78, 0
    v_mov_b32 v79, 0
    v_mov_b32 v86, 0
    v_mov_b32 v87, 0
    s_mov_b32 exec_lo, -1
    v_mov_b32 v88, 0xff800000
    v_mov_b32 v89, 0xff800000
    v_mov_b32 v90, 0xff800000
    v_mov_b32 v91, 0xff800000
    s_mov_b32 s16, 0
L_k2_fbloop:
    buffer_load_dwordx4 a[112:115], v1, s[32:35], s16 offen offset:0
    buffer_load_dwordx4 a[116:119], v1, s[32:35], s16 offen offset:1024
    s_waitcnt vmcnt(3)
    buffer_load_dwordx4 a[120:123], v1, s[32:35], s16 offen offset:2048
    s_waitcnt vmcnt(3)
    buffer_load_dwordx4 a[124:127], v1, s[32:35], s16 offen offset:3072
    s_waitcnt vmcnt(3)
    v_mfma_f32_32x32x16_bf16 v[16:31], a[112:115], v[56:59], 0
    s_waitcnt vmcnt(2)
    v_mfma_f32_32x32x16_bf16 v[16:31], a[116:119], v[60:63], v[16:31]
    s_nop 11
    v_max3_f32 v88, v88, v16, v17
    v_max3_f32 v88, v88, v18, v19
    v_max3_f32 v88, v88, v20, v21
    v_max3_f32 v88, v88, v22, v23
    v_max3_f32 v88, v88, v24, v25
    v_max3_f32 v88, v88, v26, v27
    v_max3_f32 v88, v88, v28, v29
    v_max3_f32 v88, v88, v30, v31
    v_mfma_f32_32x32x16_bf16 v[16:31], a[112:115], v[64:67], 0
    v_mfma_f32_32x32x16_bf16 v[16:31], a[116:119], v[68:71], v[16:31]
    s_nop 11
    v_max3_f32 v89, v89, v16, v17
    v_max3_f32 v89, v89, v18, v19
    v_max3_f32 v89, v89, v20, v21
    v_max3_f32 v89, v89, v22, v23
    v_max3_f32 v89, v89, v24, v25
    v_max3_f32 v89, v89, v26, v27
    v_max3_f32 v89, v89, v28, v29
    v_max3_f32 v89, v89, v30, v31
    v_mfma_f32_32x32x16_bf16 v[16:31], a[112:115], v[72:75], 0
    v_mfma_f32_32x32x16_bf16 v[16:31], a[116:119], v[76:79], v[16:31]
    s_nop 11
    v_max3_f32 v90, v90, v16, v17
    v_max3_f32 v90, v90, v18, v19
    v_max3_f32 v90, v90, v20, v21
    v_max3_f32 v90, v90, v22, v23
    v_max3_f32 v90, v90, v24, v25
    v_max3_f32 v90, v90, v26, v27
    v_max3_f32 v90, v90, v28, v29
    v_max3_f32 v90, v90, v30, v31
    v_mfma_f32_32x32x16_bf16 v[16:31], a[112:115], v[80:83], 0
    v_mfma_f32_32x32x16_bf16 v[16:31], a[116:119], v[84:87], v[16:31]
    s_nop 11
    v_max3_f32 v91, v91, v16, v17
    v_max3_f32 v91, v91, v18, v19
    v_max3_f32 v91, v91, v20, v21
    v_max3_f32 v91, v91, v22, v23
    v_max3_f32 v91, v91, v24, v25
    v_max3_f32 v91, v91, v26, v27
    v_max3_f32 v91, v91, v28, v29
    v_max3_f32 v91, v91, v30, v31
    s_add_u32 s16, s16, 4096
    s_cmp_lt_u32 s16, 65536
    s_cbranch_scc1 L_k2_fbloop
    v_mov_b32 v92, v88
    v_mov_b32 v93, v89
    v_mov_b32 v94, v90
    v_mov_b32 v95, v91
    v_permlane32_swap_b32 v88, v92
    v_permlane32_swap_b32 v89, v93
    v_permlane32_swap_b32 v90, v94
    v_permlane32_swap_b32 v91, v95
    v_max_f32 v88, v88, v92
    v_max_f32 v89, v89, v93
    v_max_f32 v90, v90, v94
    v_max_f32 v91, v91, v95
    v_sub_f32 v99, 0, v88
    v_and_b32 v96, 0xffff0000, v99
    v_sub_f32 v99, v99, v96
    v_and_b32 v97, 0xffff0000, v99
    v_sub_f32 v99, v99, v97
    v_and_b32 v98, 0xffff0000, v99
    v_add_f32 v99, v96, v97
    v_add_f32 v99, v99, v98
    v_sub_f32 v88, 0, v99
    s_mov_b32 exec_lo, 0
    v_lshrrev_b32 v96, 16, v96
    v_or_b32 v62, v96, v97
    v_lshrrev_b32 v63, 16, v98
    s_mov_b32 exec_lo, -1
    v_sub_f32 v99, 0, v89
    v_and_b32 v96, 0xffff0000, v99
    v_sub_f32 v99, v99, v96
    v_and_b32 v97, 0xffff0000, v99
    v_sub_f32 v99, v99, v97
    v_and_b32 v98, 0xffff0000, v99
    v_add_f32 v99, v96, v97
    v_add_f32 v99, v99, v98
    v_sub_f32 v89, 0, v99
    s_mov_b32 exec_lo, 0
    v_lshrrev_b32 v96, 16, v96
    v_or_b32 v70, v96, v97
    v_lshrrev_b32 v71, 16, v98
    s_mov_b32 exec_lo, -1
    v_sub_f32 v99, 0, v90
    v_and_b32 v96, 0xffff0000, v99
    v_sub_f32 v99, v99, v96
    v_and_b32 v97, 0xffff0000, v99
    v_sub_f32 v99, v99, v97
    v_and_b32 v98, 0xffff0000, v99
    v_add_f32 v99, v96, v97
    v_add_f32 v99, v99, v98
    v_sub_f32 v90, 0, v99
    s_mov_b32 exec_lo, 0
    v_lshrrev_b32 v96, 16, v96
    v_or_b32 v78, v96, v97
    v_lshrrev_b32 v79, 16, v98
    s_mov_b32 exec_lo, -1
    v_sub_f32 v99, 0, v91
    v_and_b32 v96, 0xffff0000, v99
    v_sub_f32 v99, v99, v96
    v_and_b32 v97, 0xffff0000, v99
    v_sub_f32 v99, v99, v97
    v_and_b32 v98, 0xffff0000, v99
    v_add_f32 v99, v96, v97
    v_add_f32 v99, v99, v98
    v_sub_f32 v91, 0, v99
    s_mov_b32 exec_lo, 0
    v_lshrrev_b32 v96, 16, v96
    v_or_b32 v86, v96, v97
    v_lshrrev_b32 v87, 16, v98
    s_mov_b32 exec_lo, -1
    s_mov_b32 s16, 4096
    s_mov_b32 s17, 8192
    buffer_load_dwordx4 a[64:67], v1, s[32:35], 0 offen offset:0
    buffer_load_dwordx4 a[68:71], v1, s[32:35], 0 offen offset:1024
    buffer_load_dwordx4 a[72:75], v1, s[32:35], 0 offen offset:2048
    buffer_load_dwordx4 a[76:79], v1, s[32:35], 0 offen offset:3072
    buffer_load_dwordx4 a[80:83], v1, s[32:35], s16 offen offset:0
    buffer_load_dwordx4 a[84:87], v1, s[32:35], s16 offen offset:1024
    buffer_load_dwordx4 a[88:91], v1, s[32:35], s16 offen offset:2048
    buffer_load_dwordx4 a[92:95], v1, s[32:35], s16 offen offset:3072
    buffer_load_dwordx4 a[96:99], v1, s[32:35], s17 offen offset:0
    buffer_load_dwordx4 a[100:103], v1, s[32:35], s17 offen offset:1024
    buffer_load_dwordx4 a[104:107], v1, s[32:35], s17 offen offset:2048
    buffer_load_dwordx4 a[108:111], v1, s[32:35], s17 offen offset:3072
    s_branch L_k2_amain
L_k2_aok:
    v_log_f32 v104, v100
    v_rcp_f32 v100, v100
    v_log_f32 v105, v101
    v_rcp_f32 v101, v101
    v_log_f32 v106, v102
    v_rcp_f32 v102, v102
    v_log_f32 v107, v103
    v_rcp_f32 v103, v103
    v_add_f32 v104, v104, v88
    v_add_f32 v105, v105, v89
    v_add_f32 v106, v106, v90
    v_add_f32 v107, v107, v91
    v_accvgpr_read_b32 v16, a0
    v_accvgpr_read_b32 v17, a1
    v_accvgpr_read_b32 v18, a2
    v_accvgpr_read_b32 v19, a3
    v_accvgpr_read_b32 v20, a4
    v_accvgpr_read_b32 v21, a5
    v_accvgpr_read_b32 v22, a6
    v_accvgpr_read_b32 v23, a7
    v_accvgpr_read_b32 v24, a8
    v_accvgpr_read_b32 v25, a9
    v_accvgpr_read_b32 v26, a10
    v_accvgpr_read_b32 v27, a11
    v_accvgpr_read_b32 v28, a12
    v_accvgpr_read_b32 v29, a13
    v_accvgpr_read_b32 v30, a14
    v_accvgpr_read_b32 v31, a15
    v_mul_f32 v16, v16, v100
    v_mul_f32 v17, v17, v100
    v_mul_f32 v18, v18, v100
    v_mul_f32 v19, v19, v100
    v_mul_f32 v20, v20, v100
    v_mul_f32 v21, v21, v100
    v_mul_f32 v22, v22, v100
    v_mul_f32 v23, v23, v100
    v_mul_f32 v24, v24, v100
    v_mul_f32 v25, v25, v100
    v_mul_f32 v26, v26, v100
    v_mul_f32 v27, v27, v100
    v_mul_f32 v28, v28, v100
    v_mul_f32 v29, v29, v100
    v_mul_f32 v30, v30, v100
    v_mul_f32 v31, v31, v100
    v_accvgpr_read_b32 v32, a16
    v_accvgpr_read_b32 v33, a17
    v_accvgpr_read_b32 v34, a18
    v_accvgpr_read_b32 v35, a19
    v_accvgpr_read_b32 v36, a20
    v_accvgpr_read_b32 v37, a21
    v_accvgpr_read_b32 v38, a22
    v_accvgpr_read_b32 v39, a23
    v_accvgpr_read_b32 v40, a24
    v_accvgpr_read_b32 v41, a25
    v_accvgpr_read_b32 v42, a26
    v_accvgpr_read_b32 v43, a27
    v_accvgpr_read_b32 v44, a28
    v_accvgpr_read_b32 v45, a29
    v_accvgpr_read_b32 v46, a30
    v_accvgpr_read_b32 v47, a31
    v_mul_f32 v32, v32, v101
    v_mul_f32 v33, v33, v101
    v_mul_f32 v34, v34, v101
    v_mul_f32 v35, v35, v101
    v_mul_f32 v36, v36, v101
    v_mul_f32 v37, v37, v101
    v_mul_f32 v38, v38, v101
    v_mul_f32 v39, v39, v101
    v_mul_f32 v40, v40, v101
    v_mul_f32 v41, v41, v101
    v_mul_f32 v42, v42, v101
    v_mul_f32 v43, v43, v101
    v_mul_f32 v44, v44, v101
    v_mul_f32 v45, v45, v101
    v_mul_f32 v46, v46, v101
    v_mul_f32 v47, v47, v101
    v_accvgpr_read_b32 v56, a32
    v_accvgpr_read_b32 v57, a33
    v_accvgpr_read_b32 v58, a34
    v_accvgpr_read_b32 v59, a35
    v_accvgpr_read_b32 v60, a36
    v_accvgpr_read_b32 v61, a37
    v_accvgpr_read_b32 v62, a38
    v_accvgpr_read_b32 v63, a39
    v_accvgpr_read_b32 v64, a40
    v_accvgpr_read_b32 v65, a41
    v_accvgpr_read_b32 v66, a42
    v_accvgpr_read_b32 v67, a43
    v_accvgpr_read_b32 v68, a44
    v_accvgpr_read_b32 v69, a45
    v_accvgpr_read_b32 v70, a46
    v_accvgpr_read_b32 v71, a47
    v_mul_f32 v56, v56, v102
    v_mul_f32 v57, v57, v102
    v_mul_f32 v58, v58, v102
    v_mul_f32 v59, v59, v102
    v_mul_f32 v60, v60, v102
    v_mul_f32 v61, v61, v102
    v_mul_f32 v62, v62, v102
    v_mul_f32 v63, v63, v102
    v_mul_f32 v64, v64, v102
    v_mul_f32 v65, v65, v102
    v_mul_f32 v66, v66, v102
    v_mul_f32 v67, v67, v102
    v_mul_f32 v68, v68, v102
    v_mul_f32 v69, v69, v102
    v_mul_f32 v70, v70, v102
    v_mul_f32 v71, v71, v102
    v_accvgpr_read_b32 v72, a48
    v_accvgpr_read_b32 v73, a49
    v_accvgpr_read_b32 v74, a50
    v_accvgpr_read_b32 v75, a51
    v_accvgpr_read_b32 v76, a52
    v_accvgpr_read_b32 v77, a53
    v_accvgpr_read_b32 v78, a54
    v_accvgpr_read_b32 v79, a55
    v_accvgpr_read_b32 v80, a56
    v_accvgpr_read_b32 v81, a57
    v_accvgpr_read_b32 v82, a58
    v_accvgpr_read_b32 v83, a59
    v_accvgpr_read_b32 v84, a60
    v_accvgpr_read_b32 v85, a61
    v_accvgpr_read_b32 v86, a62
    v_accvgpr_read_b32 v87, a63
    v_mul_f32 v72, v72, v103
    v_mul_f32 v73, v73, v103
    v_mul_f32 v74, v74, v103
    v_mul_f32 v75, v75, v103
    v_mul_f32 v76, v76, v103
    v_mul_f32 v77, v77, v103
    v_mul_f32 v78, v78, v103
    v_mul_f32 v79, v79, v103
    v_mul_f32 v80, v80, v103
    v_mul_f32 v81, v81, v103
    v_mul_f32 v82, v82, v103
    v_mul_f32 v83, v83, v103
    v_mul_f32 v84, v84, v103
    v_mul_f32 v85, v85, v103
    v_mul_f32 v86, v86, v103
    v_mul_f32 v87, v87, v103
    s_lshl_b32 s15, s3, 13
    s_add_u32 s15, s15, 131072
    v_add_u32 v3, s15, v1
    v_lshlrev_b32 v4, 2, v0
    v_add_u32 v4, s15, v4
    v_cvt_pk_bf16_f32 v32, v32, v33
    v_cvt_pk_bf16_f32 v33, v34, v35
    v_cvt_pk_bf16_f32 v34, v36, v37
    v_cvt_pk_bf16_f32 v35, v38, v39
    v_cvt_pk_bf16_f32 v36, v40, v41
    v_cvt_pk_bf16_f32 v37, v42, v43
    v_cvt_pk_bf16_f32 v38, v44, v45
    v_cvt_pk_bf16_f32 v39, v46, v47
    ds_write_b128 v3, v[32:35] offset:0
    ds_write_b128 v3, v[36:39] offset:1024
    ds_write_b32 v4, v105 offset:6400
    v_cvt_pk_bf16_f32 v56, v56, v57
    v_cvt_pk_bf16_f32 v57, v58, v59
    v_cvt_pk_bf16_f32 v58, v60, v61
    v_cvt_pk_bf16_f32 v59, v62, v63
    v_cvt_pk_bf16_f32 v60, v64, v65
    v_cvt_pk_bf16_f32 v61, v66, v67
    v_cvt_pk_bf16_f32 v62, v68, v69
    v_cvt_pk_bf16_f32 v63, v70, v71
    ds_write_b128 v3, v[56:59] offset:2048
    ds_write_b128 v3, v[60:63] offset:3072
    ds_write_b32 v4, v106 offset:6656
    v_cvt_pk_bf16_f32 v72, v72, v73
    v_cvt_pk_bf16_f32 v73, v74, v75
    v_cvt_pk_bf16_f32 v74, v76, v77
    v_cvt_pk_bf16_f32 v75, v78, v79
    v_cvt_pk_bf16_f32 v76, v80, v81
    v_cvt_pk_bf16_f32 v77, v82, v83
    v_cvt_pk_bf16_f32 v78, v84, v85
    v_cvt_pk_bf16_f32 v79, v86, v87
    ds_write_b128 v3, v[72:75] offset:4096
    ds_write_b128 v3, v[76:79] offset:5120
    ds_write_b32 v4, v107 offset:6912
    s_waitcnt lgkmcnt(0)
    s_barrier
    s_sub_u32 s14, s3, 1
    s_and_b32 s14, s14, 3
    s_lshl_b32 s15, s14, 13
    s_add_u32 s15, s15, 131072
    v_add_u32 v2, s15, v1
    ds_read_b128 v[40:43], v2 offset:0
    ds_read_b128 v[44:47], v2 offset:1024
    v_lshlrev_b32 v4, 2, v0
    v_add_u32 v4, s15, v4
    ds_read_b32 v105, v4 offset:6400
    s_sub_u32 s14, s3, 2
    s_and_b32 s14, s14, 3
    s_lshl_b32 s15, s14, 13
    s_add_u32 s15, s15, 131072
    v_add_u32 v2, s15, v1
    ds_read_b128 v[64:67], v2 offset:2048
    ds_read_b128 v[68:71], v2 offset:3072
    v_lshlrev_b32 v4, 2, v0
    v_add_u32 v4, s15, v4
    ds_read_b32 v106, v4 offset:6656
    s_sub_u32 s14, s3, 3
    s_and_b32 s14, s14, 3
    s_lshl_b32 s15, s14, 13
    s_add_u32 s15, s15, 131072
    v_add_u32 v2, s15, v1
    ds_read_b128 v[80:83], v2 offset:4096
    ds_read_b128 v[84:87], v2 offset:5120
    v_lshlrev_b32 v4, 2, v0
    v_add_u32 v4, s15, v4
    ds_read_b32 v107, v4 offset:6912
    s_waitcnt lgkmcnt(3)
    v_max3_f32 v92, v104, v105, v106
    s_waitcnt lgkmcnt(0)
    v_max_f32 v92, v92, v107
    v_sub_f32 v104, v104, v92
    v_sub_f32 v105, v105, v92
    v_sub_f32 v106, v106, v92
    v_sub_f32 v107, v107, v92
    v_exp_f32 v104, v104
    v_exp_f32 v105, v105
    v_exp_f32 v106, v106
    v_exp_f32 v107, v107
    v_add_f32 v92, v104, v105
    v_add_f32 v93, v106, v107
    v_add_f32 v92, v92, v93
    v_rcp_f32 v92, v92
    s_nop 0
    v_mul_f32 v104, v104, v92
    v_mul_f32 v105, v105, v92
    v_mul_f32 v106, v106, v92
    v_mul_f32 v107, v107, v92
    v_mul_f32 v16, v16, v104
    v_mul_f32 v17, v17, v104
    v_mul_f32 v18, v18, v104
    v_mul_f32 v19, v19, v104
    v_mul_f32 v20, v20, v104
    v_mul_f32 v21, v21, v104
    v_mul_f32 v22, v22, v104
    v_mul_f32 v23, v23, v104
    v_mul_f32 v24, v24, v104
    v_mul_f32 v25, v25, v104
    v_mul_f32 v26, v26, v104
    v_mul_f32 v27, v27, v104
    v_mul_f32 v28, v28, v104
    v_mul_f32 v29, v29, v104
    v_mul_f32 v30, v30, v104
    v_mul_f32 v31, v31, v104
    v_lshlrev_b32 v94, 16, v40
    v_and_b32 v95, 0xffff0000, v40
    v_fmac_f32 v16, v94, v105
    v_fmac_f32 v17, v95, v105
    v_lshlrev_b32 v96, 16, v41
    v_and_b32 v97, 0xffff0000, v41
    v_fmac_f32 v18, v96, v105
    v_fmac_f32 v19, v97, v105
    v_lshlrev_b32 v94, 16, v42
    v_and_b32 v95, 0xffff0000, v42
    v_fmac_f32 v20, v94, v105
    v_fmac_f32 v21, v95, v105
    v_lshlrev_b32 v96, 16, v43
    v_and_b32 v97, 0xffff0000, v43
    v_fmac_f32 v22, v96, v105
    v_fmac_f32 v23, v97, v105
    v_lshlrev_b32 v94, 16, v44
    v_and_b32 v95, 0xffff0000, v44
    v_fmac_f32 v24, v94, v105
    v_fmac_f32 v25, v95, v105
    v_lshlrev_b32 v96, 16, v45
    v_and_b32 v97, 0xffff0000, v45
    v_fmac_f32 v26, v96, v105
    v_fmac_f32 v27, v97, v105
    v_lshlrev_b32 v94, 16, v46
    v_and_b32 v95, 0xffff0000, v46
    v_fmac_f32 v28, v94, v105
    v_fmac_f32 v29, v95, v105
    v_lshlrev_b32 v96, 16, v47
    v_and_b32 v97, 0xffff0000, v47
    v_fmac_f32 v30, v96, v105
    v_fmac_f32 v31, v97, v105
    v_lshlrev_b32 v94, 16, v64
    v_and_b32 v95, 0xffff0000, v64
    v_fmac_f32 v16, v94, v106
    v_fmac_f32 v17, v95, v106
    v_lshlrev_b32 v96, 16, v65
    v_and_b32 v97, 0xffff0000, v65
    v_fmac_f32 v18, v96, v106
    v_fmac_f32 v19, v97, v106
    v_lshlrev_b32 v94, 16, v66
    v_and_b32 v95, 0xffff0000, v66
    v_fmac_f32 v20, v94, v106
    v_fmac_f32 v21, v95, v106
    v_lshlrev_b32 v96, 16, v67
    v_and_b32 v97, 0xffff0000, v67
    v_fmac_f32 v22, v96, v106
    v_fmac_f32 v23, v97, v106
    v_lshlrev_b32 v94, 16, v68
    v_and_b32 v95, 0xffff0000, v68
    v_fmac_f32 v24, v94, v106
    v_fmac_f32 v25, v95, v106
    v_lshlrev_b32 v96, 16, v69
    v_and_b32 v97, 0xffff0000, v69
    v_fmac_f32 v26, v96, v106
    v_fmac_f32 v27, v97, v106
    v_lshlrev_b32 v94, 16, v70
    v_and_b32 v95, 0xffff0000, v70
    v_fmac_f32 v28, v94, v106
    v_fmac_f32 v29, v95, v106
    v_lshlrev_b32 v96, 16, v71
    v_and_b32 v97, 0xffff0000, v71
    v_fmac_f32 v30, v96, v106
    v_fmac_f32 v31, v97, v106
    v_lshlrev_b32 v94, 16, v80
    v_and_b32 v95, 0xffff0000, v80
    v_fmac_f32 v16, v94, v107
    v_fmac_f32 v17, v95, v107
    v_lshlrev_b32 v96, 16, v81
    v_and_b32 v97, 0xffff0000, v81
    v_fmac_f32 v18, v96, v107
    v_fmac_f32 v19, v97, v107
    v_lshlrev_b32 v94, 16, v82
    v_and_b32 v95, 0xffff0000, v82
    v_fmac_f32 v20, v94, v107
    v_fmac_f32 v21, v95, v107
    v_lshlrev_b32 v96, 16, v83
    v_and_b32 v97, 0xffff0000, v83
    v_fmac_f32 v22, v96, v107
    v_fmac_f32 v23, v97, v107
    v_lshlrev_b32 v94, 16, v84
    v_and_b32 v95, 0xffff0000, v84
    v_fmac_f32 v24, v94, v107
    v_fmac_f32 v25, v95, v107
    v_lshlrev_b32 v96, 16, v85
    v_and_b32 v97, 0xffff0000, v85
    v_fmac_f32 v26, v96, v107
    v_fmac_f32 v27, v97, v107
    v_lshlrev_b32 v94, 16, v86
    v_and_b32 v95, 0xffff0000, v86
    v_fmac_f32 v28, v94, v107
    v_fmac_f32 v29, v95, v107
    v_lshlrev_b32 v96, 16, v87
    v_and_b32 v97, 0xffff0000, v87
    v_fmac_f32 v30, v96, v107
    v_fmac_f32 v31, v97, v107
    v_cvt_pk_bf16_f32 v48, v16, v17
    v_cvt_pk_bf16_f32 v49, v18, v19
    v_cvt_pk_bf16_f32 v50, v20, v21
    v_cvt_pk_bf16_f32 v51, v22, v23
    v_cvt_pk_bf16_f32 v52, v24, v25
    v_cvt_pk_bf16_f32 v53, v26, v27
    v_cvt_pk_bf16_f32 v54, v28, v29
    v_cvt_pk_bf16_f32 v55, v30, v31
    s_mov_b32 exec_lo, 0
    v_mov_b32 v54, 0
    v_mov_b32 v55, 0
    s_mov_b32 exec_lo, -1
    s_lshl_b32 s14, s13, 2
    s_add_u32 s14, s14, s3
    s_mul_i32 s14, s14, 88
    s_lshl_b32 s15, s12, 1
    s_add_u32 s14, s14, s15
    s_lshl_b32 s14, s14, 10
    s_add_u32 s14, s14, 14680064
    buffer_store_dwordx4 v[48:51], v1, s[28:31], s14 offen
    buffer_store_dwordx4 v[52:55], v1, s[28:31], s14 offen offset:1024
    s_branch L_k2_fin
L_k2_gemm:
    s_cmp_ge_u32 s11, 28
    s_cbranch_scc1 L_k2_pref
    s_setprio 3
    s_sub_u32 s3, s3, 4
    s_lshr_b32 s12, s10, 1
    s_lshl_b32 s12, s12, 2
    s_and_b32 s13, s11, 3
    s_add_u32 s12, s12, s13
    s_and_b32 s13, s10, 1
    s_mul_i32 s13, s13, 7
    s_lshr_b32 s14, s11, 2
    s_add_u32 s13, s13, s14
    s_lshl_b32 s14, s12, 19
    s_lshl_b32 s15, s3, 10
    s_add_u32 s14, s14, s15
    s_add_u32 s20, s4, s14
    s_addc_u32 s21, s5, 0
    s_and_b32 s21, s21, 0xffff
    s_sub_u32 s22, 8388608, s14
    s_mov_b32 s23, 0x20000
    s_lshl_b32 s14, s3, 2
    s_add_u32 s15, s14, 0
    s_and_b32 s15, s15, 15
    s_lshl_b32 s36, s15, 15
    s_add_u32 s15, s14, 1
    s_and_b32 s15, s15, 15
    s_lshl_b32 s37, s15, 15
    s_add_u32 s15, s14, 2
    s_and_b32 s15, s15, 15
    s_lshl_b32 s38, s15, 15
    s_add_u32 s15, s14, 3
    s_and_b32 s15, s15, 15
    s_lshl_b32 s39, s15, 15
    s_add_u32 s15, s14, 4
    s_and_b32 s15, s15, 15
    s_lshl_b32 s40, s15, 15
    s_add_u32 s15, s14, 5
    s_and_b32 s15, s15, 15
    s_lshl_b32 s41, s15, 15
    s_add_u32 s15, s14, 6
    s_and_b32 s15, s15, 15
    s_lshl_b32 s42, s15, 15
    s_add_u32 s15, s14, 7
    s_and_b32 s15, s15, 15
    s_lshl_b32 s43, s15, 15
    s_add_u32 s15, s14, 8
    s_and_b32 s15, s15, 15
    s_lshl_b32 s44, s15, 15
    s_add_u32 s15, s14, 9
    s_and_b32 s15, s15, 15
    s_lshl_b32 s45, s15, 15
    s_add_u32 s15, s14, 10
    s_and_b32 s15, s15, 15
    s_lshl_b32 s46, s15, 15
    s_add_u32 s15, s14, 11
    s_and_b32 s15, s15, 15
    s_lshl_b32 s47, s15, 15
    s_add_u32 s15, s14, 12
    s_and_b32 s15, s15, 15
    s_lshl_b32 s48, s15, 15
    s_add_u32 s15, s14, 13
    s_and_b32 s15, s15, 15
    s_lshl_b32 s49, s15, 15
    s_add_u32 s15, s14, 14
    s_and_b32 s15, s15, 15
    s_lshl_b32 s50, s15, 15
    s_add_u32 s15, s14, 15
    s_and_b32 s15, s15, 15
    s_lshl_b32 s51, s15, 15
    s_lshl_b32 s52, s3, 15
    v_lshrrev_b32 v4, 3, v0
    v_lshlrev_b32 v4, 12, v4
    v_lshrrev_b32 v5, 4, v0
    v_sub_u32 v2, v0, v5
    v_and_b32 v2, 7, v2
    v_xor_b32 v3, 4, v2
    v_lshl_add_u32 v2, v2, 4, v4
    v_lshl_add_u32 v3, v3, 4, v4
    v_add_u32 v8, 128, v2
    v_add_u32 v9, 128, v3
    v_and_b32 v10, 31, v0
    v_lshrrev_b32 v11, 1, v10
    v_lshrrev_b32 v12, 5, v0
    v_add_u32 v11, v11, v12
    v_lshlrev_b32 v10, 7, v10
    v_add_u32 v10, s52, v10
    v_add_u32 v12, 0, v11
    v_and_b32 v12, 7, v12
    v_lshl_add_u32 v4, v12, 4, v10
    v_add_u32 v12, 2, v11
    v_and_b32 v12, 7, v12
    v_lshl_add_u32 v5, v12, 4, v10
    v_add_u32 v12, 4, v11
    v_and_b32 v12, 7, v12
    v_lshl_add_u32 v6, v12, 4, v10
    v_add_u32 v12, 6, v11
    v_and_b32 v12, 7, v12
    v_lshl_add_u32 v7, v12, 4, v10
    s_lshl_b32 s53, s13, 18
    s_lshl_b32 s14, s3, 15
    s_add_u32 s53, s53, s14
    s_add_u32 s53, s53, 10485760
    s_add_u32 s54, s53, 131072
    v_mov_b32 v112, 0
    v_mov_b32 v113, 0
    v_mov_b32 v114, 0
    v_mov_b32 v115, 0
    s_setprio 0
    s_add_u32 m0, s52, 0
    s_nop 0
    buffer_load_dwordx4 v2, s[20:23], s36 offen lds
    s_add_u32 m0, s52, 1024
    s_nop 0
    buffer_load_dwordx4 v3, s[20:23], s37 offen lds
    s_add_u32 m0, s52, 2048
    s_nop 0
    buffer_load_dwordx4 v2, s[20:23], s38 offen lds
    s_add_u32 m0, s52, 3072
    s_nop 0
    buffer_load_dwordx4 v3, s[20:23], s39 offen lds
    buffer_load_dwordx4 v[16:19], v1, s[28:31], s53 offen offset:0
    buffer_load_dwordx4 v[20:23], v1, s[28:31], s53 offen offset:1024
    buffer_load_dwordx4 v[24:27], v1, s[28:31], s53 offen offset:2048
    buffer_load_dwordx4 v[28:31], v1, s[28:31], s53 offen offset:3072
    buffer_load_dwordx4 v[32:35], v1, s[28:31], s54 offen offset:0
    buffer_load_dwordx4 v[36:39], v1, s[28:31], s54 offen offset:1024
    buffer_load_dwordx4 v[40:43], v1, s[28:31], s54 offen offset:2048
    buffer_load_dwordx4 v[44:47], v1, s[28:31], s54 offen offset:3072
    s_add_u32 s53, s53, 4096
    s_add_u32 s54, s54, 4096
    s_add_u32 m0, s52, 4096
    s_nop 0
    buffer_load_dwordx4 v2, s[20:23], s40 offen lds
    s_add_u32 m0, s52, 5120
    s_nop 0
    buffer_load_dwordx4 v3, s[20:23], s41 offen lds
    s_add_u32 m0, s52, 6144
    s_nop 0
    buffer_load_dwordx4 v2, s[20:23], s42 offen lds
    s_add_u32 m0, s52, 7168
    s_nop 0
    buffer_load_dwordx4 v3, s[20:23], s43 offen lds
    s_add_u32 m0, s52, 8192
    s_nop 0
    buffer_load_dwordx4 v2, s[20:23], s44 offen lds
    s_add_u32 m0, s52, 9216
    s_nop 0
    buffer_load_dwordx4 v3, s[20:23], s45 offen lds
    s_add_u32 m0, s52, 10240
    s_nop 0
    buffer_load_dwordx4 v2, s[20:23], s46 offen lds
    s_add_u32 m0, s52, 11264
    s_nop 0
    buffer_load_dwordx4 v3, s[20:23], s47 offen lds
    v_mfma_f32_32x32x16_bf16 a[0:15], v[112:115], v[112:115], 0
    v_mfma_f32_32x32x16_bf16 a[16:31], v[112:115], v[112:115], 0
    v_mfma_f32_32x32x16_bf16 a[32:47], v[112:115], v[112:115], 0
    v_mfma_f32_32x32x16_bf16 a[48:63], v[112:115], v[112:115], 0
    v_mfma_f32_32x32x16_bf16 a[64:79], v[112:115], v[112:115], 0
    v_mfma_f32_32x32x16_bf16 a[80:95], v[112:115], v[112:115], 0
    v_mfma_f32_32x32x16_bf16 a[96:111], v[112:115], v[112:115], 0
    v_mfma_f32_32x32x16_bf16 a[112:127], v[112:115], v[112:115], 0
    s_waitcnt vmcnt(16)
    ds_read_b128 v[80:83], v4 offset:0
    ds_read_b128 v[84:87], v5 offset:0
    ds_read_b128 v[88:91], v6 offset:0
    ds_read_b128 v[92:95], v7 offset:0
    s_setprio 0
    s_mov_b32 s19, 2
    s_waitcnt vmcnt(15) lgkmcnt(3)
    v_mfma_f32_32x32x16_bf16 a[0:15], v[16:19], v[80:83], a[0:15]
    s_waitcnt vmcnt(4)
    ds_read_b128 v[96:99], v4 offset:4096
    ds_read_b128 v[100:103], v5 offset:4096
    ds_read_b128 v[104:107], v6 offset:4096
    ds_read_b128 v[108:111], v7 offset:4096
    s_add_u32 m0, s52, 12288
    s_nop 0
    buffer_load_dwordx4 v2, s[20:23], s48 offen lds
    v_mfma_f32_32x32x16_bf16 a[16:31], v[32:35], v[80:83], a[16:31]
    s_add_u32 m0, s52, 13312
    s_nop 0
    buffer_load_dwordx4 v3, s[20:23], s49 offen lds
    s_add_u32 m0, s52, 14336
    s_nop 0
    buffer_load_dwordx4 v2, s[20:23], s50 offen lds
    s_waitcnt lgkmcnt(6)
    v_mfma_f32_32x32x16_bf16 a[0:15], v[20:23], v[84:87], a[0:15]
    s_add_u32 m0, s52, 15360
    s_nop 0
    buffer_load_dwordx4 v3, s[20:23], s51 offen lds
    v_mfma_f32_32x32x16_bf16 a[16:31], v[36:39], v[84:87], a[16:31]
    s_add_u32 m0, s52, 16384
    s_nop 0
    buffer_load_dwordx4 v8, s[20:23], s36 offen lds
    s_add_u32 m0, s52, 17408
    s_nop 0
    buffer_load_dwordx4 v9, s[20:23], s37 offen lds
    s_waitcnt lgkmcnt(5)
    v_mfma_f32_32x32x16_bf16 a[0:15], v[24:27], v[88:91], a[0:15]
    s_add_u32 m0, s52, 18432
    s_nop 0
    buffer_load_dwordx4 v8, s[20:23], s38 offen lds
    v_mfma_f32_32x32x16_bf16 a[16:31], v[40:43], v[88:91], a[16:31]
    s_add_u32 m0, s52, 19456
    s_nop 0
    buffer_load_dwordx4 v9, s[20:23], s39 offen lds
    buffer_load_dwordx4 v[48:51], v1, s[28:31], s53 offen offset:0
    s_waitcnt lgkmcnt(4)
    v_mfma_f32_32x32x16_bf16 a[0:15], v[28:31], v[92:95], a[0:15]
    buffer_load_dwordx4 v[52:55], v1, s[28:31], s53 offen offset:1024
    v_mfma_f32_32x32x16_bf16 a[16:31], v[44:47], v[92:95], a[16:31]
    buffer_load_dwordx4 v[56:59], v1, s[28:31], s53 offen offset:2048
    buffer_load_dwordx4 v[60:63], v1, s[28:31], s53 offen offset:3072
    s_add_u32 s53, s53, 4096
    s_waitcnt lgkmcnt(3)
    v_mfma_f32_32x32x16_bf16 a[32:47], v[16:19], v[96:99], a[32:47]
    s_waitcnt vmcnt(12)
    ds_read_b128 v[80:83], v4 offset:8192
    ds_read_b128 v[84:87], v5 offset:8192
    ds_read_b128 v[88:91], v6 offset:8192
    ds_read_b128 v[92:95], v7 offset:8192
    s_add_u32 m0, s52, 20480
    s_nop 0
    buffer_load_dwordx4 v8, s[20:23], s40 offen lds
    v_mfma_f32_32x32x16_bf16 a[48:63], v[32:35], v[96:99], a[48:63]
    s_add_u32 m0, s52, 21504
    s_nop 0
    buffer_load_dwordx4 v9, s[20:23], s41 offen lds
    s_add_u32 m0, s52, 22528
    s_nop 0
    buffer_load_dwordx4 v8, s[20:23], s42 offen lds
    s_waitcnt lgkmcnt(6)
    v_mfma_f32_32x32x16_bf16 a[32:47], v[20:23], v[100:103], a[32:47]
    s_add_u32 m0, s52, 23552
    s_nop 0
    buffer_load_dwordx4 v9, s[20:23], s43 offen lds
    v_mfma_f32_32x32x16_bf16 a[48:63], v[36:39], v[100:103], a[48:63]
    s_add_u32 m0, s52, 24576
    s_nop 0
    buffer_load_dwordx4 v8, s[20:23], s44 offen lds
    s_add_u32 m0, s52, 25600
    s_nop 0
    buffer_load_dwordx4 v9, s[20:23], s45 offen lds
    s_waitcnt lgkmcnt(5)
    v_mfma_f32_32x32x16_bf16 a[32:47], v[24:27], v[104:107], a[32:47]
    s_add_u32 m0, s52, 26624
    s_nop 0
    buffer_load_dwordx4 v8, s[20:23], s46 offen lds
    v_mfma_f32_32x32x16_bf16 a[48:63], v[40:43], v[104:107], a[48:63]
    s_add_u32 m0, s52, 27648
    s_nop 0
    buffer_load_dwordx4 v9, s[20:23], s47 offen lds
    buffer_load_dwordx4 v[64:67], v1, s[28:31], s54 offen offset:0
    s_waitcnt lgkmcnt(4)
    v_mfma_f32_32x32x16_bf16 a[32:47], v[28:31], v[108:111], a[32:47]
    buffer_load_dwordx4 v[68:71], v1, s[28:31], s54 offen offset:1024
    v_mfma_f32_32x32x16_bf16 a[48:63], v[44:47], v[108:111], a[48:63]
    buffer_load_dwordx4 v[72:75], v1, s[28:31], s54 offen offset:2048
    buffer_load_dwordx4 v[76:79], v1, s[28:31], s54 offen offset:3072
    s_add_u32 s54, s54, 4096
    s_waitcnt lgkmcnt(3)
    v_mfma_f32_32x32x16_bf16 a[64:79], v[16:19], v[80:83], a[64:79]
    s_waitcnt vmcnt(20)
    ds_read_b128 v[96:99], v4 offset:12288
    ds_read_b128 v[100:103], v5 offset:12288
    ds_read_b128 v[104:107], v6 offset:12288
    ds_read_b128 v[108:111], v7 offset:12288
    s_add_u32 m0, s52, 28672
    s_nop 0
    buffer_load_dwordx4 v8, s[20:23], s48 offen lds
    v_mfma_f32_32x32x16_bf16 a[80:95], v[32:35], v[80:83], a[80:95]
    s_add_u32 m0, s52, 29696
    s_nop 0
    buffer_load_dwordx4 v9, s[20:23], s49 offen lds
    s_waitcnt lgkmcnt(6)
    v_mfma_f32_32x32x16_bf16 a[64:79], v[20:23], v[84:87], a[64:79]
    s_add_u32 m0, s52, 30720
    s_nop 0
    buffer_load_dwordx4 v8, s[20:23], s50 offen lds
    v_mfma_f32_32x32x16_bf16 a[80:95], v[36:39], v[84:87], a[80:95]
    s_add_u32 m0, s52, 31744
    s_nop 0
    buffer_load_dwordx4 v9, s[20:23], s51 offen lds
    s_waitcnt lgkmcnt(5)
    v_mfma_f32_32x32x16_bf16 a[64:79], v[24:27], v[88:91], a[64:79]
    s_add_u32 s20, s20, 256
    s_addc_u32 s21, s21, 0
    s_sub_u32 s22, s22, 256
    s_add_u32 m0, s52, 0
    s_nop 0
    buffer_load_dwordx4 v2, s[20:23], s36 offen lds
    v_mfma_f32_32x32x16_bf16 a[80:95], v[40:43], v[88:91], a[80:95]
    s_add_u32 m0, s52, 1024
    s_nop 0
    buffer_load_dwordx4 v3, s[20:23], s37 offen lds
    s_waitcnt lgkmcnt(4)
    v_mfma_f32_32x32x16_bf16 a[64:79], v[28:31], v[92:95], a[64:79]
    s_add_u32 m0, s52, 2048
    s_nop 0
    buffer_load_dwordx4 v2, s[20:23], s38 offen lds
    v_mfma_f32_32x32x16_bf16 a[80:95], v[44:47], v[92:95], a[80:95]
    s_add_u32 m0, s52, 3072
    s_nop 0
    buffer_load_dwordx4 v3, s[20:23], s39 offen lds
    s_waitcnt lgkmcnt(3)
    v_mfma_f32_32x32x16_bf16 a[96:111], v[16:19], v[96:99], a[96:111]
    s_waitcnt vmcnt(24)
    ds_read_b128 v[80:83], v4 offset:16384
    ds_read_b128 v[84:87], v5 offset:16384
    ds_read_b128 v[88:91], v6 offset:16384
    ds_read_b128 v[92:95], v7 offset:16384
    s_add_u32 m0, s52, 4096
    s_nop 0
    buffer_load_dwordx4 v2, s[20:23], s40 offen lds
    v_mfma_f32_32x32x16_bf16 a[112:127], v[32:35], v[96:99], a[112:127]
    s_add_u32 m0, s52, 5120
    s_nop 0
    buffer_load_dwordx4 v3, s[20:23], s41 offen lds
    s_waitcnt lgkmcnt(6)
    v_mfma_f32_32x32x16_bf16 a[96:111], v[20:23], v[100:103], a[96:111]
    s_add_u32 m0, s52, 6144
    s_nop 0
    buffer_load_dwordx4 v2, s[20:23], s42 offen lds
    v_mfma_f32_32x32x16_bf16 a[112:127], v[36:39], v[100:103], a[112:127]
    s_add_u32 m0, s52, 7168
    s_nop 0
    buffer_load_dwordx4 v3, s[20:23], s43 offen lds
    s_waitcnt lgkmcnt(5)
    v_mfma_f32_32x32x16_bf16 a[96:111], v[24:27], v[104:107], a[96:111]
    s_add_u32 m0, s52, 8192
    s_nop 0
    buffer_load_dwordx4 v2, s[20:23], s44 offen lds
    v_mfma_f32_32x32x16_bf16 a[112:127], v[40:43], v[104:107], a[112:127]
    s_add_u32 m0, s52, 9216
    s_nop 0
    buffer_load_dwordx4 v3, s[20:23], s45 offen lds
    s_waitcnt lgkmcnt(4)
    v_mfma_f32_32x32x16_bf16 a[96:111], v[28:31], v[108:111], a[96:111]
    s_add_u32 m0, s52, 10240
    s_nop 0
    buffer_load_dwordx4 v2, s[20:23], s46 offen lds
    v_mfma_f32_32x32x16_bf16 a[112:127], v[44:47], v[108:111], a[112:127]
    s_add_u32 m0, s52, 11264
    s_nop 0
    buffer_load_dwordx4 v3, s[20:23], s47 offen lds
    s_waitcnt vmcnt(31) lgkmcnt(3)
    v_mfma_f32_32x32x16_bf16 a[0:15], v[48:51], v[80:83], a[0:15]
    s_waitcnt vmcnt(24)
    ds_read_b128 v[96:99], v4 offset:20480
    ds_read_b128 v[100:103], v5 offset:20480
    ds_read_b128 v[104:107], v6 offset:20480
    ds_read_b128 v[108:111], v7 offset:20480
    s_add_u32 m0, s52, 12288
    s_nop 0
    buffer_load_dwordx4 v2, s[20:23], s48 offen lds
    s_waitcnt vmcnt(20)
    v_mfma_f32_32x32x16_bf16 a[16:31], v[64:67], v[80:83], a[16:31]
    s_add_u32 m0, s52, 13312
    s_nop 0
    buffer_load_dwordx4 v3, s[20:23], s49 offen lds
    s_waitcnt lgkmcnt(6)
    v_mfma_f32_32x32x16_bf16 a[0:15], v[52:55], v[84:87], a[0:15]
    s_add_u32 m0, s52, 14336
    s_nop 0
    buffer_load_dwordx4 v2, s[20:23], s50 offen lds
    s_waitcnt vmcnt(21)
    v_mfma_f32_32x32x16_bf16 a[16:31], v[68:71], v[84:87], a[16:31]
    s_add_u32 m0, s52, 15360
    s_nop 0
    buffer_load_dwordx4 v3, s[20:23], s51 offen lds
    s_waitcnt lgkmcnt(5)
    v_mfma_f32_32x32x16_bf16 a[0:15], v[56:59], v[88:91], a[0:15]
    buffer_load_dwordx4 v[16:19], v1, s[28:31], s53 offen offset:0
    s_waitcnt vmcnt(22)
    v_mfma_f32_32x32x16_bf16 a[16:31], v[72:75], v[88:91], a[16:31]
    buffer_load_dwordx4 v[20:23], v1, s[28:31], s53 offen offset:1024
    s_waitcnt lgkmcnt(4)
    v_mfma_f32_32x32x16_bf16 a[0:15], v[60:63], v[92:95], a[0:15]
    buffer_load_dwordx4 v[24:27], v1, s[28:31], s53 offen offset:2048
    s_waitcnt vmcnt(23)
    v_mfma_f32_32x32x16_bf16 a[16:31], v[76:79], v[92:95], a[16:31]
    buffer_load_dwordx4 v[28:31], v1, s[28:31], s53 offen offset:3072
    s_add_u32 s53, s53, 4096
    s_waitcnt lgkmcnt(3)
    v_mfma_f32_32x32x16_bf16 a[32:47], v[48:51], v[96:99], a[32:47]
    ds_read_b128 v[80:83], v4 offset:24576
    ds_read_b128 v[84:87], v5 offset:24576
    ds_read_b128 v[88:91], v6 offset:24576
    ds_read_b128 v[92:95], v7 offset:24576
    s_add_u32 m0, s52, 16384
    s_nop 0
    buffer_load_dwordx4 v8, s[20:23], s36 offen lds
    v_mfma_f32_32x32x16_bf16 a[48:63], v[64:67], v[96:99], a[48:63]
    s_add_u32 m0, s52, 17408
    s_nop 0
    buffer_load_dwordx4 v9, s[20:23], s37 offen lds
    s_waitcnt lgkmcnt(6)
    v_mfma_f32_32x32x16_bf16 a[32:47], v[52:55], v[100:103], a[32:47]
    s_add_u32 m0, s52, 18432
    s_nop 0
    buffer_load_dwordx4 v8, s[20:23], s38 offen lds
    v_mfma_f32_32x32x16_bf16 a[48:63], v[68:71], v[100:103], a[48:63]
    s_add_u32 m0, s52, 19456
    s_nop 0
    buffer_load_dwordx4 v9, s[20:23], s39 offen lds
    s_waitcnt lgkmcnt(5)
    v_mfma_f32_32x32x16_bf16 a[32:47], v[56:59], v[104:107], a[32:47]
    buffer_load_dwordx4 v[32:35], v1, s[28:31], s54 offen offset:0
    v_mfma_f32_32x32x16_bf16 a[48:63], v[72:75], v[104:107], a[48:63]
    buffer_load_dwordx4 v[36:39], v1, s[28:31], s54 offen offset:1024
    s_waitcnt lgkmcnt(4)
    v_mfma_f32_32x32x16_bf16 a[32:47], v[60:63], v[108:111], a[32:47]
    buffer_load_dwordx4 v[40:43], v1, s[28:31], s54 offen offset:2048
    v_mfma_f32_32x32x16_bf16 a[48:63], v[76:79], v[108:111], a[48:63]
    buffer_load_dwordx4 v[44:47], v1, s[28:31], s54 offen offset:3072
    s_add_u32 s54, s54, 4096
    s_waitcnt lgkmcnt(3)
    v_mfma_f32_32x32x16_bf16 a[64:79], v[48:51], v[80:83], a[64:79]
    s_waitcnt vmcnt(28)
    ds_read_b128 v[96:99], v4 offset:28672
    ds_read_b128 v[100:103], v5 offset:28672
    ds_read_b128 v[104:107], v6 offset:28672
    ds_read_b128 v[108:111], v7 offset:28672
    v_mfma_f32_32x32x16_bf16 a[80:95], v[64:67], v[80:83], a[80:95]
    s_add_u32 m0, s52, 20480
    s_nop 0
    buffer_load_dwordx4 v8, s[20:23], s40 offen lds
    s_waitcnt lgkmcnt(6)
    v_mfma_f32_32x32x16_bf16 a[64:79], v[52:55], v[84:87], a[64:79]
    v_mfma_f32_32x32x16_bf16 a[80:95], v[68:71], v[84:87], a[80:95]
    s_add_u32 m0, s52, 21504
    s_nop 0
    buffer_load_dwordx4 v9, s[20:23], s41 offen lds
    s_waitcnt lgkmcnt(5)
    v_mfma_f32_32x32x16_bf16 a[64:79], v[56:59], v[88:91], a[64:79]
    v_mfma_f32_32x32x16_bf16 a[80:95], v[72:75], v[88:91], a[80:95]
    s_add_u32 m0, s52, 22528
    s_nop 0
    buffer_load_dwordx4 v8, s[20:23], s42 offen lds
    s_waitcnt lgkmcnt(4)
    v_mfma_f32_32x32x16_bf16 a[64:79], v[60:63], v[92:95], a[64:79]
    v_mfma_f32_32x32x16_bf16 a[80:95], v[76:79], v[92:95], a[80:95]
    s_add_u32 m0, s52, 23552
    s_nop 0
    buffer_load_dwordx4 v9, s[20:23], s43 offen lds
    s_waitcnt lgkmcnt(3)
    v_mfma_f32_32x32x16_bf16 a[96:111], v[48:51], v[96:99], a[96:111]
    s_waitcnt vmcnt(28)
    ds_read_b128 v[80:83], v4 offset:0
    ds_read_b128 v[84:87], v5 offset:0
    ds_read_b128 v[88:91], v6 offset:0
    ds_read_b128 v[92:95], v7 offset:0
    v_mfma_f32_32x32x16_bf16 a[112:127], v[64:67], v[96:99], a[112:127]
    s_add_u32 m0, s52, 24576
    s_nop 0
    buffer_load_dwordx4 v8, s[20:23], s44 offen lds
    s_waitcnt lgkmcnt(6)
    v_mfma_f32_32x32x16_bf16 a[96:111], v[52:55], v[100:103], a[96:111]
    v_mfma_f32_32x32x16_bf16 a[112:127], v[68:71], v[100:103], a[112:127]
    s_add_u32 m0, s52, 25600
    s_nop 0
    buffer_load_dwordx4 v9, s[20:23], s45 offen lds
    s_waitcnt lgkmcnt(5)
    v_mfma_f32_32x32x16_bf16 a[96:111], v[56:59], v[104:107], a[96:111]
    v_mfma_f32_32x32x16_bf16 a[112:127], v[72:75], v[104:107], a[112:127]
    s_add_u32 m0, s52, 26624
    s_nop 0
    buffer_load_dwordx4 v8, s[20:23], s46 offen lds
    s_waitcnt lgkmcnt(4)
    v_mfma_f32_32x32x16_bf16 a[96:111], v[60:63], v[108:111], a[96:111]
    v_mfma_f32_32x32x16_bf16 a[112:127], v[76:79], v[108:111], a[112:127]
    s_add_u32 m0, s52, 27648
    s_nop 0
    buffer_load_dwordx4 v9, s[20:23], s47 offen lds
L_k2_gloop:
    s_waitcnt vmcnt(19) lgkmcnt(3)
    v_mfma_f32_32x32x16_bf16 a[0:15], v[16:19], v[80:83], a[0:15]
    ds_read_b128 v[96:99], v4 offset:4096
    ds_read_b128 v[100:103], v5 offset:4096
    ds_read_b128 v[104:107], v6 offset:4096
    ds_read_b128 v[108:111], v7 offset:4096
    s_add_u32 m0, s52, 28672
    s_nop 0
    buffer_load_dwordx4 v8, s[20:23], s48 offen lds
    s_waitcnt vmcnt(12)
    v_mfma_f32_32x32x16_bf16 a[16:31], v[32:35], v[80:83], a[16:31]
    s_add_u32 m0, s52, 29696
    s_nop 0
    buffer_load_dwordx4 v9, s[20:23], s49 offen lds
    s_waitcnt lgkmcnt(6)
    v_mfma_f32_32x32x16_bf16 a[0:15], v[20:23], v[84:87], a[0:15]
    s_add_u32 m0, s52, 30720
    s_nop 0
    buffer_load_dwordx4 v8, s[20:23], s50 offen lds
    s_waitcnt vmcnt(13)
    v_mfma_f32_32x32x16_bf16 a[16:31], v[36:39], v[84:87], a[16:31]
    s_add_u32 m0, s52, 31744
    s_nop 0
    buffer_load_dwordx4 v9, s[20:23], s51 offen lds
    s_waitcnt lgkmcnt(5)
    v_mfma_f32_32x32x16_bf16 a[0:15], v[24:27], v[88:91], a[0:15]
    buffer_load_dwordx4 v[48:51], v1, s[28:31], s53 offen offset:0
    s_waitcnt vmcnt(14)
    v_mfma_f32_32x32x16_bf16 a[16:31], v[40:43], v[88:91], a[16:31]
    buffer_load_dwordx4 v[52:55], v1, s[28:31], s53 offen offset:1024
    s_waitcnt lgkmcnt(4)
    v_mfma_f32_32x32x16_bf16 a[0:15], v[28:31], v[92:95], a[0:15]
    buffer_load_dwordx4 v[56:59], v1, s[28:31], s53 offen offset:2048
    s_waitcnt vmcnt(15)
    v_mfma_f32_32x32x16_bf16 a[16:31], v[44:47], v[92:95], a[16:31]
    buffer_load_dwordx4 v[60:63], v1, s[28:31], s53 offen offset:3072
    s_add_u32 s53, s53, 4096
    s_waitcnt lgkmcnt(3)
    v_mfma_f32_32x32x16_bf16 a[32:47], v[16:19], v[96:99], a[32:47]
    ds_read_b128 v[80:83], v4 offset:8192
    ds_read_b128 v[84:87], v5 offset:8192
    ds_read_b128 v[88:91], v6 offset:8192
    ds_read_b128 v[92:95], v7 offset:8192
    s_add_u32 s20, s20, 256
    s_addc_u32 s21, s21, 0
    s_sub_u32 s22, s22, 256
    s_add_u32 m0, s52, 0
    s_nop 0
    buffer_load_dwordx4 v2, s[20:23], s36 offen lds
    v_mfma_f32_32x32x16_bf16 a[48:63], v[32:35], v[96:99], a[48:63]
    s_add_u32 m0, s52, 1024
    s_nop 0
    buffer_load_dwordx4 v3, s[20:23], s37 offen lds
    s_waitcnt lgkmcnt(6)
    v_mfma_f32_32x32x16_bf16 a[32:47], v[20:23], v[100:103], a[32:47]
    s_add_u32 m0, s52, 2048
    s_nop 0
    buffer_load_dwordx4 v2, s[20:23], s38 offen lds
    v_mfma_f32_32x32x16_bf16 a[48:63], v[36:39], v[100:103], a[48:63]
    s_add_u32 m0, s52, 3072
    s_nop 0
    buffer_load_dwordx4 v3, s[20:23], s39 offen lds
    s_waitcnt lgkmcnt(5)
    v_mfma_f32_32x32x16_bf16 a[32:47], v[24:27], v[104:107], a[32:47]
    buffer_load_dwordx4 v[64:67], v1, s[28:31], s54 offen offset:0
    v_mfma_f32_32x32x16_bf16 a[48:63], v[40:43], v[104:107], a[48:63]
    buffer_load_dwordx4 v[68:71], v1, s[28:31], s54 offen offset:1024
    s_waitcnt lgkmcnt(4)
    v_mfma_f32_32x32x16_bf16 a[32:47], v[28:31], v[108:111], a[32:47]
    buffer_load_dwordx4 v[72:75], v1, s[28:31], s54 offen offset:2048
    v_mfma_f32_32x32x16_bf16 a[48:63], v[44:47], v[108:111], a[48:63]
    buffer_load_dwordx4 v[76:79], v1, s[28:31], s54 offen offset:3072
    s_add_u32 s54, s54, 4096
    s_waitcnt lgkmcnt(3)
    v_mfma_f32_32x32x16_bf16 a[64:79], v[16:19], v[80:83], a[64:79]
    ds_read_b128 v[96:99], v4 offset:12288
    ds_read_b128 v[100:103], v5 offset:12288
    ds_read_b128 v[104:107], v6 offset:12288
    ds_read_b128 v[108:111], v7 offset:12288
    v_mfma_f32_32x32x16_bf16 a[80:95], v[32:35], v[80:83], a[80:95]
    s_add_u32 m0, s52, 4096
    s_nop 0
    buffer_load_dwordx4 v2, s[20:23], s40 offen lds
    s_waitcnt lgkmcnt(6)
    v_mfma_f32_32x32x16_bf16 a[64:79], v[20:23], v[84:87], a[64:79]
    v_mfma_f32_32x32x16_bf16 a[80:95], v[36:39], v[84:87], a[80:95]
    s_add_u32 m0, s52, 5120
    s_nop 0
    buffer_load_dwordx4 v3, s[20:23], s41 offen lds
    s_waitcnt lgkmcnt(5)
    v_mfma_f32_32x32x16_bf16 a[64:79], v[24:27], v[88:91], a[64:79]
    v_mfma_f32_32x32x16_bf16 a[80:95], v[40:43], v[88:91], a[80:95]
    s_add_u32 m0, s52, 6144
    s_nop 0
    buffer_load_dwordx4 v2, s[20:23], s42 offen lds
    s_waitcnt lgkmcnt(4)
    v_mfma_f32_32x32x16_bf16 a[64:79], v[28:31], v[92:95], a[64:79]
    v_mfma_f32_32x32x16_bf16 a[80:95], v[44:47], v[92:95], a[80:95]
    s_add_u32 m0, s52, 7168
    s_nop 0
    buffer_load_dwordx4 v3, s[20:23], s43 offen lds
    s_waitcnt lgkmcnt(3)
    v_mfma_f32_32x32x16_bf16 a[96:111], v[16:19], v[96:99], a[96:111]
    ds_read_b128 v[80:83], v4 offset:16384
    ds_read_b128 v[84:87], v5 offset:16384
    ds_read_b128 v[88:91], v6 offset:16384
    ds_read_b128 v[92:95], v7 offset:16384
    v_mfma_f32_32x32x16_bf16 a[112:127], v[32:35], v[96:99], a[112:127]
    s_add_u32 m0, s52, 8192
    s_nop 0
    buffer_load_dwordx4 v2, s[20:23], s44 offen lds
    s_waitcnt lgkmcnt(6)
    v_mfma_f32_32x32x16_bf16 a[96:111], v[20:23], v[100:103], a[96:111]
    v_mfma_f32_32x32x16_bf16 a[112:127], v[36:39], v[100:103], a[112:127]
    s_add_u32 m0, s52, 9216
    s_nop 0
    buffer_load_dwordx4 v3, s[20:23], s45 offen lds
    s_waitcnt lgkmcnt(5)
    v_mfma_f32_32x32x16_bf16 a[96:111], v[24:27], v[104:107], a[96:111]
    v_mfma_f32_32x32x16_bf16 a[112:127], v[40:43], v[104:107], a[112:127]
    s_add_u32 m0, s52, 10240
    s_nop 0
    buffer_load_dwordx4 v2, s[20:23], s46 offen lds
    s_waitcnt lgkmcnt(4)
    v_mfma_f32_32x32x16_bf16 a[96:111], v[28:31], v[108:111], a[96:111]
    v_mfma_f32_32x32x16_bf16 a[112:127], v[44:47], v[108:111], a[112:127]
    s_add_u32 m0, s52, 11264
    s_nop 0
    buffer_load_dwordx4 v3, s[20:23], s47 offen lds
    s_waitcnt vmcnt(19) lgkmcnt(3)
    v_mfma_f32_32x32x16_bf16 a[0:15], v[48:51], v[80:83], a[0:15]
    ds_read_b128 v[96:99], v4 offset:20480
    ds_read_b128 v[100:103], v5 offset:20480
    ds_read_b128 v[104:107], v6 offset:20480
    ds_read_b128 v[108:111], v7 offset:20480
    s_add_u32 m0, s52, 12288
    s_nop 0
    buffer_load_dwordx4 v2, s[20:23], s48 offen lds
    s_waitcnt vmcnt(12)
    v_mfma_f32_32x32x16_bf16 a[16:31], v[64:67], v[80:83], a[16:31]
    s_add_u32 m0, s52, 13312
    s_nop 0
    buffer_load_dwordx4 v3, s[20:23], s49 offen lds
    s_waitcnt lgkmcnt(6)
    v_mfma_f32_32x32x16_bf16 a[0:15], v[52:55], v[84:87], a[0:15]
    s_add_u32 m0, s52, 14336
    s_nop 0
    buffer_load_dwordx4 v2, s[20:23], s50 offen lds
    s_waitcnt vmcnt(13)
    v_mfma_f32_32x32x16_bf16 a[16:31], v[68:71], v[84:87], a[16:31]
    s_add_u32 m0, s52, 15360
    s_nop 0
    buffer_load_dwordx4 v3, s[20:23], s51 offen lds
    s_waitcnt lgkmcnt(5)
    v_mfma_f32_32x32x16_bf16 a[0:15], v[56:59], v[88:91], a[0:15]
    buffer_load_dwordx4 v[16:19], v1, s[28:31], s53 offen offset:0
    s_waitcnt vmcnt(14)
    v_mfma_f32_32x32x16_bf16 a[16:31], v[72:75], v[88:91], a[16:31]
    buffer_load_dwordx4 v[20:23], v1, s[28:31], s53 offen offset:1024
    s_waitcnt lgkmcnt(4)
    v_mfma_f32_32x32x16_bf16 a[0:15], v[60:63], v[92:95], a[0:15]
    buffer_load_dwordx4 v[24:27], v1, s[28:31], s53 offen offset:2048
    s_waitcnt vmcnt(15)
    v_mfma_f32_32x32x16_bf16 a[16:31], v[76:79], v[92:95], a[16:31]
    buffer_load_dwordx4 v[28:31], v1, s[28:31], s53 offen offset:3072
    s_add_u32 s53, s53, 4096
    s_waitcnt lgkmcnt(3)
    v_mfma_f32_32x32x16_bf16 a[32:47], v[48:51], v[96:99], a[32:47]
    ds_read_b128 v[80:83], v4 offset:24576
    ds_read_b128 v[84:87], v5 offset:24576
    ds_read_b128 v[88:91], v6 offset:24576
    ds_read_b128 v[92:95], v7 offset:24576
    s_add_u32 m0, s52, 16384
    s_nop 0
    buffer_load_dwordx4 v8, s[20:23], s36 offen lds
    v_mfma_f32_32x32x16_bf16 a[48:63], v[64:67], v[96:99], a[48:63]
    s_add_u32 m0, s52, 17408
    s_nop 0
    buffer_load_dwordx4 v9, s[20:23], s37 offen lds
    s_waitcnt lgkmcnt(6)
    v_mfma_f32_32x32x16_bf16 a[32:47], v[52:55], v[100:103], a[32:47]
    s_add_u32 m0, s52, 18432
    s_nop 0
    buffer_load_dwordx4 v8, s[20:23], s38 offen lds
    v_mfma_f32_32x32x16_bf16 a[48:63], v[68:71], v[100:103], a[48:63]
    s_add_u32 m0, s52, 19456
    s_nop 0
    buffer_load_dwordx4 v9, s[20:23], s39 offen lds
    s_waitcnt lgkmcnt(5)
    v_mfma_f32_32x32x16_bf16 a[32:47], v[56:59], v[104:107], a[32:47]
    buffer_load_dwordx4 v[32:35], v1, s[28:31], s54 offen offset:0
    v_mfma_f32_32x32x16_bf16 a[48:63], v[72:75], v[104:107], a[48:63]
    buffer_load_dwordx4 v[36:39], v1, s[28:31], s54 offen offset:1024
    s_waitcnt lgkmcnt(4)
    v_mfma_f32_32x32x16_bf16 a[32:47], v[60:63], v[108:111], a[32:47]
    buffer_load_dwordx4 v[40:43], v1, s[28:31], s54 offen offset:2048
    v_mfma_f32_32x32x16_bf16 a[48:63], v[76:79], v[108:111], a[48:63]
    buffer_load_dwordx4 v[44:47], v1, s[28:31], s54 offen offset:3072
    s_add_u32 s54, s54, 4096
    s_waitcnt lgkmcnt(3)
    v_mfma_f32_32x32x16_bf16 a[64:79], v[48:51], v[80:83], a[64:79]
    ds_read_b128 v[96:99], v4 offset:28672
    ds_read_b128 v[100:103], v5 offset:28672
    ds_read_b128 v[104:107], v6 offset:28672
    ds_read_b128 v[108:111], v7 offset:28672
    v_mfma_f32_32x32x16_bf16 a[80:95], v[64:67], v[80:83], a[80:95]
    s_add_u32 m0, s52, 20480
    s_nop 0
    buffer_load_dwordx4 v8, s[20:23], s40 offen lds
    s_waitcnt lgkmcnt(6)
    v_mfma_f32_32x32x16_bf16 a[64:79], v[52:55], v[84:87], a[64:79]
    v_mfma_f32_32x32x16_bf16 a[80:95], v[68:71], v[84:87], a[80:95]
    s_add_u32 m0, s52, 21504
    s_nop 0
    buffer_load_dwordx4 v9, s[20:23], s41 offen lds
    s_waitcnt lgkmcnt(5)
    v_mfma_f32_32x32x16_bf16 a[64:79], v[56:59], v[88:91], a[64:79]
    v_mfma_f32_32x32x16_bf16 a[80:95], v[72:75], v[88:91], a[80:95]
    s_add_u32 m0, s52, 22528
    s_nop 0
    buffer_load_dwordx4 v8, s[20:23], s42 offen lds
    s_waitcnt lgkmcnt(4)
    v_mfma_f32_32x32x16_bf16 a[64:79], v[60:63], v[92:95], a[64:79]
    v_mfma_f32_32x32x16_bf16 a[80:95], v[76:79], v[92:95], a[80:95]
    s_add_u32 m0, s52, 23552
    s_nop 0
    buffer_load_dwordx4 v9, s[20:23], s43 offen lds
    s_waitcnt lgkmcnt(3)
    v_mfma_f32_32x32x16_bf16 a[96:111], v[48:51], v[96:99], a[96:111]
    ds_read_b128 v[80:83], v4 offset:0
    ds_read_b128 v[84:87], v5 offset:0
    ds_read_b128 v[88:91], v6 offset:0
    ds_read_b128 v[92:95], v7 offset:0
    v_mfma_f32_32x32x16_bf16 a[112:127], v[64:67], v[96:99], a[112:127]
    s_add_u32 m0, s52, 24576
    s_nop 0
    buffer_load_dwordx4 v8, s[20:23], s44 offen lds
    s_waitcnt lgkmcnt(6)
    v_mfma_f32_32x32x16_bf16 a[96:111], v[52:55], v[100:103], a[96:111]
    v_mfma_f32_32x32x16_bf16 a[112:127], v[68:71], v[100:103], a[112:127]
    s_add_u32 m0, s52, 25600
    s_nop 0
    buffer_load_dwordx4 v9, s[20:23], s45 offen lds
    s_waitcnt lgkmcnt(5)
    v_mfma_f32_32x32x16_bf16 a[96:111], v[56:59], v[104:107], a[96:111]
    v_mfma_f32_32x32x16_bf16 a[112:127], v[72:75], v[104:107], a[112:127]
    s_add_u32 m0, s52, 26624
    s_nop 0
    buffer_load_dwordx4 v8, s[20:23], s46 offen lds
    s_waitcnt lgkmcnt(4)
    v_mfma_f32_32x32x16_bf16 a[96:111], v[60:63], v[108:111], a[96:111]
    v_mfma_f32_32x32x16_bf16 a[112:127], v[76:79], v[108:111], a[112:127]
    s_add_u32 m0, s52, 27648
    s_nop 0
    buffer_load_dwordx4 v9, s[20:23], s47 offen lds
    s_sub_u32 s19, s19, 1
    s_cmp_lg_u32 s19, 0
    s_cbranch_scc1 L_k2_gloop
    v_add_u32 v12, s52, v1
    s_waitcnt vmcnt(19) lgkmcnt(3)
    v_mfma_f32_32x32x16_bf16 a[0:15], v[16:19], v[80:83], a[0:15]
    ds_read_b128 v[96:99], v4 offset:4096
    ds_read_b128 v[100:103], v5 offset:4096
    ds_read_b128 v[104:107], v6 offset:4096
    ds_read_b128 v[108:111], v7 offset:4096
    s_add_u32 m0, s52, 28672
    s_nop 0
    buffer_load_dwordx4 v8, s[20:23], s48 offen lds
    s_waitcnt vmcnt(12)
    v_mfma_f32_32x32x16_bf16 a[16:31], v[32:35], v[80:83], a[16:31]
    s_add_u32 m0, s52, 29696
    s_nop 0
    buffer_load_dwordx4 v9, s[20:23], s49 offen lds
    s_waitcnt lgkmcnt(6)
    v_mfma_f32_32x32x16_bf16 a[0:15], v[20:23], v[84:87], a[0:15]
    s_add_u32 m0, s52, 30720
    s_nop 0
    buffer_load_dwordx4 v8, s[20:23], s50 offen lds
    s_waitcnt vmcnt(13)
    v_mfma_f32_32x32x16_bf16 a[16:31], v[36:39], v[84:87], a[16:31]
    s_add_u32 m0, s52, 31744
    s_nop 0
    buffer_load_dwordx4 v9, s[20:23], s51 offen lds
    s_waitcnt lgkmcnt(5)
    v_mfma_f32_32x32x16_bf16 a[0:15], v[24:27], v[88:91], a[0:15]
    buffer_load_dwordx4 v[48:51], v1, s[28:31], s53 offen offset:0
    s_waitcnt vmcnt(14)
    v_mfma_f32_32x32x16_bf16 a[16:31], v[40:43], v[88:91], a[16:31]
    buffer_load_dwordx4 v[52:55], v1, s[28:31], s53 offen offset:1024
    s_waitcnt lgkmcnt(4)
    v_mfma_f32_32x32x16_bf16 a[0:15], v[28:31], v[92:95], a[0:15]
    buffer_load_dwordx4 v[56:59], v1, s[28:31], s53 offen offset:2048
    s_waitcnt vmcnt(15)
    v_mfma_f32_32x32x16_bf16 a[16:31], v[44:47], v[92:95], a[16:31]
    buffer_load_dwordx4 v[60:63], v1, s[28:31], s53 offen offset:3072
    s_add_u32 s53, s53, 4096
    s_waitcnt lgkmcnt(3)
    v_mfma_f32_32x32x16_bf16 a[32:47], v[16:19], v[96:99], a[32:47]
    ds_read_b128 v[80:83], v4 offset:8192
    ds_read_b128 v[84:87], v5 offset:8192
    ds_read_b128 v[88:91], v6 offset:8192
    ds_read_b128 v[92:95], v7 offset:8192
    v_mfma_f32_32x32x16_bf16 a[48:63], v[32:35], v[96:99], a[48:63]
    buffer_load_dwordx4 v[64:67], v1, s[28:31], s54 offen offset:0
    s_waitcnt lgkmcnt(6)
    v_mfma_f32_32x32x16_bf16 a[32:47], v[20:23], v[100:103], a[32:47]
    v_mfma_f32_32x32x16_bf16 a[48:63], v[36:39], v[100:103], a[48:63]
    buffer_load_dwordx4 v[68:71], v1, s[28:31], s54 offen offset:1024
    s_waitcnt lgkmcnt(5)
    v_mfma_f32_32x32x16_bf16 a[32:47], v[24:27], v[104:107], a[32:47]
    v_mfma_f32_32x32x16_bf16 a[48:63], v[40:43], v[104:107], a[48:63]
    buffer_load_dwordx4 v[72:75], v1, s[28:31], s54 offen offset:2048
    s_waitcnt lgkmcnt(4)
    v_mfma_f32_32x32x16_bf16 a[32:47], v[28:31], v[108:111], a[32:47]
    v_mfma_f32_32x32x16_bf16 a[48:63], v[44:47], v[108:111], a[48:63]
    buffer_load_dwordx4 v[76:79], v1, s[28:31], s54 offen offset:3072
    s_add_u32 s54, s54, 4096
    s_waitcnt lgkmcnt(3)
    v_mfma_f32_32x32x16_bf16 a[64:79], v[16:19], v[80:83], a[64:79]
    ds_read_b128 v[96:99], v4 offset:12288
    ds_read_b128 v[100:103], v5 offset:12288
    ds_read_b128 v[104:107], v6 offset:12288
    ds_read_b128 v[108:111], v7 offset:12288
    v_mfma_f32_32x32x16_bf16 a[80:95], v[32:35], v[80:83], a[80:95]
    s_waitcnt lgkmcnt(6)
    v_mfma_f32_32x32x16_bf16 a[64:79], v[20:23], v[84:87], a[64:79]
    v_mfma_f32_32x32x16_bf16 a[80:95], v[36:39], v[84:87], a[80:95]
    s_waitcnt lgkmcnt(5)
    v_mfma_f32_32x32x16_bf16 a[64:79], v[24:27], v[88:91], a[64:79]
    v_mfma_f32_32x32x16_bf16 a[80:95], v[40:43], v[88:91], a[80:95]
    s_waitcnt lgkmcnt(4)
    v_mfma_f32_32x32x16_bf16 a[64:79], v[28:31], v[92:95], a[64:79]
    v_mfma_f32_32x32x16_bf16 a[80:95], v[44:47], v[92:95], a[80:95]
    s_waitcnt lgkmcnt(3)
    v_mfma_f32_32x32x16_bf16 a[96:111], v[16:19], v[96:99], a[96:111]
    ds_read_b128 v[80:83], v4 offset:16384
    ds_read_b128 v[84:87], v5 offset:16384
    ds_read_b128 v[88:91], v6 offset:16384
    ds_read_b128 v[92:95], v7 offset:16384
    v_mfma_f32_32x32x16_bf16 a[112:127], v[32:35], v[96:99], a[112:127]
    s_lshl_b32 s14, s12, 2
    s_add_u32 s14, s14, s3
    s_mul_i32 s15, s14, 56
    s_lshl_b32 s16, s13, 2
    s_add_u32 s15, s15, s16
    s_lshl_b32 s15, s15, 10
    s_add_u32 s15, s15, 6291456
    buffer_load_dwordx4 v[112:115], v1, s[28:31], s15 offen offset:0
    s_waitcnt lgkmcnt(6)
    v_mfma_f32_32x32x16_bf16 a[96:111], v[20:23], v[100:103], a[96:111]
    v_mfma_f32_32x32x16_bf16 a[112:127], v[36:39], v[100:103], a[112:127]
    buffer_load_dwordx4 v[116:119], v1, s[28:31], s15 offen offset:1024
    s_waitcnt lgkmcnt(5)
    v_mfma_f32_32x32x16_bf16 a[96:111], v[24:27], v[104:107], a[96:111]
    buffer_load_dwordx4 v[120:123], v1, s[28:31], s15 offen offset:2048
    v_mfma_f32_32x32x16_bf16 a[112:127], v[40:43], v[104:107], a[112:127]
    s_waitcnt lgkmcnt(4)
    v_mfma_f32_32x32x16_bf16 a[96:111], v[28:31], v[108:111], a[96:111]
    buffer_load_dwordx4 v[124:127], v1, s[28:31], s15 offen offset:3072
    v_mfma_f32_32x32x16_bf16 a[112:127], v[44:47], v[108:111], a[112:127]
    s_mov_b32 s24, s6
    s_and_b32 s25, s7, 0xffff
    s_mov_b32 s26, 4096
    s_mov_b32 s27, 0x20000
    v_and_b32 v10, 31, v0
    v_lshlrev_b32 v10, 1, v10
    s_lshl_b32 s17, s14, 6
    buffer_load_ushort v11, v10, s[24:27], s17 offen
    s_waitcnt vmcnt(12) lgkmcnt(3)
    v_mfma_f32_32x32x16_bf16 a[0:15], v[48:51], v[80:83], a[0:15]
    ds_read_b128 v[96:99], v4 offset:20480
    ds_read_b128 v[100:103], v5 offset:20480
    ds_read_b128 v[104:107], v6 offset:20480
    ds_read_b128 v[108:111], v7 offset:20480
    s_waitcnt vmcnt(8)
    v_mfma_f32_32x32x16_bf16 a[16:31], v[64:67], v[80:83], a[16:31]
    s_waitcnt lgkmcnt(6)
    v_mfma_f32_32x32x16_bf16 a[0:15], v[52:55], v[84:87], a[0:15]
    s_waitcnt vmcnt(7)
    v_mfma_f32_32x32x16_bf16 a[16:31], v[68:71], v[84:87], a[16:31]
    s_waitcnt lgkmcnt(5)
    v_mfma_f32_32x32x16_bf16 a[0:15], v[56:59], v[88:91], a[0:15]
    s_waitcnt vmcnt(6)
    v_mfma_f32_32x32x16_bf16 a[16:31], v[72:75], v[88:91], a[16:31]
    s_waitcnt lgkmcnt(4)
    v_mfma_f32_32x32x16_bf16 a[0:15], v[60:63], v[92:95], a[0:15]
    s_waitcnt vmcnt(5)
    v_mfma_f32_32x32x16_bf16 a[16:31], v[76:79], v[92:95], a[16:31]
    s_waitcnt lgkmcnt(3)
    v_mfma_f32_32x32x16_bf16 a[32:47], v[48:51], v[96:99], a[32:47]
    ds_read_b128 v[80:83], v4 offset:24576
    ds_read_b128 v[84:87], v5 offset:24576
    ds_read_b128 v[88:91], v6 offset:24576
    ds_read_b128 v[92:95], v7 offset:24576
    v_mfma_f32_32x32x16_bf16 a[48:63], v[64:67], v[96:99], a[48:63]
    s_waitcnt lgkmcnt(6)
    v_mfma_f32_32x32x16_bf16 a[32:47], v[52:55], v[100:103], a[32:47]
    v_mfma_f32_32x32x16_bf16 a[48:63], v[68:71], v[100:103], a[48:63]
    s_waitcnt lgkmcnt(5)
    v_mfma_f32_32x32x16_bf16 a[32:47], v[56:59], v[104:107], a[32:47]
    v_mfma_f32_32x32x16_bf16 a[48:63], v[72:75], v[104:107], a[48:63]
    s_waitcnt lgkmcnt(4)
    v_mfma_f32_32x32x16_bf16 a[32:47], v[60:63], v[108:111], a[32:47]
    v_mfma_f32_32x32x16_bf16 a[48:63], v[76:79], v[108:111], a[48:63]
    s_waitcnt lgkmcnt(3)
    v_mfma_f32_32x32x16_bf16 a[64:79], v[48:51], v[80:83], a[64:79]
    ds_read_b128 v[96:99], v4 offset:28672
    ds_read_b128 v[100:103], v5 offset:28672
    ds_read_b128 v[104:107], v6 offset:28672
    ds_read_b128 v[108:111], v7 offset:28672
    v_mfma_f32_32x32x16_bf16 a[80:95], v[64:67], v[80:83], a[80:95]
    s_waitcnt lgkmcnt(6)
    v_mfma_f32_32x32x16_bf16 a[64:79], v[52:55], v[84:87], a[64:79]
    s_nop 1
    ds_write_b128 v12, a[32:35] offset:0
    v_mfma_f32_32x32x16_bf16 a[80:95], v[68:71], v[84:87], a[80:95]
    ds_write_b128 v12, a[36:39] offset:1024
    s_waitcnt lgkmcnt(7)
    v_mfma_f32_32x32x16_bf16 a[64:79], v[56:59], v[88:91], a[64:79]
    ds_write_b128 v12, a[40:43] offset:2048
    ds_write_b128 v12, a[44:47] offset:3072
    v_mfma_f32_32x32x16_bf16 a[80:95], v[72:75], v[88:91], a[80:95]
    ds_write_b128 v12, a[48:51] offset:4096
    s_waitcnt lgkmcnt(9)
    v_mfma_f32_32x32x16_bf16 a[64:79], v[60:63], v[92:95], a[64:79]
    ds_write_b128 v12, a[52:55] offset:5120
    v_mfma_f32_32x32x16_bf16 a[80:95], v[76:79], v[92:95], a[80:95]
    ds_write_b128 v12, a[56:59] offset:6144
    ds_write_b128 v12, a[60:63] offset:7168
    s_waitcnt lgkmcnt(11)
    v_mfma_f32_32x32x16_bf16 a[96:111], v[48:51], v[96:99], a[96:111]
    v_mfma_f32_32x32x16_bf16 a[112:127], v[64:67], v[96:99], a[112:127]
    s_waitcnt lgkmcnt(10)
    v_mfma_f32_32x32x16_bf16 a[96:111], v[52:55], v[100:103], a[96:111]
    s_nop 2
    ds_write_b128 v12, a[64:67] offset:8192
    v_mfma_f32_32x32x16_bf16 a[112:127], v[68:71], v[100:103], a[112:127]
    ds_write_b128 v12, a[68:71] offset:9216
    s_waitcnt lgkmcnt(11)
    v_mfma_f32_32x32x16_bf16 a[96:111], v[56:59], v[104:107], a[96:111]
    ds_write_b128 v12, a[72:75] offset:10240
    ds_write_b128 v12, a[76:79] offset:11264
    v_mfma_f32_32x32x16_bf16 a[112:127], v[72:75], v[104:107], a[112:127]
    ds_write_b128 v12, a[80:83] offset:12288
    s_waitcnt lgkmcnt(13)
    v_mfma_f32_32x32x16_bf16 a[96:111], v[60:63], v[108:111], a[96:111]
    ds_write_b128 v12, a[84:87] offset:13312
    v_mfma_f32_32x32x16_bf16 a[112:127], v[76:79], v[108:111], a[112:127]
    ds_write_b128 v12, a[88:91] offset:14336
    ds_write_b128 v12, a[92:95] offset:15360
    s_setprio 3
    s_nop 6
    ds_write_b128 v12, a[96:99] offset:16384
    ds_write_b128 v12, a[100:103] offset:17408
    ds_write_b128 v12, a[104:107] offset:18432
    ds_write_b128 v12, a[108:111] offset:19456
    ds_write_b128 v12, a[112:115] offset:20480
    ds_write_b128 v12, a[116:119] offset:21504
    ds_write_b128 v12, a[120:123] offset:22528
    ds_write_b128 v12, a[124:127] offset:23552
    s_waitcnt lgkmcnt(0)
    s_barrier
    s_sub_u32 s17, s3, 1
    s_and_b32 s17, s17, 3
    s_lshl_b32 s17, s17, 15
    v_add_u32 v2, s17, v1
    ds_read_b128 v[16:19], v2 offset:0
    ds_read_b128 v[20:23], v2 offset:1024
    ds_read_b128 v[24:27], v2 offset:2048
    ds_read_b128 v[28:31], v2 offset:3072
    ds_read_b128 v[32:35], v2 offset:4096
    ds_read_b128 v[36:39], v2 offset:5120
    ds_read_b128 v[40:43], v2 offset:6144
    ds_read_b128 v[44:47], v2 offset:7168
    s_sub_u32 s17, s3, 2
    s_and_b32 s17, s17, 3
    s_lshl_b32 s17, s17, 15
    v_add_u32 v2, s17, v1
    ds_read_b128 v[48:51], v2 offset:8192
    ds_read_b128 v[52:55], v2 offset:9216
    ds_read_b128 v[56:59], v2 offset:10240
    ds_read_b128 v[60:63], v2 offset:11264
    ds_read_b128 v[64:67], v2 offset:12288
    ds_read_b128 v[68:71], v2 offset:13312
    ds_read_b128 v[72:75], v2 offset:14336
    ds_read_b128 v[76:79], v2 offset:15360
    s_sub_u32 s17, s3, 3
    s_and_b32 s17, s17, 3
    s_lshl_b32 s17, s17, 15
    v_add_u32 v2, s17, v1
    ds_read_b128 v[80:83], v2 offset:16384
    ds_read_b128 v[84:87], v2 offset:17408
    ds_read_b128 v[88:91], v2 offset:18432
    ds_read_b128 v[92:95], v2 offset:19456
    ds_read_b128 v[96:99], v2 offset:20480
    ds_read_b128 v[100:103], v2 offset:21504
    ds_read_b128 v[104:107], v2 offset:22528
    ds_read_b128 v[108:111], v2 offset:23552
    s_waitcnt vmcnt(0)
    v_lshlrev_b32 v11, 16, v11
    v_mov_b32 v10, v11
    v_mov_b32 v8, 0x40088e99
    v_mov_b32 v9, 0x40088e99
    v_accvgpr_read_b32 v2, a0
    v_accvgpr_read_b32 v3, a1
    s_waitcnt lgkmcnt(15)
    v_pk_add_f32 v[16:17], v[16:17], v[48:49]
    v_pk_add_f32 v[2:3], v[2:3], v[10:11]
    s_waitcnt lgkmcnt(7)
    v_pk_add_f32 v[16:17], v[16:17], v[80:81]
    v_pk_add_f32 v[16:17], v[16:17], v[2:3]
    v_accvgpr_read_b32 v4, a2
    v_accvgpr_read_b32 v5, a3
    v_pk_add_f32 v[18:19], v[18:19], v[50:51]
    v_pk_add_f32 v[4:5], v[4:5], v[10:11]
    v_pk_add_f32 v[18:19], v[18:19], v[82:83]
    v_pk_add_f32 v[18:19], v[18:19], v[4:5]
    v_accvgpr_read_b32 v2, a4
    v_accvgpr_read_b32 v3, a5
    v_pk_add_f32 v[20:21], v[20:21], v[52:53]
    v_pk_add_f32 v[2:3], v[2:3], v[10:11]
    s_waitcnt lgkmcnt(6)
    v_pk_add_f32 v[20:21], v[20:21], v[84:85]
    v_pk_add_f32 v[20:21], v[20:21], v[2:3]
    v_accvgpr_read_b32 v4, a6
    v_accvgpr_read_b32 v5, a7
    v_pk_add_f32 v[22:23], v[22:23], v[54:55]
    v_pk_add_f32 v[4:5], v[4:5], v[10:11]
    v_pk_add_f32 v[22:23], v[22:23], v[86:87]
    v_pk_add_f32 v[22:23], v[22:23], v[4:5]
    v_accvgpr_read_b32 v2, a8
    v_accvgpr_read_b32 v3, a9
    v_pk_add_f32 v[24:25], v[24:25], v[56:57]
    v_pk_add_f32 v[2:3], v[2:3], v[10:11]
    s_waitcnt lgkmcnt(5)
    v_pk_add_f32 v[24:25], v[24:25], v[88:89]
    v_pk_add_f32 v[24:25], v[24:25], v[2:3]
    v_accvgpr_read_b32 v4, a10
    v_accvgpr_read_b32 v5, a11
    v_pk_add_f32 v[26:27], v[26:27], v[58:59]
    v_pk_add_f32 v[4:5], v[4:5], v[10:11]
    v_pk_add_f32 v[26:27], v[26:27], v[90:91]
    v_pk_add_f32 v[26:27], v[26:27], v[4:5]
    v_accvgpr_read_b32 v2, a12
    v_accvgpr_read_b32 v3, a13
    v_pk_add_f32 v[28:29], v[28:29], v[60:61]
    v_pk_add_f32 v[2:3], v[2:3], v[10:11]
    s_waitcnt lgkmcnt(4)
    v_pk_add_f32 v[28:29], v[28:29], v[92:93]
    v_pk_add_f32 v[28:29], v[28:29], v[2:3]
    v_accvgpr_read_b32 v4, a14
    v_accvgpr_read_b32 v5, a15
    v_pk_add_f32 v[30:31], v[30:31], v[62:63]
    v_pk_add_f32 v[4:5], v[4:5], v[10:11]
    v_pk_add_f32 v[30:31], v[30:31], v[94:95]
    v_pk_add_f32 v[30:31], v[30:31], v[4:5]
    v_accvgpr_read_b32 v2, a16
    v_accvgpr_read_b32 v3, a17
    v_pk_add_f32 v[32:33], v[32:33], v[64:65]
    v_pk_add_f32 v[2:3], v[2:3], v[10:11]
    s_waitcnt lgkmcnt(3)
    v_pk_add_f32 v[32:33], v[32:33], v[96:97]
    v_pk_add_f32 v[32:33], v[32:33], v[2:3]
    v_accvgpr_read_b32 v4, a18
    v_accvgpr_read_b32 v5, a19
    v_pk_add_f32 v[34:35], v[34:35], v[66:67]
    v_pk_add_f32 v[4:5], v[4:5], v[10:11]
    v_pk_add_f32 v[34:35], v[34:35], v[98:99]
    v_pk_add_f32 v[34:35], v[34:35], v[4:5]
    v_accvgpr_read_b32 v2, a20
    v_accvgpr_read_b32 v3, a21
    v_pk_add_f32 v[36:37], v[36:37], v[68:69]
    v_pk_add_f32 v[2:3], v[2:3], v[10:11]
    s_waitcnt lgkmcnt(2)
    v_pk_add_f32 v[36:37], v[36:37], v[100:101]
    v_pk_add_f32 v[36:37], v[36:37], v[2:3]
    v_accvgpr_read_b32 v4, a22
    v_accvgpr_read_b32 v5, a23
    v_pk_add_f32 v[38:39], v[38:39], v[70:71]
    v_pk_add_f32 v[4:5], v[4:5], v[10:11]
    v_pk_add_f32 v[38:39], v[38:39], v[102:103]
    v_pk_add_f32 v[38:39], v[38:39], v[4:5]
    v_accvgpr_read_b32 v2, a24
    v_accvgpr_read_b32 v3, a25
    v_pk_add_f32 v[40:41], v[40:41], v[72:73]
    v_pk_add_f32 v[2:3], v[2:3], v[10:11]
    s_waitcnt lgkmcnt(1)
    v_pk_add_f32 v[40:41], v[40:41], v[104:105]
    v_pk_add_f32 v[40:41], v[40:41], v[2:3]
    v_accvgpr_read_b32 v4, a26
    v_accvgpr_read_b32 v5, a27
    v_pk_add_f32 v[42:43], v[42:43], v[74:75]
    v_pk_add_f32 v[4:5], v[4:5], v[10:11]
    v_pk_add_f32 v[42:43], v[42:43], v[106:107]
    v_pk_add_f32 v[42:43], v[42:43], v[4:5]
    v_accvgpr_read_b32 v2, a28
    v_accvgpr_read_b32 v3, a29
    v_pk_add_f32 v[44:45], v[44:45], v[76:77]
    v_pk_add_f32 v[2:3], v[2:3], v[10:11]
    s_waitcnt lgkmcnt(0)
    v_pk_add_f32 v[44:45], v[44:45], v[108:109]
    v_pk_add_f32 v[44:45], v[44:45], v[2:3]
    v_accvgpr_read_b32 v4, a30
    v_accvgpr_read_b32 v5, a31
    v_pk_add_f32 v[46:47], v[46:47], v[78:79]
    v_pk_add_f32 v[4:5], v[4:5], v[10:11]
    v_pk_add_f32 v[46:47], v[46:47], v[110:111]
    v_pk_add_f32 v[46:47], v[46:47], v[4:5]
    v_lshlrev_b32 v2, 16, v112
    v_and_b32 v3, 0xffff0000, v112
    v_pk_mul_f32 v[16:17], v[16:17], v[8:9]
    v_pk_mul_f32 v[16:17], v[16:17], v[2:3]
    v_cvt_pk_bf16_f32 v48, v16, v17
    v_lshlrev_b32 v4, 16, v113
    v_and_b32 v5, 0xffff0000, v113
    v_pk_mul_f32 v[18:19], v[18:19], v[8:9]
    v_pk_mul_f32 v[18:19], v[18:19], v[4:5]
    v_cvt_pk_bf16_f32 v49, v18, v19
    v_lshlrev_b32 v2, 16, v114
    v_and_b32 v3, 0xffff0000, v114
    v_pk_mul_f32 v[20:21], v[20:21], v[8:9]
    v_pk_mul_f32 v[20:21], v[20:21], v[2:3]
    v_cvt_pk_bf16_f32 v50, v20, v21
    v_lshlrev_b32 v4, 16, v115
    v_and_b32 v5, 0xffff0000, v115
    v_pk_mul_f32 v[22:23], v[22:23], v[8:9]
    v_pk_mul_f32 v[22:23], v[22:23], v[4:5]
    v_cvt_pk_bf16_f32 v51, v22, v23
    v_lshlrev_b32 v2, 16, v116
    v_and_b32 v3, 0xffff0000, v116
    v_pk_mul_f32 v[24:25], v[24:25], v[8:9]
    v_pk_mul_f32 v[24:25], v[24:25], v[2:3]
    v_cvt_pk_bf16_f32 v52, v24, v25
    v_lshlrev_b32 v4, 16, v117
    v_and_b32 v5, 0xffff0000, v117
    v_pk_mul_f32 v[26:27], v[26:27], v[8:9]
    v_pk_mul_f32 v[26:27], v[26:27], v[4:5]
    v_cvt_pk_bf16_f32 v53, v26, v27
    v_lshlrev_b32 v2, 16, v118
    v_and_b32 v3, 0xffff0000, v118
    v_pk_mul_f32 v[28:29], v[28:29], v[8:9]
    v_pk_mul_f32 v[28:29], v[28:29], v[2:3]
    v_cvt_pk_bf16_f32 v54, v28, v29
    v_lshlrev_b32 v4, 16, v119
    v_and_b32 v5, 0xffff0000, v119
    v_pk_mul_f32 v[30:31], v[30:31], v[8:9]
    v_pk_mul_f32 v[30:31], v[30:31], v[4:5]
    v_cvt_pk_bf16_f32 v55, v30, v31
    v_lshlrev_b32 v2, 16, v120
    v_and_b32 v3, 0xffff0000, v120
    v_pk_mul_f32 v[32:33], v[32:33], v[8:9]
    v_pk_mul_f32 v[32:33], v[32:33], v[2:3]
    v_cvt_pk_bf16_f32 v56, v32, v33
    v_lshlrev_b32 v4, 16, v121
    v_and_b32 v5, 0xffff0000, v121
    v_pk_mul_f32 v[34:35], v[34:35], v[8:9]
    v_pk_mul_f32 v[34:35], v[34:35], v[4:5]
    v_cvt_pk_bf16_f32 v57, v34, v35
    v_lshlrev_b32 v2, 16, v122
    v_and_b32 v3, 0xffff0000, v122
    v_pk_mul_f32 v[36:37], v[36:37], v[8:9]
    v_pk_mul_f32 v[36:37], v[36:37], v[2:3]
    v_cvt_pk_bf16_f32 v58, v36, v37
    v_lshlrev_b32 v4, 16, v123
    v_and_b32 v5, 0xffff0000, v123
    v_pk_mul_f32 v[38:39], v[38:39], v[8:9]
    v_pk_mul_f32 v[38:39], v[38:39], v[4:5]
    v_cvt_pk_bf16_f32 v59, v38, v39
    v_lshlrev_b32 v2, 16, v124
    v_and_b32 v3, 0xffff0000, v124
    v_pk_mul_f32 v[40:41], v[40:41], v[8:9]
    v_pk_mul_f32 v[40:41], v[40:41], v[2:3]
    v_cvt_pk_bf16_f32 v60, v40, v41
    v_lshlrev_b32 v4, 16, v125
    v_and_b32 v5, 0xffff0000, v125
    v_pk_mul_f32 v[42:43], v[42:43], v[8:9]
    v_pk_mul_f32 v[42:43], v[42:43], v[4:5]
    v_cvt_pk_bf16_f32 v61, v42, v43
    v_lshlrev_b32 v2, 16, v126
    v_and_b32 v3, 0xffff0000, v126
    v_pk_mul_f32 v[44:45], v[44:45], v[8:9]
    v_pk_mul_f32 v[44:45], v[44:45], v[2:3]
    v_cvt_pk_bf16_f32 v62, v44, v45
    v_lshlrev_b32 v4, 16, v127
    v_and_b32 v5, 0xffff0000, v127
    v_pk_mul_f32 v[46:47], v[46:47], v[8:9]
    v_pk_mul_f32 v[46:47], v[46:47], v[4:5]
    v_cvt_pk_bf16_f32 v63, v46, v47
    s_mul_i32 s15, s14, 88
    s_add_u32 s15, s15, s16
    s_add_u32 s15, s15, 32
    s_lshl_b32 s15, s15, 10
    s_add_u32 s15, s15, 14680064
    buffer_store_dwordx4 v[48:51], v1, s[28:31], s15 offen offset:0
    buffer_store_dwordx4 v[52:55], v1, s[28:31], s15 offen offset:1024
    buffer_store_dwordx4 v[56:59], v1, s[28:31], s15 offen offset:2048
    buffer_store_dwordx4 v[60:63], v1, s[28:31], s15 offen offset:3072
    s_add_u32 s3, s3, 4
L_k2_fin:
L_k2_end:
    s_endpgm
L_k2_pref:
    s_load_dwordx2 s[12:13], s[0:1], 16
    s_load_dwordx2 s[14:15], s[0:1], 56
    s_sub_u32 s16, s11, 28
    s_lshl_b32 s16, s16, 3
    s_add_u32 s16, s16, s10
    s_lshl_b32 s16, s16, 2
    s_sub_u32 s17, s3, 4
    s_add_u32 s16, s16, s17
    s_mul_i32 s17, s16, 4096
    s_mul_i32 s18, s16, 7168
    s_add_u32 s19, s18, 4096
    s_waitcnt lgkmcnt(0)
    s_mov_b32 s20, s12
    s_and_b32 s21, s13, 0xffff
    s_mov_b32 s22, 401408
    s_mov_b32 s23, 0x20000
    s_mov_b32 s24, s14
    s_and_b32 s25, s15, 0xffff
    s_mov_b32 s26, 802816
    s_mov_b32 s27, 0x20000
    buffer_load_dwordx4 v[4:7], v1, s[20:23], s17 offen offset:0
    buffer_load_dwordx4 v[8:11], v1, s[20:23], s17 offen offset:1024
    buffer_load_dwordx4 v[12:15], v1, s[20:23], s17 offen offset:2048
    buffer_load_dwordx4 v[16:19], v1, s[20:23], s17 offen offset:3072
    buffer_load_dwordx4 v[20:23], v1, s[24:27], s18 offen offset:0
    buffer_load_dwordx4 v[24:27], v1, s[24:27], s18 offen offset:1024
    buffer_load_dwordx4 v[28:31], v1, s[24:27], s18 offen offset:2048
    buffer_load_dwordx4 v[32:35], v1, s[24:27], s18 offen offset:3072
    buffer_load_dwordx4 v[36:39], v1, s[24:27], s19 offen offset:0
    buffer_load_dwordx4 v[40:43], v1, s[24:27], s19 offen offset:1024
    buffer_load_dwordx4 v[44:47], v1, s[24:27], s19 offen offset:2048
    s_endpgm
.section .rodata,"a"
.p2align 6
.amdhsa_kernel k2_kernel
  .amdhsa_next_free_vgpr 256
  .amdhsa_next_free_sgpr 100
  .amdhsa_accum_offset 128
  .amdhsa_group_segment_fixed_size 0
  .amdhsa_kernarg_size 88
  .amdhsa_user_sgpr_count 2
  .amdhsa_user_sgpr_kernarg_segment_ptr 1
  .amdhsa_system_sgpr_workgroup_id_x 1
.end_amdhsa_kernel

.text
.globl k3_kernel
.p2align 8
.type k3_kernel,@function
k3_kernel:
    s_cmp_ge_u32 s2, 224
    s_cbranch_scc1 L_k3_end
    s_load_dwordx2 s[4:5], s[0:1], 0
    s_load_dwordx2 s[6:7], s[0:1], 16
    s_load_dwordx4 s[8:11], s[0:1], 56
    s_load_dwordx2 s[12:13], s[0:1], 80
    v_lshrrev_b32 v1, 6, v0
    v_and_b32 v0, 63, v0
    v_readfirstlane_b32 s3, v1
    s_and_b32 s14, s2, 7
    s_lshl_b32 s14, s14, 2
    s_bfe_u32 s15, s2, 0x20003
    s_add_u32 s14, s14, s15
    s_lshr_b32 s15, s2, 5
    v_lshlrev_b32 v2, 4, v0
    v_lshrrev_b32 v3, 3, v0
    v_and_b32 v4, 7, v0
    v_bfe_u32 v5, v0, 4, 1
    v_lshlrev_b32 v5, 2, v5
    v_xor_b32 v4, v4, v5
    v_mul_u32_u24 v3, 896, v3
    v_lshl_add_u32 v3, v4, 4, v3
    v_add_u32 v4, 7168, v3
    v_bfe_u32 v5, v0, 2, 2
    v_bfe_u32 v6, v0, 5, 1
    v_lshl_add_u32 v5, v6, 2, v5
    v_lshlrev_b32 v5, 7, v5
    v_bfe_u32 v6, v0, 4, 1
    v_bfe_u32 v7, v0, 1, 1
    v_lshl_add_u32 v6, v6, 1, v7
    v_bfe_u32 v7, v0, 3, 1
    v_lshl_add_u32 v6, v7, 2, v6
    v_lshl_add_u32 v5, v6, 4, v5
    v_and_b32 v6, 1, v0
    v_lshl_add_u32 v5, v6, 3, v5
    s_mul_i32 s16, s3, 28672
    v_add_u32 v5, s16, v5
    v_xor_b32 v6, 64, v5
    s_waitcnt lgkmcnt(0)
    s_mov_b32 s20, s6
    s_and_b32 s21, s7, 0xffff
    s_mov_b32 s22, 401408
    s_mov_b32 s23, 0x20000
    s_mov_b32 s24, s8
    s_and_b32 s25, s9, 0xffff
    s_mov_b32 s26, 802816
    s_mov_b32 s27, 0x20000
    s_add_u32 s28, s12, 14680064
    s_addc_u32 s29, s13, 0
    s_and_b32 s29, s29, 0xffff
    s_mov_b32 s30, 5767168
    s_mov_b32 s31, 0x20000
    s_mov_b32 s32, s4
    s_and_b32 s33, s5, 0xffff
    s_mov_b32 s34, 1835008
    s_mov_b32 s35, 0x20000
    s_mov_b32 s36, s10
    s_and_b32 s37, s11, 0xffff
    s_mov_b32 s38, 1835008
    s_mov_b32 s39, 0x20000
    s_lshl_b32 s17, s15, 7
    s_mul_i32 s18, s3, 100352
    s_add_u32 s18, s18, s17
    s_mul_i32 s19, s3, 200704
    s_add_u32 s19, s19, s17
    s_mul_i32 s40, s14, 180224
    s_lshl_b32 s41, s3, 13
    s_add_u32 s41, s40, s41
    s_mul_i32 s42, s3, 14336
    s_add_u32 s42, s42, s40
    s_add_u32 s42, s42, 32768
    s_add_u32 s44, s18, 0
    s_add_u32 m0, s16, 0
    s_nop 0
    buffer_load_dwordx4 v3, s[20:23], s44 offen lds
    s_add_u32 m0, s16, 1024
    s_add_u32 s45, s41, 0
    buffer_load_dwordx4 v4, s[20:23], s44 offen lds
    s_add_u32 s46, s45, 90112
    buffer_load_dwordx4 v[16:19], v2, s[28:31], s45 offen
    buffer_load_dwordx4 v[20:23], v2, s[28:31], s46 offen
    s_add_u32 s44, s18, 14336
    s_add_u32 m0, s16, 2048
    s_nop 0
    buffer_load_dwordx4 v3, s[20:23], s44 offen lds
    s_add_u32 m0, s16, 3072
    s_add_u32 s45, s41, 1024
    buffer_load_dwordx4 v4, s[20:23], s44 offen lds
    s_add_u32 s46, s45, 90112
    buffer_load_dwordx4 v[24:27], v2, s[28:31], s45 offen
    buffer_load_dwordx4 v[28:31], v2, s[28:31], s46 offen
    s_add_u32 s44, s18, 25088
    s_add_u32 m0, s16, 4096
    s_nop 0
    buffer_load_dwordx4 v3, s[20:23], s44 offen lds
    s_add_u32 m0, s16, 5120
    s_add_u32 s45, s41, 2048
    buffer_load_dwordx4 v4, s[20:23], s44 offen lds
    s_add_u32 s46, s45, 90112
    buffer_load_dwordx4 v[32:35], v2, s[28:31], s45 offen
    buffer_load_dwordx4 v[36:39], v2, s[28:31], s46 offen
    s_add_u32 s44, s18, 39424
    s_add_u32 m0, s16, 6144
    s_nop 0
    buffer_load_dwordx4 v3, s[20:23], s44 offen lds
    s_add_u32 m0, s16, 7168
    s_add_u32 s45, s41, 3072
    buffer_load_dwordx4 v4, s[20:23], s44 offen lds
    s_add_u32 s46, s45, 90112
    buffer_load_dwordx4 v[40:43], v2, s[28:31], s45 offen
    buffer_load_dwordx4 v[44:47], v2, s[28:31], s46 offen
    s_add_u32 s44, s18, 50176
    s_add_u32 m0, s16, 8192
    s_nop 0
    buffer_load_dwordx4 v3, s[20:23], s44 offen lds
    s_add_u32 m0, s16, 9216
    s_add_u32 s45, s41, 4096
    buffer_load_dwordx4 v4, s[20:23], s44 offen lds
    s_add_u32 s46, s45, 90112
    buffer_load_dwordx4 v[48:51], v2, s[28:31], s45 offen
    buffer_load_dwordx4 v[52:55], v2, s[28:31], s46 offen
    s_add_u32 s44, s18, 64512
    s_add_u32 m0, s16, 10240
    s_nop 0
    buffer_load_dwordx4 v3, s[20:23], s44 offen lds
    s_add_u32 m0, s16, 11264
    s_add_u32 s45, s41, 5120
    buffer_load_dwordx4 v4, s[20:23], s44 offen lds
    s_add_u32 s46, s45, 90112
    buffer_load_dwordx4 v[56:59], v2, s[28:31], s45 offen
    buffer_load_dwordx4 v[60:63], v2, s[28:31], s46 offen
    v_and_b32 v7, 31, v0
    v_mul_u32_u24 v7, 896, v7
    v_bfe_u32 v8, v0, 5, 1
    v_lshl_add_u32 v7, v8, 4, v7
    s_lshr_b32 s47, s3, 1
    s_lshl_b32 s48, s14, 1
    s_add_u32 s47, s47, s48
    s_mul_i32 s47, s47, 28672
    s_and_b32 s48, s3, 1
    s_lshl_b32 s48, s48, 6
    s_add_u32 s47, s47, s48
    s_add_u32 s47, s47, s17
    buffer_load_dwordx4 v[208:211], v7, s[32:35], s47 offen
    buffer_load_dwordx4 v[212:215], v7, s[32:35], s47 offen offset:32
    s_waitcnt vmcnt(24)
    ds_read_b64_tr_b16 a[64:65], v5 offset:0
    ds_read_b64_tr_b16 a[66:67], v5 offset:1024
    ds_read_b64_tr_b16 a[68:69], v6 offset:0
    ds_read_b64_tr_b16 a[70:71], v6 offset:1024
    s_waitcnt vmcnt(23) lgkmcnt(2)
    v_mfma_f32_32x32x16_bf16 a[0:15], a[64:67], v[16:19], 0
    s_add_u32 s44, s18, 75264
    s_add_u32 m0, s16, 12288
    s_nop 0
    buffer_load_dwordx4 v3, s[20:23], s44 offen lds
    s_waitcnt vmcnt(21)
    ds_read_b64_tr_b16 a[72:73], v5 offset:2048
    ds_read_b64_tr_b16 a[74:75], v5 offset:3072
    ds_read_b64_tr_b16 a[76:77], v6 offset:2048
    ds_read_b64_tr_b16 a[78:79], v6 offset:3072
    v_mfma_f32_32x32x16_bf16 a[16:31], a[64:67], v[20:23], 0
    s_add_u32 m0, s16, 13312
    s_add_u32 s45, s41, 6144
    buffer_load_dwordx4 v4, s[20:23], s44 offen lds
    s_waitcnt lgkmcnt(4)
    v_mfma_f32_32x32x16_bf16 a[32:47], a[68:71], v[16:19], 0
    s_add_u32 s46, s45, 90112
    buffer_load_dwordx4 v[64:67], v2, s[28:31], s45 offen
    v_mfma_f32_32x32x16_bf16 a[48:63], a[68:71], v[20:23], 0
    buffer_load_dwordx4 v[68:71], v2, s[28:31], s46 offen
    s_waitcnt vmcnt(23) lgkmcnt(2)
    v_mfma_f32_32x32x16_bf16 a[0:15], a[72:75], v[24:27], a[0:15]
    s_add_u32 s44, s18, 89600
    s_add_u32 m0, s16, 14336
    s_nop 0
    buffer_load_dwordx4 v3, s[20:23], s44 offen lds
    s_waitcnt vmcnt(21)
    ds_read_b64_tr_b16 a[80:81], v5 offset:4096
    ds_read_b64_tr_b16 a[82:83], v5 offset:5120
    ds_read_b64_tr_b16 a[84:85], v6 offset:4096
    ds_read_b64_tr_b16 a[86:87], v6 offset:5120
    v_mfma_f32_32x32x16_bf16 a[16:31], a[72:75], v[28:31], a[16:31]
    s_add_u32 m0, s16, 15360
    s_add_u32 s45, s41, 7168
    buffer_load_dwordx4 v4, s[20:23], s44 offen lds
    s_waitcnt lgkmcnt(4)
    v_mfma_f32_32x32x16_bf16 a[32:47], a[76:79], v[24:27], a[32:47]
    s_add_u32 s46, s45, 90112
    buffer_load_dwordx4 v[72:75], v2, s[28:31], s45 offen
    v_mfma_f32_32x32x16_bf16 a[48:63], a[76:79], v[28:31], a[48:63]
    buffer_load_dwordx4 v[76:79], v2, s[28:31], s46 offen
    s_waitcnt vmcnt(23) lgkmcnt(2)
    v_mfma_f32_32x32x16_bf16 a[0:15], a[80:83], v[32:35], a[0:15]
    s_add_u32 s44, s19, 0
    s_add_u32 m0, s16, 16384
    s_nop 0
    buffer_load_dwordx4 v3, s[24:27], s44 offen lds
    s_waitcnt vmcnt(21)
    ds_read_b64_tr_b16 a[64:65], v5 offset:6144
    ds_read_b64_tr_b16 a[66:67], v5 offset:7168
    ds_read_b64_tr_b16 a[68:69], v6 offset:6144
    ds_read_b64_tr_b16 a[70:71], v6 offset:7168
    v_mfma_f32_32x32x16_bf16 a[16:31], a[80:83], v[36:39], a[16:31]
    s_add_u32 m0, s16, 17408
    s_add_u32 s45, s42, 0
    buffer_load_dwordx4 v4, s[24:27], s44 offen lds
    s_waitcnt lgkmcnt(4)
    v_mfma_f32_32x32x16_bf16 a[32:47], a[84:87], v[32:35], a[32:47]
    s_add_u32 s46, s45, 90112
    buffer_load_dwordx4 v[80:83], v2, s[28:31], s45 offen
    v_mfma_f32_32x32x16_bf16 a[48:63], a[84:87], v[36:39], a[48:63]
    buffer_load_dwordx4 v[84:87], v2, s[28:31], s46 offen
    s_waitcnt vmcnt(23) lgkmcnt(2)
    v_mfma_f32_32x32x16_bf16 a[0:15], a[64:67], v[40:43], a[0:15]
    s_add_u32 s44, s19, 14336
    s_add_u32 m0, s16, 18432
    s_nop 0
    buffer_load_dwordx4 v3, s[24:27], s44 offen lds
    s_waitcnt vmcnt(21)
    ds_read_b64_tr_b16 a[72:73], v5 offset:8192
    ds_read_b64_tr_b16 a[74:75], v5 offset:9216
    ds_read_b64_tr_b16 a[76:77], v6 offset:8192
    ds_read_b64_tr_b16 a[78:79], v6 offset:9216
    v_mfma_f32_32x32x16_bf16 a[16:31], a[64:67], v[44:47], a[16:31]
    s_add_u32 m0, s16, 19456
    s_add_u32 s45, s42, 1024
    buffer_load_dwordx4 v4, s[24:27], s44 offen lds
    s_waitcnt lgkmcnt(4)
    v_mfma_f32_32x32x16_bf16 a[32:47], a[68:71], v[40:43], a[32:47]
    s_add_u32 s46, s45, 90112
    buffer_load_dwordx4 v[88:91], v2, s[28:31], s45 offen
    v_mfma_f32_32x32x16_bf16 a[48:63], a[68:71], v[44:47], a[48:63]
    buffer_load_dwordx4 v[92:95], v2, s[28:31], s46 offen
    s_waitcnt vmcnt(23) lgkmcnt(2)
    v_mfma_f32_32x32x16_bf16 a[0:15], a[72:75], v[48:51], a[0:15]
    s_add_u32 s44, s19, 28672
    s_add_u32 m0, s16, 20480
    s_nop 0
    buffer_load_dwordx4 v3, s[24:27], s44 offen lds
    s_waitcnt vmcnt(21)
    ds_read_b64_tr_b16 a[80:81], v5 offset:10240
    ds_read_b64_tr_b16 a[82:83], v5 offset:11264
    ds_read_b64_tr_b16 a[84:85], v6 offset:10240
    ds_read_b64_tr_b16 a[86:87], v6 offset:11264
    v_mfma_f32_32x32x16_bf16 a[16:31], a[72:75], v[52:55], a[16:31]
    s_add_u32 m0, s16, 21504
    s_add_u32 s45, s42, 2048
    buffer_load_dwordx4 v4, s[24:27], s44 offen lds
    s_waitcnt lgkmcnt(4)
    v_mfma_f32_32x32x16_bf16 a[32:47], a[76:79], v[48:51], a[32:47]
    s_add_u32 s46, s45, 90112
    buffer_load_dwordx4 v[96:99], v2, s[28:31], s45 offen
    v_mfma_f32_32x32x16_bf16 a[48:63], a[76:79], v[52:55], a[48:63]
    buffer_load_dwordx4 v[100:103], v2, s[28:31], s46 offen
    s_waitcnt vmcnt(23) lgkmcnt(2)
    v_mfma_f32_32x32x16_bf16 a[0:15], a[80:83], v[56:59], a[0:15]
    s_add_u32 s44, s19, 43008
    s_add_u32 m0, s16, 22528
    s_nop 0
    buffer_load_dwordx4 v3, s[24:27], s44 offen lds
    s_waitcnt vmcnt(19)
    ds_read_b64_tr_b16 a[64:65], v5 offset:12288
    ds_read_b64_tr_b16 a[66:67], v5 offset:13312
    ds_read_b64_tr_b16 a[68:69], v6 offset:12288
    ds_read_b64_tr_b16 a[70:71], v6 offset:13312
    v_mfma_f32_32x32x16_bf16 a[16:31], a[80:83], v[60:63], a[16:31]
    s_add_u32 m0, s16, 23552
    s_add_u32 s45, s42, 3072
    buffer_load_dwordx4 v4, s[24:27], s44 offen lds
    s_waitcnt lgkmcnt(4)
    v_mfma_f32_32x32x16_bf16 a[32:47], a[84:87], v[56:59], a[32:47]
    s_add_u32 s46, s45, 90112
    buffer_load_dwordx4 v[104:107], v2, s[28:31], s45 offen
    v_mfma_f32_32x32x16_bf16 a[48:63], a[84:87], v[60:63], a[48:63]
    buffer_load_dwordx4 v[108:111], v2, s[28:31], s46 offen
    s_waitcnt vmcnt(21) lgkmcnt(2)
    v_mfma_f32_32x32x16_bf16 a[0:15], a[64:67], v[64:67], a[0:15]
    s_add_u32 s44, s19, 57344
    s_add_u32 m0, s16, 24576
    s_nop 0
    buffer_load_dwordx4 v3, s[24:27], s44 offen lds
    s_waitcnt vmcnt(19)
    ds_read_b64_tr_b16 a[72:73], v5 offset:14336
    ds_read_b64_tr_b16 a[74:75], v5 offset:15360
    ds_read_b64_tr_b16 a[76:77], v6 offset:14336
    ds_read_b64_tr_b16 a[78:79], v6 offset:15360
    v_mfma_f32_32x32x16_bf16 a[16:31], a[64:67], v[68:71], a[16:31]
    s_add_u32 m0, s16, 25600
    s_add_u32 s45, s42, 4096
    buffer_load_dwordx4 v4, s[24:27], s44 offen lds
    s_waitcnt lgkmcnt(4)
    v_mfma_f32_32x32x16_bf16 a[32:47], a[68:71], v[64:67], a[32:47]
    s_add_u32 s46, s45, 90112
    buffer_load_dwordx4 v[112:115], v2, s[28:31], s45 offen
    v_mfma_f32_32x32x16_bf16 a[48:63], a[68:71], v[68:71], a[48:63]
    buffer_load_dwordx4 v[116:119], v2, s[28:31], s46 offen
    s_waitcnt vmcnt(21) lgkmcnt(2)
    v_mfma_f32_32x32x16_bf16 a[0:15], a[72:75], v[72:75], a[0:15]
    s_add_u32 s44, s19, 71680
    s_add_u32 m0, s16, 26624
    s_nop 0
    buffer_load_dwordx4 v3, s[24:27], s44 offen lds
    s_waitcnt vmcnt(19)
    ds_read_b64_tr_b16 a[80:81], v5 offset:16384
    ds_read_b64_tr_b16 a[82:83], v5 offset:17408
    ds_read_b64_tr_b16 a[84:85], v6 offset:16384
    ds_read_b64_tr_b16 a[86:87], v6 offset:17408
    v_mfma_f32_32x32x16_bf16 a[16:31], a[72:75], v[76:79], a[16:31]
    s_add_u32 m0, s16, 27648
    s_add_u32 s45, s42, 5120
    buffer_load_dwordx4 v4, s[24:27], s44 offen lds
    s_waitcnt lgkmcnt(4)
    v_mfma_f32_32x32x16_bf16 a[32:47], a[76:79], v[72:75], a[32:47]
    s_add_u32 s46, s45, 90112
    buffer_load_dwordx4 v[120:123], v2, s[28:31], s45 offen
    v_mfma_f32_32x32x16_bf16 a[48:63], a[76:79], v[76:79], a[48:63]
    buffer_load_dwordx4 v[124:127], v2, s[28:31], s46 offen
    s_waitcnt vmcnt(21) lgkmcnt(2)
    v_mfma_f32_32x32x16_bf16 a[0:15], a[80:83], v[80:83], a[0:15]
    s_add_u32 s44, s19, 86016
    s_add_u32 m0, s16, 0
    s_nop 0
    buffer_load_dwordx4 v3, s[24:27], s44 offen lds
    s_waitcnt vmcnt(19)
    ds_read_b64_tr_b16 a[64:65], v5 offset:18432
    ds_read_b64_tr_b16 a[66:67], v5 offset:19456
    ds_read_b64_tr_b16 a[68:69], v6 offset:18432
    ds_read_b64_tr_b16 a[70:71], v6 offset:19456
    v_mfma_f32_32x32x16_bf16 a[16:31], a[80:83], v[84:87], a[16:31]
    s_add_u32 m0, s16, 1024
    s_add_u32 s45, s42, 6144
    buffer_load_dwordx4 v4, s[24:27], s44 offen lds
    s_waitcnt lgkmcnt(4)
    v_mfma_f32_32x32x16_bf16 a[32:47], a[84:87], v[80:83], a[32:47]
    s_add_u32 s46, s45, 90112
    buffer_load_dwordx4 v[128:131], v2, s[28:31], s45 offen
    v_mfma_f32_32x32x16_bf16 a[48:63], a[84:87], v[84:87], a[48:63]
    buffer_load_dwordx4 v[132:135], v2, s[28:31], s46 offen
    s_waitcnt vmcnt(21) lgkmcnt(2)
    v_mfma_f32_32x32x16_bf16 a[0:15], a[64:67], v[88:91], a[0:15]
    s_add_u32 s44, s19, 100352
    s_add_u32 m0, s16, 2048
    s_nop 0
    buffer_load_dwordx4 v3, s[24:27], s44 offen lds
    s_waitcnt vmcnt(19)
    ds_read_b64_tr_b16 a[72:73], v5 offset:20480
    ds_read_b64_tr_b16 a[74:75], v5 offset:21504
    ds_read_b64_tr_b16 a[76:77], v6 offset:20480
    ds_read_b64_tr_b16 a[78:79], v6 offset:21504
    v_mfma_f32_32x32x16_bf16 a[16:31], a[64:67], v[92:95], a[16:31]
    s_add_u32 m0, s16, 3072
    s_add_u32 s45, s42, 7168
    buffer_load_dwordx4 v4, s[24:27], s44 offen lds
    s_waitcnt lgkmcnt(4)
    v_mfma_f32_32x32x16_bf16 a[32:47], a[68:71], v[88:91], a[32:47]
    s_add_u32 s46, s45, 90112
    buffer_load_dwordx4 v[136:139], v2, s[28:31], s45 offen
    v_mfma_f32_32x32x16_bf16 a[48:63], a[68:71], v[92:95], a[48:63]
    buffer_load_dwordx4 v[140:143], v2, s[28:31], s46 offen
    s_waitcnt vmcnt(21) lgkmcnt(2)
    v_mfma_f32_32x32x16_bf16 a[0:15], a[72:75], v[96:99], a[0:15]
    s_add_u32 s44, s19, 114688
    s_add_u32 m0, s16, 4096
    s_nop 0
    buffer_load_dwordx4 v3, s[24:27], s44 offen lds
    s_waitcnt vmcnt(19)
    ds_read_b64_tr_b16 a[80:81], v5 offset:22528
    ds_read_b64_tr_b16 a[82:83], v5 offset:23552
    ds_read_b64_tr_b16 a[84:85], v6 offset:22528
    ds_read_b64_tr_b16 a[86:87], v6 offset:23552
    v_mfma_f32_32x32x16_bf16 a[16:31], a[72:75], v[100:103], a[16:31]
    s_add_u32 m0, s16, 5120
    s_add_u32 s45, s42, 8192
    buffer_load_dwordx4 v4, s[24:27], s44 offen lds
    s_waitcnt lgkmcnt(4)
    v_mfma_f32_32x32x16_bf16 a[32:47], a[76:79], v[96:99], a[32:47]
    s_add_u32 s46, s45, 90112
    buffer_load_dwordx4 v[144:147], v2, s[28:31], s45 offen
    v_mfma_f32_32x32x16_bf16 a[48:63], a[76:79], v[100:103], a[48:63]
    buffer_load_dwordx4 v[148:151], v2, s[28:31], s46 offen
    s_waitcnt vmcnt(21) lgkmcnt(2)
    v_mfma_f32_32x32x16_bf16 a[0:15], a[80:83], v[104:107], a[0:15]
    s_add_u32 s44, s19, 129024
    s_add_u32 m0, s16, 6144
    s_nop 0
    buffer_load_dwordx4 v3, s[24:27], s44 offen lds
    s_waitcnt vmcnt(19)
    ds_read_b64_tr_b16 a[64:65], v5 offset:24576
    ds_read_b64_tr_b16 a[66:67], v5 offset:25600
    ds_read_b64_tr_b16 a[68:69], v6 offset:24576
    ds_read_b64_tr_b16 a[70:71], v6 offset:25600
    v_mfma_f32_32x32x16_bf16 a[16:31], a[80:83], v[108:111], a[16:31]
    s_add_u32 m0, s16, 7168
    s_add_u32 s45, s42, 9216
    buffer_load_dwordx4 v4, s[24:27], s44 offen lds
    s_waitcnt lgkmcnt(4)
    v_mfma_f32_32x32x16_bf16 a[32:47], a[84:87], v[104:107], a[32:47]
    s_add_u32 s46, s45, 90112
    buffer_load_dwordx4 v[152:155], v2, s[28:31], s45 offen
    v_mfma_f32_32x32x16_bf16 a[48:63], a[84:87], v[108:111], a[48:63]
    buffer_load_dwordx4 v[156:159], v2, s[28:31], s46 offen
    s_waitcnt vmcnt(21) lgkmcnt(2)
    v_mfma_f32_32x32x16_bf16 a[0:15], a[64:67], v[112:115], a[0:15]
    s_add_u32 s44, s19, 143360
    s_add_u32 m0, s16, 8192
    s_nop 0
    buffer_load_dwordx4 v3, s[24:27], s44 offen lds
    s_waitcnt vmcnt(19)
    ds_read_b64_tr_b16 a[72:73], v5 offset:26624
    ds_read_b64_tr_b16 a[74:75], v5 offset:27648
    ds_read_b64_tr_b16 a[76:77], v6 offset:26624
    ds_read_b64_tr_b16 a[78:79], v6 offset:27648
    v_mfma_f32_32x32x16_bf16 a[16:31], a[64:67], v[116:119], a[16:31]
    s_add_u32 m0, s16, 9216
    s_add_u32 s45, s42, 10240
    buffer_load_dwordx4 v4, s[24:27], s44 offen lds
    s_waitcnt lgkmcnt(4)
    v_mfma_f32_32x32x16_bf16 a[32:47], a[68:71], v[112:115], a[32:47]
    s_add_u32 s46, s45, 90112
    buffer_load_dwordx4 v[160:163], v2, s[28:31], s45 offen
    v_mfma_f32_32x32x16_bf16 a[48:63], a[68:71], v[116:119], a[48:63]
    buffer_load_dwordx4 v[164:167], v2, s[28:31], s46 offen
    s_waitcnt vmcnt(21) lgkmcnt(2)
    v_mfma_f32_32x32x16_bf16 a[0:15], a[72:75], v[120:123], a[0:15]
    s_add_u32 s44, s19, 157696
    s_add_u32 m0, s16, 10240
    s_nop 0
    buffer_load_dwordx4 v3, s[24:27], s44 offen lds
    s_waitcnt vmcnt(19)
    ds_read_b64_tr_b16 a[80:81], v5 offset:0
    ds_read_b64_tr_b16 a[82:83], v5 offset:1024
    ds_read_b64_tr_b16 a[84:85], v6 offset:0
    ds_read_b64_tr_b16 a[86:87], v6 offset:1024
    v_mfma_f32_32x32x16_bf16 a[16:31], a[72:75], v[124:127], a[16:31]
    s_add_u32 m0, s16, 11264
    s_add_u32 s45, s42, 11264
    buffer_load_dwordx4 v4, s[24:27], s44 offen lds
    s_waitcnt lgkmcnt(4)
    v_mfma_f32_32x32x16_bf16 a[32:47], a[76:79], v[120:123], a[32:47]
    s_add_u32 s46, s45, 90112
    buffer_load_dwordx4 v[168:171], v2, s[28:31], s45 offen
    v_mfma_f32_32x32x16_bf16 a[48:63], a[76:79], v[124:127], a[48:63]
    buffer_load_dwordx4 v[172:175], v2, s[28:31], s46 offen
    s_waitcnt vmcnt(21) lgkmcnt(2)
    v_mfma_f32_32x32x16_bf16 a[0:15], a[80:83], v[128:131], a[0:15]
    s_add_u32 s44, s19, 172032
    s_add_u32 m0, s16, 12288
    s_nop 0
    buffer_load_dwordx4 v3, s[24:27], s44 offen lds
    s_waitcnt vmcnt(19)
    ds_read_b64_tr_b16 a[64:65], v5 offset:2048
    ds_read_b64_tr_b16 a[66:67], v5 offset:3072
    ds_read_b64_tr_b16 a[68:69], v6 offset:2048
    ds_read_b64_tr_b16 a[70:71], v6 offset:3072
    v_mfma_f32_32x32x16_bf16 a[16:31], a[80:83], v[132:135], a[16:31]
    s_add_u32 m0, s16, 13312
    s_add_u32 s45, s42, 12288
    buffer_load_dwordx4 v4, s[24:27], s44 offen lds
    s_waitcnt lgkmcnt(4)
    v_mfma_f32_32x32x16_bf16 a[32:47], a[84:87], v[128:131], a[32:47]
    s_add_u32 s46, s45, 90112
    buffer_load_dwordx4 v[176:179], v2, s[28:31], s45 offen
    v_mfma_f32_32x32x16_bf16 a[48:63], a[84:87], v[132:135], a[48:63]
    buffer_load_dwordx4 v[180:183], v2, s[28:31], s46 offen
    s_waitcnt vmcnt(21) lgkmcnt(2)
    v_mfma_f32_32x32x16_bf16 a[0:15], a[64:67], v[136:139], a[0:15]
    s_add_u32 s44, s19, 186368
    s_add_u32 m0, s16, 14336
    s_nop 0
    buffer_load_dwordx4 v3, s[24:27], s44 offen lds
    s_waitcnt vmcnt(19)
    ds_read_b64_tr_b16 a[72:73], v5 offset:4096
    ds_read_b64_tr_b16 a[74:75], v5 offset:5120
    ds_read_b64_tr_b16 a[76:77], v6 offset:4096
    ds_read_b64_tr_b16 a[78:79], v6 offset:5120
    v_mfma_f32_32x32x16_bf16 a[16:31], a[64:67], v[140:143], a[16:31]
    s_add_u32 m0, s16, 15360
    s_add_u32 s45, s42, 13312
    buffer_load_dwordx4 v4, s[24:27], s44 offen lds
    s_waitcnt lgkmcnt(4)
    v_mfma_f32_32x32x16_bf16 a[32:47], a[68:71], v[136:139], a[32:47]
    s_add_u32 s46, s45, 90112
    buffer_load_dwordx4 v[184:187], v2, s[28:31], s45 offen
    v_mfma_f32_32x32x16_bf16 a[48:63], a[68:71], v[140:143], a[48:63]
    buffer_load_dwordx4 v[188:191], v2, s[28:31], s46 offen
    s_waitcnt vmcnt(21) lgkmcnt(2)
    v_mfma_f32_32x32x16_bf16 a[0:15], a[72:75], v[144:147], a[0:15]
    s_waitcnt vmcnt(18)
    ds_read_b64_tr_b16 a[80:81], v5 offset:6144
    ds_read_b64_tr_b16 a[82:83], v5 offset:7168
    ds_read_b64_tr_b16 a[84:85], v6 offset:6144
    ds_read_b64_tr_b16 a[86:87], v6 offset:7168
    v_mfma_f32_32x32x16_bf16 a[16:31], a[72:75], v[148:151], a[16:31]
    s_waitcnt lgkmcnt(4)
    v_mfma_f32_32x32x16_bf16 a[32:47], a[76:79], v[144:147], a[32:47]
    v_mfma_f32_32x32x16_bf16 a[48:63], a[76:79], v[148:151], a[48:63]
    s_waitcnt vmcnt(17) lgkmcnt(2)
    v_mfma_f32_32x32x16_bf16 a[0:15], a[80:83], v[152:155], a[0:15]
    s_waitcnt vmcnt(14)
    ds_read_b64_tr_b16 a[64:65], v5 offset:8192
    ds_read_b64_tr_b16 a[66:67], v5 offset:9216
    ds_read_b64_tr_b16 a[68:69], v6 offset:8192
    ds_read_b64_tr_b16 a[70:71], v6 offset:9216
    v_mfma_f32_32x32x16_bf16 a[16:31], a[80:83], v[156:159], a[16:31]
    s_waitcnt lgkmcnt(4)
    v_mfma_f32_32x32x16_bf16 a[32:47], a[84:87], v[152:155], a[32:47]
    v_mfma_f32_32x32x16_bf16 a[48:63], a[84:87], v[156:159], a[48:63]
    s_waitcnt vmcnt(13) lgkmcnt(2)
    v_mfma_f32_32x32x16_bf16 a[0:15], a[64:67], v[160:163], a[0:15]
    s_waitcnt vmcnt(10)
    ds_read_b64_tr_b16 a[72:73], v5 offset:10240
    ds_read_b64_tr_b16 a[74:75], v5 offset:11264
    ds_read_b64_tr_b16 a[76:77], v6 offset:10240
    ds_read_b64_tr_b16 a[78:79], v6 offset:11264
    v_mfma_f32_32x32x16_bf16 a[16:31], a[64:67], v[164:167], a[16:31]
    s_waitcnt lgkmcnt(4)
    v_mfma_f32_32x32x16_bf16 a[32:47], a[68:71], v[160:163], a[32:47]
    v_mfma_f32_32x32x16_bf16 a[48:63], a[68:71], v[164:167], a[48:63]
    s_waitcnt vmcnt(9) lgkmcnt(2)
    v_mfma_f32_32x32x16_bf16 a[0:15], a[72:75], v[168:171], a[0:15]
    s_waitcnt vmcnt(6)
    ds_read_b64_tr_b16 a[80:81], v5 offset:12288
    ds_read_b64_tr_b16 a[82:83], v5 offset:13312
    ds_read_b64_tr_b16 a[84:85], v6 offset:12288
    ds_read_b64_tr_b16 a[86:87], v6 offset:13312
    v_mfma_f32_32x32x16_bf16 a[16:31], a[72:75], v[172:175], a[16:31]
    s_waitcnt lgkmcnt(4)
    v_mfma_f32_32x32x16_bf16 a[32:47], a[76:79], v[168:171], a[32:47]
    v_mfma_f32_32x32x16_bf16 a[48:63], a[76:79], v[172:175], a[48:63]
    s_waitcnt vmcnt(5) lgkmcnt(2)
    v_mfma_f32_32x32x16_bf16 a[0:15], a[80:83], v[176:179], a[0:15]
    s_waitcnt vmcnt(2)
    ds_read_b64_tr_b16 a[64:65], v5 offset:14336
    ds_read_b64_tr_b16 a[66:67], v5 offset:15360
    ds_read_b64_tr_b16 a[68:69], v6 offset:14336
    ds_read_b64_tr_b16 a[70:71], v6 offset:15360
    v_mfma_f32_32x32x16_bf16 a[16:31], a[80:83], v[180:183], a[16:31]
    s_waitcnt lgkmcnt(4)
    v_mfma_f32_32x32x16_bf16 a[32:47], a[84:87], v[176:179], a[32:47]
    v_mfma_f32_32x32x16_bf16 a[48:63], a[84:87], v[180:183], a[48:63]
    s_waitcnt vmcnt(1) lgkmcnt(2)
    v_mfma_f32_32x32x16_bf16 a[0:15], a[64:67], v[184:187], a[0:15]
    s_waitcnt vmcnt(0)
    v_mfma_f32_32x32x16_bf16 a[16:31], a[64:67], v[188:191], a[16:31]
    s_waitcnt lgkmcnt(0)
    v_mfma_f32_32x32x16_bf16 a[32:47], a[68:71], v[184:187], a[32:47]
    v_mfma_f32_32x32x16_bf16 a[48:63], a[68:71], v[188:191], a[48:63]
    v_add_u32 v9, s16, v2
    s_nop 5
    ds_write_b128 v9, a[0:3] offset:0
    ds_write_b128 v9, a[4:7] offset:1024
    ds_write_b128 v9, a[8:11] offset:2048
    ds_write_b128 v9, a[12:15] offset:3072
    ds_write_b128 v9, a[16:19] offset:4096
    ds_write_b128 v9, a[20:23] offset:5120
    ds_write_b128 v9, a[24:27] offset:6144
    ds_write_b128 v9, a[28:31] offset:7168
    ds_write_b128 v9, a[32:35] offset:8192
    ds_write_b128 v9, a[36:39] offset:9216
    ds_write_b128 v9, a[40:43] offset:10240
    ds_write_b128 v9, a[44:47] offset:11264
    ds_write_b128 v9, a[48:51] offset:12288
    ds_write_b128 v9, a[52:55] offset:13312
    ds_write_b128 v9, a[56:59] offset:14336
    ds_write_b128 v9, a[60:63] offset:15360
    s_waitcnt lgkmcnt(0)
    s_barrier
    s_and_b32 s48, s3, 1
    s_lshl_b32 s48, s48, 1
    s_lshr_b32 s49, s3, 1
    s_add_u32 s48, s48, s49
    s_lshl_b32 s48, s48, 12
    v_add_u32 v9, s48, v2
    v_add_u32 v10, 57344, v9
    ds_read_b128 v[16:19], v9 offset:0
    ds_read_b128 v[20:23], v9 offset:1024
    ds_read_b128 v[24:27], v9 offset:2048
    ds_read_b128 v[28:31], v9 offset:3072
    ds_read_b128 v[32:35], v9 offset:28672
    ds_read_b128 v[36:39], v9 offset:29696
    ds_read_b128 v[40:43], v9 offset:30720
    ds_read_b128 v[44:47], v9 offset:31744
    ds_read_b128 v[48:51], v10 offset:0
    ds_read_b128 v[52:55], v10 offset:1024
    ds_read_b128 v[56:59], v10 offset:2048
    ds_read_b128 v[60:63], v10 offset:3072
    ds_read_b128 v[64:67], v10 offset:28672
    ds_read_b128 v[68:71], v10 offset:29696
    ds_read_b128 v[72:75], v10 offset:30720
    ds_read_b128 v[76:79], v10 offset:31744
    v_permlane32_swap_b32 v208, v210
    v_permlane32_swap_b32 v209, v211
    v_permlane32_swap_b32 v212, v214
    v_permlane32_swap_b32 v213, v215
    v_lshlrev_b32 v96, 16, v208
    v_and_b32 v97, 0xffff0000, v208
    v_lshlrev_b32 v98, 16, v209
    v_and_b32 v99, 0xffff0000, v209
    v_lshlrev_b32 v100, 16, v210
    v_and_b32 v101, 0xffff0000, v210
    v_lshlrev_b32 v102, 16, v211
    v_and_b32 v103, 0xffff0000, v211
    v_lshlrev_b32 v104, 16, v212
    v_and_b32 v105, 0xffff0000, v212
    v_lshlrev_b32 v106, 16, v213
    v_and_b32 v107, 0xffff0000, v213
    v_lshlrev_b32 v108, 16, v214
    v_and_b32 v109, 0xffff0000, v214
    v_lshlrev_b32 v110, 16, v215
    v_and_b32 v111, 0xffff0000, v215
    s_waitcnt lgkmcnt(11)
    v_add_f32 v16, v16, v32
    s_waitcnt lgkmcnt(3)
    v_add_f32 v48, v48, v64
    v_add_f32 v16, v16, v96
    v_add_f32 v16, v16, v48
    v_add_f32 v17, v17, v33
    v_add_f32 v49, v49, v65
    v_add_f32 v17, v17, v97
    v_add_f32 v17, v17, v49
    v_add_f32 v18, v18, v34
    v_add_f32 v50, v50, v66
    v_add_f32 v18, v18, v98
    v_add_f32 v18, v18, v50
    v_add_f32 v19, v19, v35
    v_add_f32 v51, v51, v67
    v_add_f32 v19, v19, v99
    v_add_f32 v19, v19, v51
    v_add_f32 v20, v20, v36
    s_waitcnt lgkmcnt(2)
    v_add_f32 v52, v52, v68
    v_add_f32 v20, v20, v100
    v_add_f32 v20, v20, v52
    v_add_f32 v21, v21, v37
    v_add_f32 v53, v53, v69
    v_add_f32 v21, v21, v101
    v_add_f32 v21, v21, v53
    v_add_f32 v22, v22, v38
    v_add_f32 v54, v54, v70
    v_add_f32 v22, v22, v102
    v_add_f32 v22, v22, v54
    v_add_f32 v23, v23, v39
    v_add_f32 v55, v55, v71
    v_add_f32 v23, v23, v103
    v_add_f32 v23, v23, v55
    v_add_f32 v24, v24, v40
    s_waitcnt lgkmcnt(1)
    v_add_f32 v56, v56, v72
    v_add_f32 v24, v24, v104
    v_add_f32 v24, v24, v56
    v_add_f32 v25, v25, v41
    v_add_f32 v57, v57, v73
    v_add_f32 v25, v25, v105
    v_add_f32 v25, v25, v57
    v_add_f32 v26, v26, v42
    v_add_f32 v58, v58, v74
    v_add_f32 v26, v26, v106
    v_add_f32 v26, v26, v58
    v_add_f32 v27, v27, v43
    v_add_f32 v59, v59, v75
    v_add_f32 v27, v27, v107
    v_add_f32 v27, v27, v59
    v_add_f32 v28, v28, v44
    s_waitcnt lgkmcnt(0)
    v_add_f32 v60, v60, v76
    v_add_f32 v28, v28, v108
    v_add_f32 v28, v28, v60
    v_add_f32 v29, v29, v45
    v_add_f32 v61, v61, v77
    v_add_f32 v29, v29, v109
    v_add_f32 v29, v29, v61
    v_add_f32 v30, v30, v46
    v_add_f32 v62, v62, v78
    v_add_f32 v30, v30, v110
    v_add_f32 v30, v30, v62
    v_add_f32 v31, v31, v47
    v_add_f32 v63, v63, v79
    v_add_f32 v31, v31, v111
    v_add_f32 v31, v31, v63
    v_cvt_pk_bf16_f32 v120, v16, v17
    v_cvt_pk_bf16_f32 v121, v18, v19
    v_cvt_pk_bf16_f32 v122, v20, v21
    v_cvt_pk_bf16_f32 v123, v22, v23
    v_cvt_pk_bf16_f32 v124, v24, v25
    v_cvt_pk_bf16_f32 v125, v26, v27
    v_cvt_pk_bf16_f32 v126, v28, v29
    v_cvt_pk_bf16_f32 v127, v30, v31
    v_permlane32_swap_b32 v120, v122
    v_permlane32_swap_b32 v121, v123
    v_permlane32_swap_b32 v124, v126
    v_permlane32_swap_b32 v125, v127
    buffer_store_dwordx4 v[120:123], v7, s[36:39], s47 offen
    buffer_store_dwordx4 v[124:127], v7, s[36:39], s47 offen offset:32
L_k3_end:
    s_endpgm
.section .rodata,"a"
.p2align 6
.amdhsa_kernel k3_kernel
  .amdhsa_next_free_vgpr 304
  .amdhsa_next_free_sgpr 100
  .amdhsa_accum_offset 216
  .amdhsa_group_segment_fixed_size 0
  .amdhsa_kernarg_size 88
  .amdhsa_user_sgpr_count 2
  .amdhsa_user_sgpr_kernarg_segment_ptr 1
  .amdhsa_system_sgpr_workgroup_id_x 1
.end_amdhsa_kernel
```
